```python
import torch

def _softmax(x, axis=-1):
    return torch.softmax(x, dim=axis)
def _gelu(x):
    return torch.nn.functional.gelu(x, approximate="tanh")
def _silu(x):
    return torch.nn.functional.silu(x)
def _sigmoid(x):
    return torch.sigmoid(x)
def _layernorm(x, axis=-1, eps=1e-5):
    m = x.mean(dim=axis, keepdim=True)
    v = x.var(dim=axis, keepdim=True, unbiased=False)
    return (x - m) / torch.sqrt(v + eps)
def _scatter_add(tgt, idx, src, axis=0):
    return tgt.clone().index_add_(axis, idx, src)
def _segment_sum(src, seg, n):
    out = torch.zeros((n,) + src.shape[1:], dtype=src.dtype)
    return out.index_add_(0, seg, src)
def _pad(x, pw):
    flat = tuple(v for pair in reversed(pw) for v in pair)
    return torch.nn.functional.pad(x, flat)

kernel_name = 'parallel_sum__linear_attn_block__mixer_channel_mlp__prompt'

def setup_inputs():

    _w = (lambda a: (lambda t: t.to(torch.bfloat16) if t.is_floating_point() else t)(torch.as_tensor(a)))
    def _A_setup():
        B, S, D = 1, 2048, 640
        return {
            "x": _w((lambda *s: torch.randn(*s, dtype=torch.bfloat16) * 0.05)(B, S, D)),
            "wqkv": _w((lambda *s: torch.randn(*s, dtype=torch.bfloat16) * 0.1)(D, 3 * D)),
            "wo": _w((lambda *s: torch.randn(*s, dtype=torch.bfloat16) * 0.05)(D, D)),
        }
    _A_in = _A_setup()

    def _B_setup():
        B, S, D, F = 1, 2048, 640, 1728
        return {
            "x": _w((lambda *s: torch.randn(*s, dtype=torch.bfloat16) * 0.05)(B, S, D)),
            "w1": _w((lambda *s: torch.randn(*s, dtype=torch.bfloat16) * 1.6)(D, F) * (D ** -0.5)),
            "b1": _w((lambda *s: torch.randn(*s, dtype=torch.bfloat16) * 0.8)(F)),
            "w2": _w((lambda *s: torch.randn(*s, dtype=torch.bfloat16) * 0.05)(F, D) * (F ** -0.5)),
            "b2": _w((lambda *s: torch.randn(*s, dtype=torch.bfloat16) * 0.05)(D)),
        }
    _B_in = _B_setup()

    return {
        "A_x": _A_in["x"],
        "A_wqkv": _A_in["wqkv"],
        "A_wo": _A_in["wo"],
        "B_x": _B_in["x"],
        "B_w1": _B_in["w1"],
        "B_b1": _B_in["b1"],
        "B_w2": _B_in["w2"],
        "B_b2": _B_in["b2"],
    }

def reference(A_x, A_wqkv, A_wo, B_x, B_w1, B_b1, B_w2, B_b2):
    def _A_ref(x, wqkv, wo):
        B, S, D = x.shape
        H = 32; Dh = D // H
        qkv = (lambda x, *d: x.permute(*d))((x @ wqkv).reshape(B, S, 3, H, Dh), 2, 0, 3, 1, 4)
        q, k, v = qkv[0], qkv[1], qkv[2]
        phi = lambda t: torch.where(t > 0, t + 1, torch.exp(t)) + 1e-6
        pq, pk = phi(q), phi(k)
        kv = torch.einsum("bhsd,bhse->bhde", pk, v)
        z = torch.einsum("bhsd->bhd", pk)
        num = torch.einsum("bhqd,bhde->bhqe", pq, kv)
        den = torch.einsum("bhqd,bhd->bhq", pq, z)[..., None] + 1e-6
        o = num / den
        return (lambda x, *d: x.permute(*d))(o, 0, 2, 1, 3).reshape(B, S, D) @ wo

    def _B_ref(x, w1, b1, w2, b2):
        y = _layernorm(x, axis=-1)
        h = _gelu(torch.einsum("bsd,df->bsf", y, w1) + b1)
        return torch.einsum("bsf,fd->bsd", h, w2) + b2

    x = A_x
    xn = _layernorm(x, axis=-1)
    return x + _A_ref(xn, A_wqkv, A_wo) + _B_ref(xn, B_w1, B_b1, B_w2, B_b2)
```

```asm
; @launch grid=(256,1,1) block=(256,1,1) lds=163840
.amdgcn_target "amdgcn-amd-amdhsa--gfx950"
.text
.globl parallel_sum__linear_attn_block__mixer_channel_mlp__prompt_kernel
.p2align 8
.type parallel_sum__linear_attn_block__mixer_channel_mlp__prompt_kernel,@function
parallel_sum__linear_attn_block__mixer_channel_mlp__prompt_kernel:
  s_cmp_ge_u32 s2, 256
  s_cbranch_scc1 L_end
  s_load_dwordx16 s[4:19], s[0:1], 0
  s_load_dwordx4 s[20:23], s[0:1], 64
  s_load_dwordx2 s[24:25], s[0:1], 80
  s_memrealtime s[74:75]
  s_getpc_b64 s[80:81]
  s_and_b32 s79, s2, 0xf8
  s_lshl_b32 s79, s79, 8
  v_and_b32 v253, 0xc3, v0
  v_lshrrev_b32 v254, 4, v253
  v_and_or_b32 v253, v253, 3, v254
  v_lshl_add_u32 v253, v253, 7, s79
  s_mov_b64 exec, 15
  global_load_dword v39, v253, s[80:81]
  s_mov_b64 exec, -1
  v_lshrrev_b32 v252, 6, v0
  v_and_b32 v1, 63, v0
  v_readfirstlane_b32 s68, v252
  v_lshlrev_b32 v37, 4, v1
  s_and_b32 s79, s2, 1
  s_lshl_b32 s79, s79, 3
  s_bfe_u32 s80, s2, 0x30003
  s_add_u32 s69, s79, s80
  v_lshrrev_b32 v252, 3, v1
  v_lshrrev_b32 v253, 4, v1
  v_and_b32 v254, 7, v1
  v_xor_b32 v254, v254, v253
  v_lshlrev_b32 v254, 4, v254
  v_mul_u32_u24 v252, 1280, v252
  v_add_u32 v2, v252, v254
  v_xor_b32 v3, 64, v2
  v_add_u32 v3, 9216, v3
  v_add_u32 v4, 18432, v2
  v_add_u32 v5, 18432, v3
  s_lshl_b32 s79, s69, 2
  s_add_u32 s79, s79, s68
  s_mul_i32 s76, s79, 40960
  s_mul_i32 s86, s68, 12288
  s_add_u32 s86, s86, 81920
  s_mul_i32 s94, s68, 5120
  s_mov_b32 s30, 2621440
  s_mov_b32 s31, 0x20000
  s_bfe_u32 s79, s2, 0x20001
  s_lshr_b32 s80, s2, 6
  s_lshl_b32 s71, s79, 2
  s_add_u32 s71, s71, s80
  s_lshr_b32 s72, s80, 1
  s_lshl_b32 s70, s79, 1
  s_add_u32 s70, s70, s72
  s_mul_i32 s77, s70, 160
  s_mul_i32 s3, s70, 384
  s_waitcnt lgkmcnt(0)
  s_mov_b32 s28, s4
  s_mov_b32 s29, s5
  s_add_u32 s100, s76, 0
  s_add_u32 m0, s86, 0
  s_nop 0
  buffer_load_dwordx4 v2, s[28:31], s100 offen offset:0 lds
  s_add_u32 m0, s86, 0
  s_nop 0
  buffer_load_dwordx4 v3, s[28:31], s100 offen offset:1024 lds
  s_add_u32 m0, s86, 0
  s_nop 0
  buffer_load_dwordx4 v4, s[28:31], s100 offen offset:2048 lds
  s_add_u32 m0, s86, 0
  s_nop 0
  buffer_load_dwordx4 v5, s[28:31], s100 offen offset:3072 lds
  s_mov_b32 s32, s6
  s_mov_b32 s33, s7
  s_mov_b32 s34, 2457600
  s_mov_b32 s35, 0x20000
  s_mov_b32 s36, s12
  s_mov_b32 s37, s13
  s_mov_b32 s38, 2211840
  s_mov_b32 s39, 0x20000
  s_bitcmp1_b32 s2, 6
  s_cbranch_scc1 L_q
  s_lshl_b32 s79, s72, 8
  s_sub_u32 s3, s3, s79
  s_add_u32 s77, s77, 1280
  s_mov_b32 s83, 0
  s_mov_b32 s73, 0
  v_mul_u32_u24 v255, 6554, v1
  s_mov_b32 s80, 3680
  v_lshrrev_b32 v253, 16, v255
  v_mad_u32_u24 v10, v253, s80, v37
  v_add_u32 v253, 419456, v255
  v_lshrrev_b32 v253, 16, v253
  v_mad_u32_u24 v11, v253, s80, v37
  v_add_u32 v11, 1024, v11
  v_add_u32 v253, 838912, v255
  v_lshrrev_b32 v253, 16, v253
  v_mad_u32_u24 v12, v253, s80, v37
  v_add_u32 v12, 2048, v12
  v_lshrrev_b32 v253, 4, v253
  v_mul_u32_u24 v253, 60160, v253
  v_sub_u32 v12, v12, v253
  v_add_u32 v253, 1258368, v255
  v_lshrrev_b32 v253, 16, v253
  v_mad_u32_u24 v13, v253, s80, v37
  v_add_u32 v13, 4294910208, v13
  v_add_u32 v253, 1677824, v255
  v_lshrrev_b32 v253, 16, v253
  v_mad_u32_u24 v14, v253, s80, v37
  v_add_u32 v14, 4294911232, v14
  s_mul_i32 s79, s68, 61440
  s_add_u32 s90, s77, s79
  s_add_u32 s101, s90, 0
  s_add_u32 m0, s94, 0
  s_nop 0
  buffer_load_dwordx4 v10, s[32:35], s101 offen offset:0 lds
  s_add_u32 m0, s94, 1024
  s_nop 0
  buffer_load_dwordx4 v11, s[32:35], s101 offen offset:0 lds
  s_add_u32 m0, s94, 2048
  s_nop 0
  buffer_load_dwordx4 v12, s[32:35], s101 offen offset:0 lds
  s_add_u32 m0, s94, 3072
  s_nop 0
  buffer_load_dwordx4 v13, s[32:35], s101 offen offset:0 lds
  s_add_u32 m0, s94, 4096
  s_nop 0
  buffer_load_dwordx4 v14, s[32:35], s101 offen offset:0 lds
  s_or_b32 s79, s2, s68
  s_cmp_lg_u32 s79, 0
  s_cbranch_scc1 L_nn
  s_max_u32 s79, s74, 1
  v_mov_b32 v252, s79
  v_lshlrev_b32 v253, 2, v1
  global_store_dword v253, v252, s[22:23] sc1
L_nn:
  s_lshl_b32 s75, s68, 10
  s_lshl_b32 s79, s69, 7
  s_lshl_b32 s80, s71, 3
  s_add_u32 s79, s79, s80
  s_lshl_b32 s80, s68, 1
  s_add_u32 s81, s79, s80
  s_mul_i32 s78, s81, 1280
  v_lshrrev_b32 v252, 5, v1
  v_mul_u32_u24 v253, 1280, v252
  v_and_b32 v254, 31, v1
  v_lshl_add_u32 v173, v254, 3, v253
  v_add_u32 v172, s81, v252
  s_cmp_lg_u32 s68, 0
  s_cbranch_scc1 L_s0p2
  s_mov_b32 s40, s6
  s_mov_b32 s41, s7
  s_mov_b32 s44, 3840
  s_mov_b32 s52, 0
  s_add_u32 s46, s77, 0
  s_mov_b32 s92, 1073741824
  s_mov_b32 s42, s6
  s_mov_b32 s43, s7
  s_mov_b32 s45, 3840
  s_mov_b32 s53, 0
  s_add_u32 s47, s77, 64
  s_mov_b32 s93, 1073741824
  s_branch L_s0p1
L_s0p2:
  s_cmp_lg_u32 s68, 1
  s_cbranch_scc1 L_s0p3
  s_mov_b32 s40, s6
  s_mov_b32 s41, s7
  s_mov_b32 s44, 3840
  s_mov_b32 s52, 1248
  s_add_u32 s46, s77, 128
  s_mov_b32 s92, 1073741824
  s_mov_b32 s42, s6
  s_mov_b32 s43, s7
  s_mov_b32 s45, 3840
  s_mov_b32 s53, 0
  s_add_u32 s47, s77, 1280
  s_mov_b32 s93, 1073741824
  s_branch L_s0p1
L_s0p3:
  s_cmp_lg_u32 s68, 2
  s_cbranch_scc1 L_s0p4
  s_mov_b32 s40, s6
  s_mov_b32 s41, s7
  s_mov_b32 s44, 3840
  s_mov_b32 s52, 0
  s_add_u32 s46, s77, 1344
  s_mov_b32 s92, 1073741824
  s_mov_b32 s42, s12
  s_mov_b32 s43, s13
  s_mov_b32 s45, 3456
  s_mov_b32 s53, 0
  s_add_u32 s47, s3, 0
  s_mov_b32 s93, s47
  s_branch L_s0p1
L_s0p4:
  s_mov_b32 s40, s12
  s_mov_b32 s41, s13
  s_mov_b32 s44, 3456
  s_mov_b32 s52, 0
  s_add_u32 s46, s3, 64
  s_mov_b32 s92, s46
  s_mov_b32 s42, s12
  s_mov_b32 s43, s13
  s_mov_b32 s45, 3456
  s_mov_b32 s53, 0
  s_mov_b32 s47, 0
  s_mov_b32 s93, 1073741824
L_s0p1:
  v_and_b32 v252, 4, v1
  v_cmp_ne_u32 vcc, 0, v252
  v_mov_b32 v174, s44
  v_mov_b32 v253, s45
  v_cndmask_b32 v174, v174, v253, vcc
  v_mov_b32 v175, 0
  v_mov_b32 v254, s46
  v_mov_b32 v253, s47
  v_cndmask_b32 v254, v254, v253, vcc
  v_mov_b32 v255, s52
  v_mov_b32 v253, s53
  v_cndmask_b32 v255, v255, v253, vcc
  v_mov_b32 v158, s40
  v_mov_b32 v253, s42
  v_cndmask_b32 v158, v158, v253, vcc
  v_mov_b32 v159, s41
  v_mov_b32 v253, s43
  v_cndmask_b32 v159, v159, v253, vcc
  v_bfe_u32 v252, v1, 1, 1
  v_mad_i32_i24 v254, v252, v255, v254
  v_and_b32 v252, 3, v1
  v_lshl_add_u32 v254, v252, 4, v254
  v_lshrrev_b32 v252, 3, v1
  v_mul_u32_u24 v252, 5, v252
  s_mul_i32 s79, s69, 40
  v_add_u32 v252, s79, v252
  v_mad_u32_u24 v254, v252, v174, v254
  v_mov_b32 v255, 0
  v_lshl_add_u64 v[158:159], v[254:255], 0, v[158:159]
  v_lshl_add_u64 v[160:161], v[174:175], 0, v[158:159]
  v_lshl_add_u64 v[162:163], v[174:175], 0, v[160:161]
  v_lshl_add_u64 v[164:165], v[174:175], 0, v[162:163]
  v_lshl_add_u64 v[166:167], v[174:175], 0, v[164:165]
  buffer_load_dwordx2 v[128:129], v173, s[28:31], s78 offen offset:0
  buffer_load_dwordx2 v[130:131], v173, s[28:31], s78 offen offset:256
  buffer_load_dwordx2 v[132:133], v173, s[28:31], s78 offen offset:512
  buffer_load_dwordx2 v[134:135], v173, s[28:31], s78 offen offset:768
  buffer_load_dwordx2 v[136:137], v173, s[28:31], s78 offen offset:1024
  global_load_dwordx4 v[138:141], v[158:159], off
  global_load_dwordx4 v[142:145], v[160:161], off
  global_load_dwordx4 v[146:149], v[162:163], off
  global_load_dwordx4 v[150:153], v[164:165], off
  global_load_dwordx4 v[154:157], v[166:167], off
  v_and_b32 v252, 31, v1
  v_lshrrev_b32 v253, 5, v1
  v_bfe_u32 v254, v1, 1, 3
  v_xor_b32 v254, v254, v253
  v_lshlrev_b32 v254, 4, v254
  v_lshl_add_u32 v254, v252, 7, v254
  v_xor_b32 v6, 0, v254
  v_add_u32 v6, s86, v6
  v_xor_b32 v7, 32, v254
  v_add_u32 v7, s86, v7
  v_xor_b32 v8, 64, v254
  v_add_u32 v8, s86, v8
  v_xor_b32 v9, 96, v254
  v_add_u32 v9, s86, v9
  v_lshrrev_b32 v253, 5, v1
  v_bfe_u32 v252, v1, 2, 2
  v_lshl_add_u32 v252, v253, 3, v252
  v_bfe_u32 v253, v1, 4, 1
  v_and_b32 v254, 3, v1
  v_lshlrev_b32 v254, 3, v254
  v_mul_u32_u24 v252, 160, v252
  v_add_u32 v252, v252, v254
  v_lshl_add_u32 v208, v253, 5, v252
  v_add_u32 v210, 128, v252
  v_mul_u32_u24 v253, 2560, v253
  v_add_u32 v210, v210, v253
  v_add_u32 v209, 0x8000, v208
  v_add_u32 v211, 0x8000, v210
  s_mov_b32 s48, s24
  s_mov_b32 s49, s25
  s_mov_b32 s50, 20971520
  s_mov_b32 s51, 0x20000
  s_mov_b32 s88, 0x3f80
  s_mov_b32 s89, 0x3f800000
  s_mov_b32 s64, s22
  s_mov_b32 s65, s23
  s_mov_b32 s66, 256
  s_mov_b32 s67, 0x20000
  v_mov_b32 v45, 0
  s_mov_b32 s56, s14
  s_mov_b32 s57, s15
  s_mov_b32 s58, 3456
  s_mov_b32 s59, 0x20000
  s_mov_b32 s40, s8
  s_mov_b32 s41, s9
  s_mov_b32 s42, 819200
  s_mov_b32 s43, 0x20000
  s_mov_b32 s44, s16
  s_mov_b32 s45, s17
  s_mov_b32 s46, 2211840
  s_mov_b32 s47, 0x20000
  s_mov_b32 s52, s20
  s_mov_b32 s53, s21
  s_mov_b32 s54, 2621440
  s_mov_b32 s55, 0x20000
  s_mov_b32 s60, s18
  s_mov_b32 s61, s19
  s_mov_b32 s62, 1280
  s_mov_b32 s63, 0x20000
  v_and_b32 v252, 31, v1
  v_lshrrev_b32 v253, 5, v1
  v_lshlrev_b32 v19, 4, v252
  v_add_u32 v19, 131072, v19
  v_sub_u32 v29, 0, v253
  v_bfe_u32 v254, v1, 4, 1
  v_mul_u32_u24 v254, 75776, v254
  v_and_b32 v255, 15, v1
  v_lshl_add_u32 v255, v253, 4, v255
  v_lshl_add_u32 v15, v255, 4, v254
  s_lshl_b32 s79, s69, 2
  s_add_u32 s79, s79, s68
  s_mul_i32 s85, s79, 151552
  s_add_u32 s85, s85, 8388608
  s_mul_i32 s25, s70, 2560
  s_add_u32 s25, s25, s85
  s_add_u32 s85, s85, 20480
  s_lshl_b32 s79, s73, 4
  s_add_u32 s95, s85, s79
  s_or_b32 s95, s95, s83
  s_lshl_b32 s79, s3, 4
  s_add_u32 s85, s85, s79
  s_lshl_b32 s79, s2, 7
  v_and_b32 v254, 1073741824, v29
  v_lshl_add_u32 v254, v252, 2, v254
  v_add_u32 v206, s79, v254
  s_lshl_b32 s79, s2, 9
  s_lshl_b32 s80, s68, 7
  s_add_u32 s79, s79, s80
  v_add_u32 v16, s79, v254
  v_mov_b32 v201, 0
  v_lshlrev_b32 v200, 2, v1
  v_add_u32 v200, 135680, v200
  ds_write_b32 v200, v201
  v_mov_b32 v201, 1
  s_mov_b32 s84, 897988541
  s_lshl_b32 s79, s2, 2
  s_add_u32 s79, s79, s68
  s_mul_i32 s96, s79, 2176
  s_mul_i32 s97, s79, 896
  v_lshlrev_b32 v179, 7, v1
  s_lshr_b32 s79, s69, 3
  s_and_b32 s80, s69, 7
  s_lshl_b32 s80, s80, 3
  s_add_u32 s79, s79, s80
  s_lshl_b32 s79, s79, 7
  v_and_b32 v252, 48, v1
  v_lshlrev_b32 v252, 4, v252
  v_bfe_u32 v253, v1, 2, 2
  v_lshl_add_u32 v252, v253, 13, v252
  v_add_u32 v17, s79, v252
  s_lshr_b32 s79, s71, 2
  s_lshl_b32 s79, s79, 8
  s_and_b32 s80, s71, 3
  s_lshl_b32 s80, s80, 13
  s_add_u32 s79, s79, s80
  v_and_b32 v252, 32, v1
  v_lshlrev_b32 v252, 2, v252
  v_bfe_u32 v253, v1, 2, 3
  v_lshl_add_u32 v252, v253, 10, v252
  v_add_u32 v18, s79, v252
  v_and_b32 v252, 31, v1
  v_lshlrev_b32 v252, 6, v252
  s_lshl_b32 s79, s69, 2
  s_add_u32 s79, s79, s68
  s_lshl_b32 s79, s79, 11
  s_add_u32 s79, s79, 6291456
  v_add_u32 v216, s79, v252
  v_lshrrev_b32 v252, 4, v1
  v_lshlrev_b32 v252, 10, v252
  v_and_b32 v253, 15, v1
  v_lshl_add_u32 v252, v253, 4, v252
  s_lshl_b32 s79, s71, 14
  s_lshl_b32 s80, s68, 8
  s_add_u32 s79, s79, s80
  s_waitcnt vmcnt(10) lgkmcnt(0)
  s_barrier
  ds_read_b128 a[0:3], v6 offset:0
  ds_read_b128 a[4:7], v7 offset:0
  ds_read_b128 a[8:11], v8 offset:0
  ds_read_b128 a[12:15], v9 offset:0
  ds_read_b64_tr_b16 a[160:161], v208 offset:0
  ds_read_b64_tr_b16 a[162:163], v208 offset:640
  ds_read_b64_tr_b16 a[164:165], v208 offset:5120
  ds_read_b64_tr_b16 a[166:167], v208 offset:5760
  ds_read_b64_tr_b16 a[168:169], v208 offset:10240
  ds_read_b64_tr_b16 a[170:171], v208 offset:10880
  ds_read_b64_tr_b16 a[172:173], v208 offset:15360
  ds_read_b64_tr_b16 a[174:175], v208 offset:16000
  ds_read_b64_tr_b16 a[176:177], v208 offset:64
  ds_read_b64_tr_b16 a[178:179], v208 offset:704
  s_add_u32 s100, s76, 128
  s_add_u32 m0, s86, 4096
  s_waitcnt lgkmcnt(6)
  v_mfma_f32_32x32x16_bf16 v[48:63], a[160:163], a[0:3], 0
  ds_read_b64_tr_b16 a[180:181], v208 offset:5184
  ds_read_b64_tr_b16 a[182:183], v208 offset:5824
  buffer_load_dwordx4 v2, s[28:31], s100 offen offset:0 lds
  buffer_load_dwordx4 v3, s[28:31], s100 offen offset:1024 lds
  s_add_u32 s79, s79, 65536
  v_add_u32 v217, s79, v252
  v_add_u32 v218, 4096, v217
  v_add_u32 v219, 8192, v217
  v_add_u32 v220, 12288, v217
  v_lshlrev_b32 v222, 2, v253
  v_lshrrev_b32 v252, 5, v1
  v_lshl_add_u32 v222, v252, 1, v222
  v_bfe_u32 v252, v1, 4, 1
  v_add_u32 v222, v222, v252
  v_cmp_le_u32 vcc, 32, v222
  v_mov_b32 v252, s92
  v_mov_b32 v253, s93
  v_cndmask_b32 v252, v252, v253, vcc
  v_and_b32 v253, 31, v222
  v_lshl_add_u32 v221, v253, 1, v252
  v_lshlrev_b32 v222, 4, v222
  v_add_u32 v222, s75, v222
  v_add_u32 v222, 131072, v222
  v_lshrrev_b32 v252, 3, v1
  s_lshl_b32 s79, s68, 4
  v_add_u32 v252, s79, v252
  v_mul_u32_u24 v252, 3456, v252
  v_bfe_u32 v253, v1, 4, 1
  v_lshlrev_b32 v253, 2, v253
  v_and_b32 v254, 7, v1
  v_xor_b32 v253, v253, v254
  v_lshl_add_u32 v46, v253, 4, v252
  v_add_u32 v47, 26624, v46
  s_lshl_b32 s91, s68, 11
  v_lshrrev_b32 v253, 5, v1
  v_bfe_u32 v252, v1, 2, 2
  v_lshl_add_u32 v252, v253, 3, v252
  v_bfe_u32 v253, v1, 4, 1
  v_and_b32 v254, 3, v1
  v_mfma_f32_32x32x16_bf16 v[48:63], a[164:167], a[4:7], v[48:63]
  ds_read_b64_tr_b16 a[184:185], v208 offset:10304
  ds_read_b64_tr_b16 a[186:187], v208 offset:10944
  buffer_load_dwordx4 v4, s[28:31], s100 offen offset:2048 lds
  v_lshlrev_b32 v254, 3, v254
  v_lshl_add_u32 v254, v253, 5, v254
  v_lshl_add_u32 v254, v252, 7, v254
  v_bfe_u32 v253, v1, 3, 1
  v_lshl_add_u32 v254, v253, 6, v254
  v_add_u32 v212, 32768, v254
  v_xor_b32 v213, 64, v212
  v_subrev_u32 v214, 0x8000, v212
  v_subrev_u32 v215, 0x8000, v213
  s_and_b32 s79, s2, 1
  s_lshl_b32 s79, s79, 3
  s_and_b32 s80, s2, 4
  s_add_u32 s79, s79, s80
  s_lshr_b32 s80, s2, 6
  s_bfe_u32 s81, s2, 65539
  s_xor_b32 s80, s80, s81
  s_add_u32 s4, s79, s80
  s_bfe_u32 s80, s2, 0x30003
  s_mul_i32 s5, s80, 160
  s_mov_b32 s15, s80
  s_bfe_u32 s81, s2, 0x10001
  s_lshl_b32 s8, s81, 2
  s_add_u32 s8, s8, s68
  s_and_b32 s79, s68, 1
  s_lshl_b32 s79, s79, 1
  s_mul_i32 s6, s8, 6
  s_sub_u32 s6, s6, s79
  s_sub_u32 s7, s6, s79
  s_add_u32 s6, s6, 4
  s_sub_u32 s13, s8, s81
  s_add_u32 s13, s13, 48
  s_cmp_eq_u32 s68, 3
  s_cselect_b32 s11, 1073741824, 0
  s_lshl_b32 s79, s4, 1
  s_add_u32 s80, s79, s81
  s_mul_i32 s10, s80, 303104
  s_add_u32 s10, s10, 8388608
  s_lshl_b32 s12, s80, 2
  s_waitcnt lgkmcnt(6)
  v_mfma_f32_32x32x16_bf16 v[48:63], a[168:171], a[8:11], v[48:63]
  ds_read_b64_tr_b16 a[188:189], v208 offset:15424
  ds_read_b64_tr_b16 a[190:191], v208 offset:16064
  buffer_load_dwordx4 v5, s[28:31], s100 offen offset:3072 lds
  s_add_u32 s12, s12, s68
  s_mul_i32 s12, s12, 20480
  s_add_u32 s12, s12, s5
  s_xor_b32 s80, s80, 1
  s_mul_i32 s9, s80, 303104
  s_add_u32 s9, s9, 8388608
  s_add_u32 s79, s6, 20
  s_lshl_b32 s17, s79, 10
  s_add_u32 s79, s7, 20
  s_lshl_b32 s18, s79, 10
  s_add_u32 s79, s13, 20
  s_lshl_b32 s19, s79, 10
  s_or_b32 s19, s19, s11
  s_lshl_b32 s20, s68, 10
  s_mul_i32 s21, s6, 40960
  s_add_u32 s21, s21, s5
  s_mul_i32 s22, s7, 40960
  s_add_u32 s22, s22, s5
  s_mul_i32 s23, s13, 40960
  s_add_u32 s23, s23, s5
  s_or_b32 s23, s23, s11
  s_mul_i32 s24, s68, 40960
  s_add_u32 s24, s24, s5
  v_mul_u32_u24 v255, 6554, v1
  s_mov_b32 s80, 1120
  s_mul_i32 s79, s68, 5632
  s_add_u32 s79, s79, 141312
  v_lshl_add_u32 v254, v1, 5, s79
  v_lshrrev_b32 v253, 16, v255
  v_mad_u32_u24 v180, v253, s80, v37
  v_lshl_add_u32 v202, v253, 4, v254
  v_add_u32 v253, 419456, v255
  v_lshrrev_b32 v253, 16, v253
  v_mad_u32_u24 v181, v253, s80, v37
  v_lshl_add_u32 v203, v253, 4, v254
  v_add_u32 v253, 838912, v255
  v_lshrrev_b32 v253, 16, v253
  v_mad_u32_u24 v182, v253, s80, v37
  s_add_u32 s101, s90, 245760
  s_add_u32 m0, s94, 20480
  v_mfma_f32_32x32x16_bf16 v[48:63], a[172:175], a[12:15], v[48:63]
  ds_read_b64_tr_b16 a[160:161], v210 offset:0
  ds_read_b64_tr_b16 a[162:163], v210 offset:640
  buffer_load_dwordx4 v10, s[32:35], s101 offen offset:0 lds
  v_lshl_add_u32 v204, v253, 4, v254
  v_add_u32 v253, 1258368, v255
  v_lshrrev_b32 v253, 16, v253
  v_mad_u32_u24 v183, v253, s80, v37
  v_add_u32 v253, 1677824, v255
  v_lshrrev_b32 v253, 16, v253
  v_mad_u32_u24 v184, v253, s80, v37
  v_add_u32 v184, 4096, v184
  v_and_b32 v253, 15, v1
  v_mul_u32_u24 v253, 336, v253
  v_and_b32 v254, 48, v1
  v_add3_u32 v198, v253, v254, s79
  s_add_u32 s79, s68, 0
  s_and_b32 s79, s79, 3
  s_mul_i32 s79, s79, 75776
  s_add_u32 s79, s79, s10
  v_add_u32 v185, s79, v37
  s_add_u32 s79, s68, 1
  s_and_b32 s79, s79, 3
  s_mul_i32 s79, s79, 75776
  s_add_u32 s79, s79, s10
  v_add_u32 v186, s79, v37
  s_add_u32 s79, s68, 2
  s_and_b32 s79, s79, 3
  s_mul_i32 s79, s79, 75776
  s_add_u32 s79, s79, s10
  v_add_u32 v187, s79, v37
  s_add_u32 s79, s68, 3
  s_and_b32 s79, s79, 3
  s_mul_i32 s79, s79, 75776
  s_add_u32 s79, s79, s10
  v_add_u32 v188, s79, v37
  v_lshrrev_b32 v252, 5, v1
  v_lshlrev_b32 v252, 4, v252
  v_bfe_u32 v253, v1, 4, 1
  v_lshl_add_u32 v252, v253, 2, v252
  v_bfe_u32 v253, v1, 2, 2
  s_add_u32 m0, s94, 21504
  s_waitcnt lgkmcnt(6)
  v_mfma_f32_32x32x16_bf16 v[64:79], a[176:179], a[0:3], 0
  ds_read_b64_tr_b16 a[164:165], v210 offset:5120
  ds_read_b64_tr_b16 a[166:167], v210 offset:5760
  buffer_load_dwordx4 v11, s[32:35], s101 offen offset:0 lds
  v_add_u32 v252, v252, v253
  v_mul_u32_u24 v252, 160, v252
  v_and_b32 v253, 3, v1
  v_lshl_add_u32 v252, v253, 3, v252
  v_add_u32 v189, s94, v252
  v_add_u32 v190, 0x10000, v189
  v_add_u32 v191, 0x20000, v189
  s_lshr_b32 s79, s69, 3
  s_and_b32 s80, s69, 7
  s_lshl_b32 s80, s80, 3
  s_add_u32 s79, s79, s80
  s_lshl_b32 s79, s79, 7
  v_subrev_u32 v205, s79, v17
  s_lshr_b32 s79, s4, 3
  s_and_b32 s80, s4, 7
  s_lshl_b32 s80, s80, 3
  s_add_u32 s79, s79, s80
  s_lshl_b32 s79, s79, 7
  v_add_u32 v205, s79, v205
  v_and_b32 v33, 0xffffdfff, v205
  v_or_b32 v205, 0x2000, v205
  s_mov_b32 s7, 0
  v_add_u32 v192, s94, v37
  v_add_u32 v193, 0x10000, v192
  v_add_u32 v207, 0x20000, v192
  s_sub_u32 s79, s68, 1
  s_and_b32 s79, s79, 3
  s_mul_i32 s79, s79, 5120
  s_add_u32 s79, s79, 0
  v_add_u32 v194, s79, v37
  s_sub_u32 s79, s68, 2
  s_and_b32 s79, s79, 3
  s_mul_i32 s79, s79, 5120
  s_add_u32 s79, s79, 20480
  v_add_u32 v195, s79, v37
  s_sub_u32 s79, s68, 3
  s_and_b32 s79, s79, 3
  s_mul_i32 s79, s79, 5120
  s_add_u32 m0, s94, 22528
  v_mfma_f32_32x32x16_bf16 v[64:79], a[180:183], a[4:7], v[64:79]
  ds_read_b64_tr_b16 a[168:169], v210 offset:10240
  ds_read_b64_tr_b16 a[170:171], v210 offset:10880
  buffer_load_dwordx4 v12, s[32:35], s101 offen offset:0 lds
  s_add_u32 m0, s94, 23552
  s_nop 0
  buffer_load_dwordx4 v13, s[32:35], s101 offen offset:0 lds
  s_add_u32 s79, s79, 143360
  v_add_u32 v196, s79, v37
  s_xor_b32 s79, s2, 2
  s_lshl_b32 s80, s79, 9
  s_lshl_b32 s81, s68, 7
  s_add_u32 s80, s80, s81
  v_mov_b32 v35, s80
  s_lshl_b32 s16, s2, 2
  s_add_u32 s16, s16, s68
  s_mul_i32 s16, s16, 3072
  s_add_u32 s16, s16, 524288
  v_and_b32 v197, 1073741824, v29
  v_or_b32 v197, v197, v182
  v_lshrrev_b32 v252, 4, v1
  v_lshlrev_b32 v252, 3, v252
  v_add_u32 v199, s5, v252
  v_and_b32 v252, 31, v1
  s_lshl_b32 s79, s68, 5
  v_add_u32 v252, s79, v252
  v_mul_u32_u24 v252, 328, v252
  v_add_u32 v252, 81920, v252
  v_add_u32 v25, 320, v252
  v_lshrrev_b32 v253, 5, v1
  v_lshl_add_u32 v20, v253, 3, v252
  v_bfe_u32 v252, v1, 2, 2
  v_lshl_add_u32 v252, v253, 3, v252
  v_mul_u32_u24 v252, 328, v252
  v_add_u32 v252, 81920, v252
  v_bfe_u32 v253, v1, 4, 1
  v_and_b32 v254, 3, v1
  v_lshl_add_u32 v253, v253, 2, v254
  s_mul_i32 s79, s68, 40
  v_lshl_add_u32 v23, v253, 3, v252
  v_add_u32 v23, s79, v23
  v_add_u32 v22, 160, v23
  v_add_u32 v252, 320, v252
  s_add_u32 m0, s94, 24576
  s_waitcnt lgkmcnt(6)
  v_mfma_f32_32x32x16_bf16 v[64:79], a[184:187], a[8:11], v[64:79]
  ds_read_b64_tr_b16 a[172:173], v210 offset:15360
  ds_read_b64_tr_b16 a[174:175], v210 offset:16000
  buffer_load_dwordx4 v14, s[32:35], s101 offen offset:0 lds
  v_cmp_eq_u32 vcc, 5, v253
  s_nop 1
  v_cndmask_b32 v22, v22, v252, vcc
  v_and_b32 v252, 31, v1
  v_cmp_gt_u32 vcc, 24, v252
  v_lshlrev_b32 v252, 3, v252
  v_and_b32 v253, 192, v29
  v_add_u32 v252, v252, v253
  s_lshl_b32 s79, s70, 2
  s_add_u32 s79, s79, s68
  s_lshl_b32 s79, s79, 4
  s_add_u32 s79, s79, s69
  s_mul_i32 s79, s79, 1280
  s_add_u32 s79, s79, 4194304
  v_add_u32 v252, s79, v252
  v_mov_b32 v24, 1073741824
  v_cndmask_b32 v24, v24, v252, vcc
  s_add_u32 s100, s76, 256
  s_add_u32 m0, s86, 8192
  v_mfma_f32_32x32x16_bf16 v[64:79], a[188:191], a[12:15], v[64:79]
  ds_read_b64_tr_b16 a[176:177], v208 offset:2560
  ds_read_b64_tr_b16 a[178:179], v208 offset:3200
  buffer_load_dwordx4 v2, s[28:31], s100 offen offset:0 lds
  s_waitcnt lgkmcnt(6)
  v_mfma_f32_32x32x16_bf16 v[80:95], a[160:163], a[0:3], 0
  ds_read_b64_tr_b16 a[180:181], v208 offset:7680
  ds_read_b64_tr_b16 a[182:183], v208 offset:8320
  buffer_load_dwordx4 v3, s[28:31], s100 offen offset:1024 lds
  v_mfma_f32_32x32x16_bf16 v[80:95], a[164:167], a[4:7], v[80:95]
  ds_read_b64_tr_b16 a[184:185], v208 offset:12800
  ds_read_b64_tr_b16 a[186:187], v208 offset:13440
  buffer_load_dwordx4 v4, s[28:31], s100 offen offset:2048 lds
  s_waitcnt lgkmcnt(6)
  v_mfma_f32_32x32x16_bf16 v[80:95], a[168:171], a[8:11], v[80:95]
  ds_read_b64_tr_b16 a[188:189], v208 offset:17920
  ds_read_b64_tr_b16 a[190:191], v208 offset:18560
  buffer_load_dwordx4 v5, s[28:31], s100 offen offset:3072 lds
  s_add_u32 s101, s90, 491520
  s_add_u32 m0, s94, 40960
  s_nop 0
  buffer_load_dwordx4 v10, s[32:35], s101 offen offset:0 lds
  s_mov_b32 s87, 0x3f803f80
  s_waitcnt vmcnt(23)
  v_dot2_f32_bf16 v168, v128, s87, 0
  v_dot2_f32_bf16 v169, v128, v128, 0
  v_dot2_f32_bf16 v168, v129, s87, v168
  v_dot2_f32_bf16 v169, v129, v129, v169
  s_waitcnt vmcnt(22)
  v_dot2_f32_bf16 v168, v130, s87, v168
  v_dot2_f32_bf16 v169, v130, v130, v169
  v_dot2_f32_bf16 v168, v131, s87, v168
  v_dot2_f32_bf16 v169, v131, v131, v169
  s_waitcnt vmcnt(21)
  v_dot2_f32_bf16 v168, v132, s87, v168
  v_dot2_f32_bf16 v169, v132, v132, v169
  v_dot2_f32_bf16 v168, v133, s87, v168
  v_dot2_f32_bf16 v169, v133, v133, v169
  s_waitcnt vmcnt(20)
  v_dot2_f32_bf16 v168, v134, s87, v168
  v_dot2_f32_bf16 v169, v134, v134, v169
  v_dot2_f32_bf16 v168, v135, s87, v168
  v_dot2_f32_bf16 v169, v135, v135, v169
  s_waitcnt vmcnt(19)
  v_dot2_f32_bf16 v168, v136, s87, v168
  v_dot2_f32_bf16 v169, v136, v136, v169
  v_dot2_f32_bf16 v168, v137, s87, v168
  v_dot2_f32_bf16 v169, v137, v137, v169
  v_lshlrev_b32 v172, 6, v172
  v_add_u32 v172, 6291456, v172
  v_and_b32 v170, 7, v1
  v_lshl_add_u32 v172, v170, 3, v172
  v_bfe_u32 v170, v1, 3, 2
  v_min_u32 v170, 1, v170
  v_lshl_add_u32 v172, v170, 30, v172
  s_waitcnt vmcnt(18)
  v_dot2_f32_bf16 v158, v138, s88, 0
  v_dot2_f32_bf16 v159, v138, s89, 0
  v_dot2_f32_bf16 v160, v139, s88, 0
  v_dot2_f32_bf16 v161, v139, s89, 0
  v_dot2_f32_bf16 v162, v140, s88, 0
  v_dot2_f32_bf16 v163, v140, s89, 0
  v_dot2_f32_bf16 v164, v141, s88, 0
  s_add_u32 m0, s94, 41984
  v_mfma_f32_32x32x16_bf16 v[80:95], a[172:175], a[12:15], v[80:95]
  ds_read_b64_tr_b16 a[160:161], v208 offset:2624
  ds_read_b64_tr_b16 a[162:163], v208 offset:3264
  buffer_load_dwordx4 v11, s[32:35], s101 offen offset:0 lds
  v_dot2_f32_bf16 v165, v141, s89, 0
  s_waitcnt vmcnt(18)
  v_dot2_f32_bf16 v158, v142, s88, v158
  v_dot2_f32_bf16 v159, v142, s89, v159
  v_dot2_f32_bf16 v160, v143, s88, v160
  v_dot2_f32_bf16 v161, v143, s89, v161
  v_dot2_f32_bf16 v162, v144, s88, v162
  v_dot2_f32_bf16 v163, v144, s89, v163
  v_dot2_f32_bf16 v164, v145, s88, v164
  v_dot2_f32_bf16 v165, v145, s89, v165
  s_waitcnt vmcnt(17)
  v_dot2_f32_bf16 v158, v146, s88, v158
  v_dot2_f32_bf16 v159, v146, s89, v159
  v_dot2_f32_bf16 v160, v147, s88, v160
  v_dot2_f32_bf16 v161, v147, s89, v161
  v_dot2_f32_bf16 v162, v148, s88, v162
  v_dot2_f32_bf16 v163, v148, s89, v163
  v_dot2_f32_bf16 v164, v149, s88, v164
  v_dot2_f32_bf16 v165, v149, s89, v165
  s_waitcnt vmcnt(16)
  v_dot2_f32_bf16 v158, v150, s88, v158
  v_dot2_f32_bf16 v159, v150, s89, v159
  v_dot2_f32_bf16 v160, v151, s88, v160
  v_dot2_f32_bf16 v161, v151, s89, v161
  v_dot2_f32_bf16 v162, v152, s88, v162
  v_dot2_f32_bf16 v163, v152, s89, v163
  v_dot2_f32_bf16 v164, v153, s88, v164
  v_dot2_f32_bf16 v165, v153, s89, v165
  s_waitcnt vmcnt(15)
  v_dot2_f32_bf16 v158, v154, s88, v158
  v_dot2_f32_bf16 v159, v154, s89, v159
  v_dot2_f32_bf16 v160, v155, s88, v160
  v_dot2_f32_bf16 v161, v155, s89, v161
  v_dot2_f32_bf16 v162, v156, s88, v162
  v_dot2_f32_bf16 v163, v156, s89, v163
  v_dot2_f32_bf16 v164, v157, s88, v164
  v_dot2_f32_bf16 v165, v157, s89, v165
  v_add_f32_dpp v168, v168, v168 row_ror:8 row_mask:0xf bank_mask:0xf
  v_and_b32 v174, 7, v1
  v_add_f32_dpp v169, v169, v169 row_ror:8 row_mask:0xf bank_mask:0xf
  v_lshlrev_b32 v174, 5, v174
  v_add_f32_dpp v168, v168, v168 row_ror:4 row_mask:0xf bank_mask:0xf
  s_add_u32 m0, s94, 43008
  s_waitcnt lgkmcnt(6)
  v_mfma_f32_32x32x16_bf16 v[96:111], a[176:179], a[0:3], 0
  ds_read_b64_tr_b16 a[164:165], v208 offset:7744
  ds_read_b64_tr_b16 a[166:167], v208 offset:8384
  buffer_load_dwordx4 v12, s[32:35], s101 offen offset:0 lds
  v_lshrrev_b32 v175, 5, v1
  v_add_f32_dpp v169, v169, v169 row_ror:4 row_mask:0xf bank_mask:0xf
  v_lshl_add_u32 v174, v175, 4, v174
  v_add_f32_dpp v168, v168, v168 row_ror:2 row_mask:0xf bank_mask:0xf
  v_permlane32_swap_b32 v158, v162
  v_add_f32_dpp v169, v169, v169 row_ror:2 row_mask:0xf bank_mask:0xf
  v_permlane32_swap_b32 v159, v163
  v_add_f32_dpp v168, v168, v168 row_ror:1 row_mask:0xf bank_mask:0xf
  v_permlane32_swap_b32 v160, v164
  v_add_f32_dpp v169, v169, v169 row_ror:1 row_mask:0xf bank_mask:0xf
  v_permlane32_swap_b32 v161, v165
  v_mov_b32 v170, v168
  v_add_f32 v158, v158, v162
  v_mov_b32 v171, v169
  v_add_f32 v159, v159, v163
  v_permlane16_swap_b32 v168, v170
  v_add_f32 v160, v160, v164
  v_permlane16_swap_b32 v169, v171
  v_add_f32 v161, v161, v165
  v_add_f32 v168, v168, v170
  v_bfe_u32 v175, v1, 4, 1
  v_add_f32 v169, v169, v171
  v_lshl_add_u32 v174, v175, 3, v174
  v_mul_f32 v168, 986500301, v168
  v_permlane16_swap_b32 v158, v160
  v_mul_f32 v169, 986500301, v169
  v_permlane16_swap_b32 v159, v161
  v_fma_f32 v169, -v168, v168, v169
  v_add_f32 v158, v158, v160
  v_max_f32 v169, 0, v169
  v_add_f32 v159, v159, v161
  v_bfe_u32 v175, v1, 3, 1
  v_lshl_add_u32 v174, v175, 30, v174
  v_add_f32_dpp v158, v158, v158 row_ror:8 row_mask:0xf bank_mask:0xf
  v_add_f32_dpp v159, v159, v159 row_ror:8 row_mask:0xf bank_mask:0xf
  s_lshl_b32 s78, s71, 4
  s_add_u32 s78, s78, s69
  s_lshl_b32 s78, s78, 2
  s_add_u32 m0, s94, 44032
  v_mfma_f32_32x32x16_bf16 v[96:111], a[180:183], a[4:7], v[96:111]
  ds_read_b64_tr_b16 a[168:169], v208 offset:12864
  ds_read_b64_tr_b16 a[170:171], v208 offset:13504
  buffer_load_dwordx4 v13, s[32:35], s101 offen offset:0 lds
  s_add_u32 s78, s78, s68
  s_lshl_b32 s78, s78, 8
  s_add_u32 s78, s78, 65536
  v_add_u32 v174, s78, v174
  s_add_u32 m0, s94, 45056
  s_waitcnt lgkmcnt(6)
  v_mfma_f32_32x32x16_bf16 v[96:111], a[184:187], a[8:11], v[96:111]
  ds_read_b64_tr_b16 a[172:173], v208 offset:17984
  ds_read_b64_tr_b16 a[174:175], v208 offset:18624
  buffer_load_dwordx4 v14, s[32:35], s101 offen offset:0 lds
  buffer_load_dword v45, v45, s[64:67], 0 offen sc1
  buffer_store_dwordx2 v[168:169], v172, s[48:51], 0 offen sc1
  buffer_store_dwordx2 v[158:159], v174, s[48:51], 0 offen sc1
  s_waitcnt vmcnt(12)
  s_barrier
  v_mfma_f32_32x32x16_bf16 v[96:111], a[188:191], a[12:15], v[96:111]
  ds_read_b64_tr_b16 a[176:177], v208 offset:20480
  ds_read_b64_tr_b16 a[178:179], v208 offset:21120
  ds_read_b128 a[16:19], v6 offset:4096
  s_add_u32 s100, s76, 384
  s_add_u32 m0, s86, 0
  s_waitcnt lgkmcnt(7)
  v_mfma_f32_32x32x16_bf16 v[112:127], a[160:163], a[0:3], 0
  ds_read_b64_tr_b16 a[180:181], v208 offset:25600
  ds_read_b64_tr_b16 a[182:183], v208 offset:26240
  ds_read_b128 a[20:23], v7 offset:4096
  buffer_load_dwordx4 v2, s[28:31], s100 offen offset:0 lds
  v_mfma_f32_32x32x16_bf16 v[112:127], a[164:167], a[4:7], v[112:127]
  ds_read_b64_tr_b16 a[184:185], v208 offset:30720
  ds_read_b64_tr_b16 a[186:187], v208 offset:31360
  ds_read_b128 a[24:27], v8 offset:4096
  s_waitcnt lgkmcnt(9)
  v_mfma_f32_32x32x16_bf16 v[112:127], a[168:171], a[8:11], v[112:127]
  ds_read_b64_tr_b16 a[188:189], v209 offset:3072
  ds_read_b64_tr_b16 a[190:191], v209 offset:3712
  ds_read_b128 a[28:31], v9 offset:4096
  buffer_load_dwordx4 v3, s[28:31], s100 offen offset:1024 lds
  v_mfma_f32_32x32x16_bf16 v[112:127], a[172:175], a[12:15], v[112:127]
  ds_read_b64_tr_b16 a[160:161], v208 offset:20544
  ds_read_b64_tr_b16 a[162:163], v208 offset:21184
  s_waitcnt lgkmcnt(9)
  v_mfma_f32_32x32x16_bf16 v[48:63], a[176:179], a[16:19], v[48:63]
  ds_read_b64_tr_b16 a[164:165], v208 offset:25664
  ds_read_b64_tr_b16 a[166:167], v208 offset:26304
  buffer_load_dwordx4 v4, s[28:31], s100 offen offset:2048 lds
  s_waitcnt lgkmcnt(10)
  v_mfma_f32_32x32x16_bf16 v[48:63], a[180:183], a[20:23], v[48:63]
  ds_read_b64_tr_b16 a[168:169], v208 offset:30784
  ds_read_b64_tr_b16 a[170:171], v208 offset:31424
  s_waitcnt lgkmcnt(7)
  v_mfma_f32_32x32x16_bf16 v[48:63], a[184:187], a[24:27], v[48:63]
  ds_read_b64_tr_b16 a[172:173], v209 offset:3136
  ds_read_b64_tr_b16 a[174:175], v209 offset:3776
  buffer_load_dwordx4 v5, s[28:31], s100 offen offset:3072 lds
  s_waitcnt lgkmcnt(8)
  v_mfma_f32_32x32x16_bf16 v[48:63], a[188:191], a[28:31], v[48:63]
  ds_read_b64_tr_b16 a[176:177], v210 offset:20480
  ds_read_b64_tr_b16 a[178:179], v210 offset:21120
  s_add_u32 s101, s90, 737280
  s_add_u32 m0, s94, 61440
  s_waitcnt lgkmcnt(6)
  v_mfma_f32_32x32x16_bf16 v[64:79], a[160:163], a[16:19], v[64:79]
  ds_read_b64_tr_b16 a[180:181], v210 offset:25600
  ds_read_b64_tr_b16 a[182:183], v210 offset:26240
  buffer_load_dwordx4 v10, s[32:35], s101 offen offset:0 lds
  v_mfma_f32_32x32x16_bf16 v[64:79], a[164:167], a[20:23], v[64:79]
  ds_read_b64_tr_b16 a[184:185], v210 offset:30720
  ds_read_b64_tr_b16 a[186:187], v210 offset:31360
  s_add_u32 m0, s94, 62464
  s_waitcnt lgkmcnt(6)
  v_mfma_f32_32x32x16_bf16 v[64:79], a[168:171], a[24:27], v[64:79]
  ds_read_b64_tr_b16 a[188:189], v211 offset:3072
  ds_read_b64_tr_b16 a[190:191], v211 offset:3712
  buffer_load_dwordx4 v11, s[32:35], s101 offen offset:0 lds
  v_mfma_f32_32x32x16_bf16 v[64:79], a[172:175], a[28:31], v[64:79]
  ds_read_b64_tr_b16 a[160:161], v208 offset:23040
  ds_read_b64_tr_b16 a[162:163], v208 offset:23680
  s_add_u32 m0, s94, 63488
  s_waitcnt lgkmcnt(6)
  v_mfma_f32_32x32x16_bf16 v[80:95], a[176:179], a[16:19], v[80:95]
  ds_read_b64_tr_b16 a[164:165], v208 offset:28160
  ds_read_b64_tr_b16 a[166:167], v208 offset:28800
  buffer_load_dwordx4 v12, s[32:35], s101 offen offset:0 lds
  v_mfma_f32_32x32x16_bf16 v[80:95], a[180:183], a[20:23], v[80:95]
  ds_read_b64_tr_b16 a[168:169], v209 offset:512
  ds_read_b64_tr_b16 a[170:171], v209 offset:1152
  s_add_u32 m0, s94, 64512
  s_waitcnt lgkmcnt(6)
  v_mfma_f32_32x32x16_bf16 v[80:95], a[184:187], a[24:27], v[80:95]
  ds_read_b64_tr_b16 a[172:173], v209 offset:5632
  ds_read_b64_tr_b16 a[174:175], v209 offset:6272
  buffer_load_dwordx4 v13, s[32:35], s101 offen offset:0 lds
  v_mfma_f32_32x32x16_bf16 v[80:95], a[188:191], a[28:31], v[80:95]
  ds_read_b64_tr_b16 a[176:177], v208 offset:23104
  ds_read_b64_tr_b16 a[178:179], v208 offset:23744
  s_add_u32 m0, s94, 65536
  s_waitcnt lgkmcnt(6)
  v_mfma_f32_32x32x16_bf16 v[96:111], a[160:163], a[16:19], v[96:111]
  ds_read_b64_tr_b16 a[180:181], v208 offset:28224
  ds_read_b64_tr_b16 a[182:183], v208 offset:28864
  buffer_load_dwordx4 v14, s[32:35], s101 offen offset:0 lds
  s_waitcnt vmcnt(11)
  v_readfirstlane_b32 s74, v45
  s_nop 0
  s_cmp_eq_u32 s74, 0
  s_cbranch_scc1 L_nslow6
L_nback7:
  s_waitcnt vmcnt(9)
  s_mov_b64 exec, 1
  ds_add_rtn_u32 v26, v200, v201 offset:4
  s_mov_b64 exec, -1
  s_waitcnt lgkmcnt(0)
  v_readfirstlane_b32 s82, v26
  s_nop 0
  s_cmp_lg_u32 s82, 3
  s_cbranch_scc1 L_sig9
  s_add_u32 s82, s74, 1
  v_mov_b32 v26, s82
  s_mov_b32 s82, 5275648
  buffer_store_dword v26, v206, s[48:51], s82 offen sc1
L_sig9:
  v_mfma_f32_32x32x16_bf16 v[96:111], a[164:167], a[20:23], v[96:111]
  ds_read_b64_tr_b16 a[184:185], v209 offset:576
  ds_read_b64_tr_b16 a[186:187], v209 offset:1216
  v_mfma_f32_32x32x16_bf16 v[96:111], a[168:171], a[24:27], v[96:111]
  ds_read_b64_tr_b16 a[188:189], v209 offset:5696
  ds_read_b64_tr_b16 a[190:191], v209 offset:6336
  s_barrier
  v_mfma_f32_32x32x16_bf16 v[96:111], a[172:175], a[28:31], v[96:111]
  ds_read_b64_tr_b16 a[160:161], v209 offset:8192
  ds_read_b64_tr_b16 a[162:163], v209 offset:8832
  ds_read_b128 a[32:35], v6 offset:8192
  s_add_u32 s100, s76, 512
  s_add_u32 m0, s86, 4096
  v_mfma_f32_32x32x16_bf16 v[112:127], a[176:179], a[16:19], v[112:127]
  ds_read_b64_tr_b16 a[164:165], v209 offset:13312
  ds_read_b64_tr_b16 a[166:167], v209 offset:13952
  ds_read_b128 a[36:39], v7 offset:8192
  buffer_load_dwordx4 v2, s[28:31], s100 offen offset:0 lds
  v_mfma_f32_32x32x16_bf16 v[112:127], a[180:183], a[20:23], v[112:127]
  ds_read_b64_tr_b16 a[168:169], v209 offset:18432
  ds_read_b64_tr_b16 a[170:171], v209 offset:19072
  ds_read_b128 a[40:43], v8 offset:8192
  buffer_load_dwordx4 v3, s[28:31], s100 offen offset:1024 lds
  s_waitcnt lgkmcnt(9)
  v_mfma_f32_32x32x16_bf16 v[112:127], a[184:187], a[24:27], v[112:127]
  ds_read_b64_tr_b16 a[172:173], v209 offset:23552
  ds_read_b64_tr_b16 a[174:175], v209 offset:24192
  ds_read_b128 a[44:47], v9 offset:8192
  v_mfma_f32_32x32x16_bf16 v[112:127], a[188:191], a[28:31], v[112:127]
  ds_read_b64_tr_b16 a[176:177], v209 offset:8256
  ds_read_b64_tr_b16 a[178:179], v209 offset:8896
  buffer_load_dwordx4 v4, s[28:31], s100 offen offset:2048 lds
  s_waitcnt lgkmcnt(9)
  v_mfma_f32_32x32x16_bf16 v[48:63], a[160:163], a[32:35], v[48:63]
  ds_read_b64_tr_b16 a[180:181], v209 offset:13376
  ds_read_b64_tr_b16 a[182:183], v209 offset:14016
  s_waitcnt lgkmcnt(10)
  v_mfma_f32_32x32x16_bf16 v[48:63], a[164:167], a[36:39], v[48:63]
  ds_read_b64_tr_b16 a[184:185], v209 offset:18496
  ds_read_b64_tr_b16 a[186:187], v209 offset:19136
  buffer_load_dwordx4 v5, s[28:31], s100 offen offset:3072 lds
  s_add_u32 s101, s90, 983040
  s_add_u32 m0, s94, 0
  s_waitcnt lgkmcnt(7)
  v_mfma_f32_32x32x16_bf16 v[48:63], a[168:171], a[40:43], v[48:63]
  ds_read_b64_tr_b16 a[188:189], v209 offset:23616
  ds_read_b64_tr_b16 a[190:191], v209 offset:24256
  buffer_load_dwordx4 v10, s[32:35], s101 offen offset:0 lds
  s_waitcnt lgkmcnt(8)
  v_mfma_f32_32x32x16_bf16 v[48:63], a[172:175], a[44:47], v[48:63]
  ds_read_b64_tr_b16 a[160:161], v211 offset:8192
  ds_read_b64_tr_b16 a[162:163], v211 offset:8832
  s_add_u32 m0, s94, 1024
  s_waitcnt lgkmcnt(6)
  v_mfma_f32_32x32x16_bf16 v[64:79], a[176:179], a[32:35], v[64:79]
  ds_read_b64_tr_b16 a[164:165], v211 offset:13312
  ds_read_b64_tr_b16 a[166:167], v211 offset:13952
  buffer_load_dwordx4 v11, s[32:35], s101 offen offset:0 lds
  v_mfma_f32_32x32x16_bf16 v[64:79], a[180:183], a[36:39], v[64:79]
  ds_read_b64_tr_b16 a[168:169], v211 offset:18432
  ds_read_b64_tr_b16 a[170:171], v211 offset:19072
  s_add_u32 m0, s94, 2048
  s_waitcnt lgkmcnt(6)
  v_mfma_f32_32x32x16_bf16 v[64:79], a[184:187], a[40:43], v[64:79]
  ds_read_b64_tr_b16 a[172:173], v211 offset:23552
  ds_read_b64_tr_b16 a[174:175], v211 offset:24192
  buffer_load_dwordx4 v12, s[32:35], s101 offen offset:0 lds
  v_mfma_f32_32x32x16_bf16 v[64:79], a[188:191], a[44:47], v[64:79]
  ds_read_b64_tr_b16 a[176:177], v209 offset:10752
  ds_read_b64_tr_b16 a[178:179], v209 offset:11392
  s_add_u32 m0, s94, 3072
  s_waitcnt lgkmcnt(6)
  v_mfma_f32_32x32x16_bf16 v[80:95], a[160:163], a[32:35], v[80:95]
  ds_read_b64_tr_b16 a[180:181], v209 offset:15872
  ds_read_b64_tr_b16 a[182:183], v209 offset:16512
  buffer_load_dwordx4 v13, s[32:35], s101 offen offset:0 lds
  s_add_u32 m0, s94, 4096
  v_mfma_f32_32x32x16_bf16 v[80:95], a[164:167], a[36:39], v[80:95]
  ds_read_b64_tr_b16 a[184:185], v209 offset:20992
  ds_read_b64_tr_b16 a[186:187], v209 offset:21632
  buffer_load_dwordx4 v14, s[32:35], s101 offen offset:0 lds
  s_waitcnt lgkmcnt(6)
  v_mfma_f32_32x32x16_bf16 v[80:95], a[168:171], a[40:43], v[80:95]
  ds_read_b64_tr_b16 a[188:189], v209 offset:26112
  ds_read_b64_tr_b16 a[190:191], v209 offset:26752
  v_mfma_f32_32x32x16_bf16 v[80:95], a[172:175], a[44:47], v[80:95]
  ds_read_b64_tr_b16 a[160:161], v209 offset:10816
  ds_read_b64_tr_b16 a[162:163], v209 offset:11456
  s_mov_b32 exec_hi, 0
  s_mov_b32 exec_lo, 131071
  buffer_load_dword v39, v179, s[44:47], s96 offen
  s_mov_b64 exec, -1
  s_waitcnt lgkmcnt(6)
  v_mfma_f32_32x32x16_bf16 v[96:111], a[176:179], a[32:35], v[96:111]
  ds_read_b64_tr_b16 a[164:165], v209 offset:15936
  ds_read_b64_tr_b16 a[166:167], v209 offset:16576
  v_mfma_f32_32x32x16_bf16 v[96:111], a[180:183], a[36:39], v[96:111]
  ds_read_b64_tr_b16 a[168:169], v209 offset:21056
  ds_read_b64_tr_b16 a[170:171], v209 offset:21696
  s_mov_b32 exec_hi, 0
  s_mov_b32 exec_lo, 127
  buffer_load_dword v39, v179, s[40:43], s97 offen
  s_mov_b64 exec, -1
  s_waitcnt lgkmcnt(6)
  v_mfma_f32_32x32x16_bf16 v[96:111], a[184:187], a[40:43], v[96:111]
  ds_read_b64_tr_b16 a[172:173], v209 offset:26176
  ds_read_b64_tr_b16 a[174:175], v209 offset:26816
  buffer_load_ushort v178, v221, s[56:59], 0 offen
  s_waitcnt vmcnt(12)
  s_barrier
  v_mfma_f32_32x32x16_bf16 v[96:111], a[188:191], a[44:47], v[96:111]
  ds_read_b64_tr_b16 a[176:177], v209 offset:28672
  ds_read_b64_tr_b16 a[178:179], v209 offset:29312
  ds_read_b128 a[48:51], v6 offset:0
  buffer_load_dwordx2 v[226:227], v199, s[60:63], 0 offen offset:0
  s_add_u32 s100, s76, 640
  s_add_u32 m0, s86, 8192
  s_waitcnt lgkmcnt(7)
  v_mfma_f32_32x32x16_bf16 v[112:127], a[160:163], a[32:35], v[112:127]
  ds_read_b64_tr_b16 a[180:181], v209 offset:33792
  ds_read_b64_tr_b16 a[182:183], v209 offset:34432
  ds_read_b128 a[52:55], v7 offset:0
  buffer_load_dwordx4 v2, s[28:31], s100 offen offset:0 lds
  buffer_load_dwordx2 v[230:231], v199, s[60:63], 0 offen offset:32
  v_mfma_f32_32x32x16_bf16 v[112:127], a[164:167], a[36:39], v[112:127]
  ds_read_b64_tr_b16 a[184:185], v209 offset:38912
  ds_read_b64_tr_b16 a[186:187], v209 offset:39552
  ds_read_b128 a[56:59], v8 offset:0
  buffer_load_dwordx2 v[234:235], v199, s[60:63], 0 offen offset:64
  s_waitcnt lgkmcnt(9)
  v_mfma_f32_32x32x16_bf16 v[112:127], a[168:171], a[40:43], v[112:127]
  ds_read_b64_tr_b16 a[188:189], v209 offset:44032
  ds_read_b64_tr_b16 a[190:191], v209 offset:44672
  ds_read_b128 a[60:63], v9 offset:0
  buffer_load_dwordx4 v3, s[28:31], s100 offen offset:1024 lds
  buffer_load_dwordx2 v[238:239], v199, s[60:63], 0 offen offset:96
  v_mfma_f32_32x32x16_bf16 v[112:127], a[172:175], a[44:47], v[112:127]
  ds_read_b64_tr_b16 a[160:161], v209 offset:28736
  ds_read_b64_tr_b16 a[162:163], v209 offset:29376
  buffer_load_dwordx2 v[242:243], v199, s[60:63], 0 offen offset:128
  s_waitcnt lgkmcnt(9)
  v_mfma_f32_32x32x16_bf16 v[48:63], a[176:179], a[48:51], v[48:63]
  ds_read_b64_tr_b16 a[164:165], v209 offset:33856
  ds_read_b64_tr_b16 a[166:167], v209 offset:34496
  buffer_load_dwordx4 v4, s[28:31], s100 offen offset:2048 lds
  s_waitcnt lgkmcnt(10)
  v_mfma_f32_32x32x16_bf16 v[48:63], a[180:183], a[52:55], v[48:63]
  ds_read_b64_tr_b16 a[168:169], v209 offset:38976
  ds_read_b64_tr_b16 a[170:171], v209 offset:39616
  s_waitcnt lgkmcnt(7)
  v_mfma_f32_32x32x16_bf16 v[48:63], a[184:187], a[56:59], v[48:63]
  ds_read_b64_tr_b16 a[172:173], v209 offset:44096
  ds_read_b64_tr_b16 a[174:175], v209 offset:44736
  buffer_load_dwordx4 v5, s[28:31], s100 offen offset:3072 lds
  s_waitcnt lgkmcnt(8)
  v_mfma_f32_32x32x16_bf16 v[48:63], a[188:191], a[60:63], v[48:63]
  ds_read_b64_tr_b16 a[176:177], v211 offset:28672
  ds_read_b64_tr_b16 a[178:179], v211 offset:29312
  s_add_u32 s101, s90, 1228800
  s_add_u32 m0, s94, 20480
  s_waitcnt lgkmcnt(6)
  v_mfma_f32_32x32x16_bf16 v[64:79], a[160:163], a[48:51], v[64:79]
  ds_read_b64_tr_b16 a[180:181], v211 offset:33792
  ds_read_b64_tr_b16 a[182:183], v211 offset:34432
  buffer_load_dwordx4 v10, s[32:35], s101 offen offset:0 lds
  v_mfma_f32_32x32x16_bf16 v[64:79], a[164:167], a[52:55], v[64:79]
  ds_read_b64_tr_b16 a[184:185], v211 offset:38912
  ds_read_b64_tr_b16 a[186:187], v211 offset:39552
  s_add_u32 m0, s94, 21504
  s_waitcnt lgkmcnt(6)
  v_mfma_f32_32x32x16_bf16 v[64:79], a[168:171], a[56:59], v[64:79]
  ds_read_b64_tr_b16 a[188:189], v211 offset:44032
  ds_read_b64_tr_b16 a[190:191], v211 offset:44672
  buffer_load_dwordx4 v11, s[32:35], s101 offen offset:0 lds
  v_mfma_f32_32x32x16_bf16 v[64:79], a[172:175], a[60:63], v[64:79]
  ds_read_b64_tr_b16 a[160:161], v209 offset:31232
  ds_read_b64_tr_b16 a[162:163], v209 offset:31872
  s_add_u32 m0, s94, 22528
  s_waitcnt lgkmcnt(6)
  v_mfma_f32_32x32x16_bf16 v[80:95], a[176:179], a[48:51], v[80:95]
  ds_read_b64_tr_b16 a[164:165], v209 offset:36352
  ds_read_b64_tr_b16 a[166:167], v209 offset:36992
  buffer_load_dwordx4 v12, s[32:35], s101 offen offset:0 lds
  v_mfma_f32_32x32x16_bf16 v[80:95], a[180:183], a[52:55], v[80:95]
  ds_read_b64_tr_b16 a[168:169], v209 offset:41472
  ds_read_b64_tr_b16 a[170:171], v209 offset:42112
  s_add_u32 m0, s94, 23552
  s_waitcnt lgkmcnt(6)
  v_mfma_f32_32x32x16_bf16 v[80:95], a[184:187], a[56:59], v[80:95]
  ds_read_b64_tr_b16 a[172:173], v209 offset:46592
  ds_read_b64_tr_b16 a[174:175], v209 offset:47232
  buffer_load_dwordx4 v13, s[32:35], s101 offen offset:0 lds
  v_mfma_f32_32x32x16_bf16 v[80:95], a[188:191], a[60:63], v[80:95]
  ds_read_b64_tr_b16 a[176:177], v209 offset:31296
  ds_read_b64_tr_b16 a[178:179], v209 offset:31936
  s_add_u32 m0, s94, 24576
  s_waitcnt lgkmcnt(6)
  v_mfma_f32_32x32x16_bf16 v[96:111], a[160:163], a[48:51], v[96:111]
  ds_read_b64_tr_b16 a[180:181], v209 offset:36416
  ds_read_b64_tr_b16 a[182:183], v209 offset:37056
  buffer_load_dwordx4 v14, s[32:35], s101 offen offset:0 lds
  v_mfma_f32_32x32x16_bf16 v[96:111], a[164:167], a[52:55], v[96:111]
  ds_read_b64_tr_b16 a[184:185], v209 offset:41536
  ds_read_b64_tr_b16 a[186:187], v209 offset:42176
  s_waitcnt lgkmcnt(6)
  v_mfma_f32_32x32x16_bf16 v[96:111], a[168:171], a[56:59], v[96:111]
  ds_read_b64_tr_b16 a[188:189], v209 offset:46656
  ds_read_b64_tr_b16 a[190:191], v209 offset:47296
  s_waitcnt vmcnt(17)
  s_barrier
  v_mfma_f32_32x32x16_bf16 v[96:111], a[172:175], a[60:63], v[96:111]
  ds_read_b64_tr_b16 a[160:161], v208 offset:0
  ds_read_b64_tr_b16 a[162:163], v208 offset:640
  ds_read_b128 a[64:67], v6 offset:4096
  s_add_u32 s100, s76, 768
  s_add_u32 m0, s86, 0
  s_waitcnt lgkmcnt(7)
  v_mfma_f32_32x32x16_bf16 v[112:127], a[176:179], a[48:51], v[112:127]
  ds_read_b64_tr_b16 a[164:165], v208 offset:5120
  ds_read_b64_tr_b16 a[166:167], v208 offset:5760
  ds_read_b128 a[68:71], v7 offset:4096
  buffer_load_dwordx4 v2, s[28:31], s100 offen offset:0 lds
  v_mfma_f32_32x32x16_bf16 v[112:127], a[180:183], a[52:55], v[112:127]
  ds_read_b64_tr_b16 a[168:169], v208 offset:10240
  ds_read_b64_tr_b16 a[170:171], v208 offset:10880
  ds_read_b128 a[72:75], v8 offset:4096
  s_waitcnt lgkmcnt(9)
  v_mfma_f32_32x32x16_bf16 v[112:127], a[184:187], a[56:59], v[112:127]
  ds_read_b64_tr_b16 a[172:173], v208 offset:15360
  ds_read_b64_tr_b16 a[174:175], v208 offset:16000
  ds_read_b128 a[76:79], v9 offset:4096
  buffer_load_dwordx4 v3, s[28:31], s100 offen offset:1024 lds
  v_mfma_f32_32x32x16_bf16 v[112:127], a[188:191], a[60:63], v[112:127]
  ds_read_b64_tr_b16 a[176:177], v208 offset:64
  ds_read_b64_tr_b16 a[178:179], v208 offset:704
  s_waitcnt lgkmcnt(9)
  v_mfma_f32_32x32x16_bf16 v[48:63], a[160:163], a[64:67], v[48:63]
  ds_read_b64_tr_b16 a[180:181], v208 offset:5184
  ds_read_b64_tr_b16 a[182:183], v208 offset:5824
  buffer_load_dwordx4 v4, s[28:31], s100 offen offset:2048 lds
  s_waitcnt lgkmcnt(10)
  v_mfma_f32_32x32x16_bf16 v[48:63], a[164:167], a[68:71], v[48:63]
  ds_read_b64_tr_b16 a[184:185], v208 offset:10304
  ds_read_b64_tr_b16 a[186:187], v208 offset:10944
  s_waitcnt lgkmcnt(7)
  v_mfma_f32_32x32x16_bf16 v[48:63], a[168:171], a[72:75], v[48:63]
  ds_read_b64_tr_b16 a[188:189], v208 offset:15424
  ds_read_b64_tr_b16 a[190:191], v208 offset:16064
  buffer_load_dwordx4 v5, s[28:31], s100 offen offset:3072 lds
  s_waitcnt lgkmcnt(8)
  v_mfma_f32_32x32x16_bf16 v[48:63], a[172:175], a[76:79], v[48:63]
  ds_read_b64_tr_b16 a[160:161], v210 offset:0
  ds_read_b64_tr_b16 a[162:163], v210 offset:640
  s_add_u32 s101, s90, 1474560
  s_add_u32 m0, s94, 40960
  s_waitcnt lgkmcnt(6)
  v_mfma_f32_32x32x16_bf16 v[64:79], a[176:179], a[64:67], v[64:79]
  ds_read_b64_tr_b16 a[164:165], v210 offset:5120
  ds_read_b64_tr_b16 a[166:167], v210 offset:5760
  buffer_load_dwordx4 v10, s[32:35], s101 offen offset:0 lds
  v_mfma_f32_32x32x16_bf16 v[64:79], a[180:183], a[68:71], v[64:79]
  ds_read_b64_tr_b16 a[168:169], v210 offset:10240
  ds_read_b64_tr_b16 a[170:171], v210 offset:10880
  s_add_u32 m0, s94, 41984
  s_waitcnt lgkmcnt(6)
  v_mfma_f32_32x32x16_bf16 v[64:79], a[184:187], a[72:75], v[64:79]
  ds_read_b64_tr_b16 a[172:173], v210 offset:15360
  ds_read_b64_tr_b16 a[174:175], v210 offset:16000
  buffer_load_dwordx4 v11, s[32:35], s101 offen offset:0 lds
  v_mfma_f32_32x32x16_bf16 v[64:79], a[188:191], a[76:79], v[64:79]
  ds_read_b64_tr_b16 a[176:177], v208 offset:2560
  ds_read_b64_tr_b16 a[178:179], v208 offset:3200
  s_add_u32 m0, s94, 43008
  s_waitcnt lgkmcnt(6)
  v_mfma_f32_32x32x16_bf16 v[80:95], a[160:163], a[64:67], v[80:95]
  ds_read_b64_tr_b16 a[180:181], v208 offset:7680
  ds_read_b64_tr_b16 a[182:183], v208 offset:8320
  buffer_load_dwordx4 v12, s[32:35], s101 offen offset:0 lds
  v_mfma_f32_32x32x16_bf16 v[80:95], a[164:167], a[68:71], v[80:95]
  ds_read_b64_tr_b16 a[184:185], v208 offset:12800
  ds_read_b64_tr_b16 a[186:187], v208 offset:13440
  s_add_u32 m0, s94, 44032
  s_waitcnt lgkmcnt(6)
  v_mfma_f32_32x32x16_bf16 v[80:95], a[168:171], a[72:75], v[80:95]
  ds_read_b64_tr_b16 a[188:189], v208 offset:17920
  ds_read_b64_tr_b16 a[190:191], v208 offset:18560
  buffer_load_dwordx4 v13, s[32:35], s101 offen offset:0 lds
  v_mfma_f32_32x32x16_bf16 v[80:95], a[172:175], a[76:79], v[80:95]
  ds_read_b64_tr_b16 a[160:161], v208 offset:2624
  ds_read_b64_tr_b16 a[162:163], v208 offset:3264
  s_add_u32 m0, s94, 45056
  s_waitcnt lgkmcnt(6)
  v_mfma_f32_32x32x16_bf16 v[96:111], a[176:179], a[64:67], v[96:111]
  ds_read_b64_tr_b16 a[164:165], v208 offset:7744
  ds_read_b64_tr_b16 a[166:167], v208 offset:8384
  buffer_load_dwordx4 v14, s[32:35], s101 offen offset:0 lds
  v_mfma_f32_32x32x16_bf16 v[96:111], a[180:183], a[68:71], v[96:111]
  ds_read_b64_tr_b16 a[168:169], v208 offset:12864
  ds_read_b64_tr_b16 a[170:171], v208 offset:13504
  s_waitcnt lgkmcnt(6)
  v_mfma_f32_32x32x16_bf16 v[96:111], a[184:187], a[72:75], v[96:111]
  ds_read_b64_tr_b16 a[172:173], v208 offset:17984
  ds_read_b64_tr_b16 a[174:175], v208 offset:18624
  s_waitcnt vmcnt(9)
  s_barrier
  v_mfma_f32_32x32x16_bf16 v[96:111], a[188:191], a[76:79], v[96:111]
  ds_read_b64_tr_b16 a[176:177], v208 offset:20480
  ds_read_b64_tr_b16 a[178:179], v208 offset:21120
  ds_read_b128 a[80:83], v6 offset:8192
  s_add_u32 s100, s76, 896
  s_add_u32 m0, s86, 4096
  s_waitcnt lgkmcnt(7)
  v_mfma_f32_32x32x16_bf16 v[112:127], a[160:163], a[64:67], v[112:127]
  ds_read_b64_tr_b16 a[180:181], v208 offset:25600
  ds_read_b64_tr_b16 a[182:183], v208 offset:26240
  ds_read_b128 a[84:87], v7 offset:8192
  buffer_load_dwordx4 v2, s[28:31], s100 offen offset:0 lds
  v_mfma_f32_32x32x16_bf16 v[112:127], a[164:167], a[68:71], v[112:127]
  ds_read_b64_tr_b16 a[184:185], v208 offset:30720
  ds_read_b64_tr_b16 a[186:187], v208 offset:31360
  ds_read_b128 a[88:91], v8 offset:8192
  s_waitcnt lgkmcnt(9)
  v_mfma_f32_32x32x16_bf16 v[112:127], a[168:171], a[72:75], v[112:127]
  ds_read_b64_tr_b16 a[188:189], v209 offset:3072
  ds_read_b64_tr_b16 a[190:191], v209 offset:3712
  ds_read_b128 a[92:95], v9 offset:8192
  buffer_load_dwordx4 v3, s[28:31], s100 offen offset:1024 lds
  v_mfma_f32_32x32x16_bf16 v[112:127], a[172:175], a[76:79], v[112:127]
  ds_read_b64_tr_b16 a[160:161], v208 offset:20544
  ds_read_b64_tr_b16 a[162:163], v208 offset:21184
  s_waitcnt lgkmcnt(9)
  v_mfma_f32_32x32x16_bf16 v[48:63], a[176:179], a[80:83], v[48:63]
  ds_read_b64_tr_b16 a[164:165], v208 offset:25664
  ds_read_b64_tr_b16 a[166:167], v208 offset:26304
  buffer_load_dwordx4 v4, s[28:31], s100 offen offset:2048 lds
  s_waitcnt lgkmcnt(10)
  v_mfma_f32_32x32x16_bf16 v[48:63], a[180:183], a[84:87], v[48:63]
  ds_read_b64_tr_b16 a[168:169], v208 offset:30784
  ds_read_b64_tr_b16 a[170:171], v208 offset:31424
  s_waitcnt lgkmcnt(7)
  v_mfma_f32_32x32x16_bf16 v[48:63], a[184:187], a[88:91], v[48:63]
  ds_read_b64_tr_b16 a[172:173], v209 offset:3136
  ds_read_b64_tr_b16 a[174:175], v209 offset:3776
  buffer_load_dwordx4 v5, s[28:31], s100 offen offset:3072 lds
  s_waitcnt lgkmcnt(8)
  v_mfma_f32_32x32x16_bf16 v[48:63], a[188:191], a[92:95], v[48:63]
  ds_read_b64_tr_b16 a[176:177], v210 offset:20480
  ds_read_b64_tr_b16 a[178:179], v210 offset:21120
  s_add_u32 s101, s90, 1720320
  s_add_u32 m0, s94, 61440
  s_waitcnt lgkmcnt(6)
  v_mfma_f32_32x32x16_bf16 v[64:79], a[160:163], a[80:83], v[64:79]
  ds_read_b64_tr_b16 a[180:181], v210 offset:25600
  ds_read_b64_tr_b16 a[182:183], v210 offset:26240
  buffer_load_dwordx4 v10, s[32:35], s101 offen offset:0 lds
  v_mfma_f32_32x32x16_bf16 v[64:79], a[164:167], a[84:87], v[64:79]
  ds_read_b64_tr_b16 a[184:185], v210 offset:30720
  ds_read_b64_tr_b16 a[186:187], v210 offset:31360
  s_add_u32 m0, s94, 62464
  s_waitcnt lgkmcnt(6)
  v_mfma_f32_32x32x16_bf16 v[64:79], a[168:171], a[88:91], v[64:79]
  ds_read_b64_tr_b16 a[188:189], v211 offset:3072
  ds_read_b64_tr_b16 a[190:191], v211 offset:3712
  buffer_load_dwordx4 v11, s[32:35], s101 offen offset:0 lds
  v_mfma_f32_32x32x16_bf16 v[64:79], a[172:175], a[92:95], v[64:79]
  ds_read_b64_tr_b16 a[160:161], v208 offset:23040
  ds_read_b64_tr_b16 a[162:163], v208 offset:23680
  s_add_u32 m0, s94, 63488
  s_waitcnt lgkmcnt(6)
  v_mfma_f32_32x32x16_bf16 v[80:95], a[176:179], a[80:83], v[80:95]
  ds_read_b64_tr_b16 a[164:165], v208 offset:28160
  ds_read_b64_tr_b16 a[166:167], v208 offset:28800
  buffer_load_dwordx4 v12, s[32:35], s101 offen offset:0 lds
  v_mfma_f32_32x32x16_bf16 v[80:95], a[180:183], a[84:87], v[80:95]
  ds_read_b64_tr_b16 a[168:169], v209 offset:512
  ds_read_b64_tr_b16 a[170:171], v209 offset:1152
  s_add_u32 m0, s94, 64512
  s_waitcnt lgkmcnt(6)
  v_mfma_f32_32x32x16_bf16 v[80:95], a[184:187], a[88:91], v[80:95]
  ds_read_b64_tr_b16 a[172:173], v209 offset:5632
  ds_read_b64_tr_b16 a[174:175], v209 offset:6272
  buffer_load_dwordx4 v13, s[32:35], s101 offen offset:0 lds
  v_mfma_f32_32x32x16_bf16 v[80:95], a[188:191], a[92:95], v[80:95]
  ds_read_b64_tr_b16 a[176:177], v208 offset:23104
  ds_read_b64_tr_b16 a[178:179], v208 offset:23744
  s_add_u32 m0, s94, 65536
  s_waitcnt lgkmcnt(6)
  v_mfma_f32_32x32x16_bf16 v[96:111], a[160:163], a[80:83], v[96:111]
  ds_read_b64_tr_b16 a[180:181], v208 offset:28224
  ds_read_b64_tr_b16 a[182:183], v208 offset:28864
  buffer_load_dwordx4 v14, s[32:35], s101 offen offset:0 lds
  s_mov_b32 s82, 5275648
  buffer_load_dword v27, v17, s[48:51], s82 offen sc1
  s_mov_b32 s82, 5275648
  buffer_load_dword v45, v18, s[48:51], s82 offen sc1
  v_mfma_f32_32x32x16_bf16 v[96:111], a[164:167], a[84:87], v[96:111]
  ds_read_b64_tr_b16 a[184:185], v209 offset:576
  ds_read_b64_tr_b16 a[186:187], v209 offset:1216
  s_waitcnt lgkmcnt(6)
  v_mfma_f32_32x32x16_bf16 v[96:111], a[168:171], a[88:91], v[96:111]
  ds_read_b64_tr_b16 a[188:189], v209 offset:5696
  ds_read_b64_tr_b16 a[190:191], v209 offset:6336
  s_waitcnt vmcnt(11)
  s_barrier
  v_mfma_f32_32x32x16_bf16 v[96:111], a[172:175], a[92:95], v[96:111]
  ds_read_b64_tr_b16 a[160:161], v209 offset:8192
  ds_read_b64_tr_b16 a[162:163], v209 offset:8832
  ds_read_b128 a[96:99], v6 offset:0
  s_add_u32 s100, s76, 1024
  s_add_u32 m0, s86, 8192
  s_waitcnt lgkmcnt(7)
  v_mfma_f32_32x32x16_bf16 v[112:127], a[176:179], a[80:83], v[112:127]
  ds_read_b64_tr_b16 a[164:165], v209 offset:13312
  ds_read_b64_tr_b16 a[166:167], v209 offset:13952
  ds_read_b128 a[100:103], v7 offset:0
  buffer_load_dwordx4 v2, s[28:31], s100 offen offset:0 lds
  v_mfma_f32_32x32x16_bf16 v[112:127], a[180:183], a[84:87], v[112:127]
  ds_read_b64_tr_b16 a[168:169], v209 offset:18432
  ds_read_b64_tr_b16 a[170:171], v209 offset:19072
  ds_read_b128 a[104:107], v8 offset:0
  s_waitcnt lgkmcnt(9)
  v_mfma_f32_32x32x16_bf16 v[112:127], a[184:187], a[88:91], v[112:127]
  ds_read_b64_tr_b16 a[172:173], v209 offset:23552
  ds_read_b64_tr_b16 a[174:175], v209 offset:24192
  ds_read_b128 a[108:111], v9 offset:0
  buffer_load_dwordx4 v3, s[28:31], s100 offen offset:1024 lds
  v_mfma_f32_32x32x16_bf16 v[112:127], a[188:191], a[92:95], v[112:127]
  ds_read_b64_tr_b16 a[176:177], v209 offset:8256
  ds_read_b64_tr_b16 a[178:179], v209 offset:8896
  s_waitcnt lgkmcnt(9)
  v_mfma_f32_32x32x16_bf16 v[48:63], a[160:163], a[96:99], v[48:63]
  ds_read_b64_tr_b16 a[180:181], v209 offset:13376
  ds_read_b64_tr_b16 a[182:183], v209 offset:14016
  buffer_load_dwordx4 v4, s[28:31], s100 offen offset:2048 lds
  s_waitcnt lgkmcnt(10)
  v_mfma_f32_32x32x16_bf16 v[48:63], a[164:167], a[100:103], v[48:63]
  ds_read_b64_tr_b16 a[184:185], v209 offset:18496
  ds_read_b64_tr_b16 a[186:187], v209 offset:19136
  s_waitcnt lgkmcnt(7)
  v_mfma_f32_32x32x16_bf16 v[48:63], a[168:171], a[104:107], v[48:63]
  ds_read_b64_tr_b16 a[188:189], v209 offset:23616
  ds_read_b64_tr_b16 a[190:191], v209 offset:24256
  buffer_load_dwordx4 v5, s[28:31], s100 offen offset:3072 lds
  s_waitcnt lgkmcnt(8)
  v_mfma_f32_32x32x16_bf16 v[48:63], a[172:175], a[108:111], v[48:63]
  ds_read_b64_tr_b16 a[160:161], v211 offset:8192
  ds_read_b64_tr_b16 a[162:163], v211 offset:8832
  s_add_u32 s101, s90, 1966080
  s_add_u32 m0, s94, 0
  s_waitcnt lgkmcnt(6)
  v_mfma_f32_32x32x16_bf16 v[64:79], a[176:179], a[96:99], v[64:79]
  ds_read_b64_tr_b16 a[164:165], v211 offset:13312
  ds_read_b64_tr_b16 a[166:167], v211 offset:13952
  buffer_load_dwordx4 v10, s[32:35], s101 offen offset:0 lds
  v_mfma_f32_32x32x16_bf16 v[64:79], a[180:183], a[100:103], v[64:79]
  ds_read_b64_tr_b16 a[168:169], v211 offset:18432
  ds_read_b64_tr_b16 a[170:171], v211 offset:19072
  s_add_u32 m0, s94, 1024
  s_waitcnt lgkmcnt(6)
  v_mfma_f32_32x32x16_bf16 v[64:79], a[184:187], a[104:107], v[64:79]
  ds_read_b64_tr_b16 a[172:173], v211 offset:23552
  ds_read_b64_tr_b16 a[174:175], v211 offset:24192
  buffer_load_dwordx4 v11, s[32:35], s101 offen offset:0 lds
  v_mfma_f32_32x32x16_bf16 v[64:79], a[188:191], a[108:111], v[64:79]
  ds_read_b64_tr_b16 a[176:177], v209 offset:10752
  ds_read_b64_tr_b16 a[178:179], v209 offset:11392
  s_add_u32 m0, s94, 2048
  s_waitcnt lgkmcnt(6)
  v_mfma_f32_32x32x16_bf16 v[80:95], a[160:163], a[96:99], v[80:95]
  ds_read_b64_tr_b16 a[180:181], v209 offset:15872
  ds_read_b64_tr_b16 a[182:183], v209 offset:16512
  buffer_load_dwordx4 v12, s[32:35], s101 offen offset:0 lds
  v_mfma_f32_32x32x16_bf16 v[80:95], a[164:167], a[100:103], v[80:95]
  ds_read_b64_tr_b16 a[184:185], v209 offset:20992
  ds_read_b64_tr_b16 a[186:187], v209 offset:21632
  s_add_u32 m0, s94, 3072
  s_waitcnt lgkmcnt(6)
  v_mfma_f32_32x32x16_bf16 v[80:95], a[168:171], a[104:107], v[80:95]
  ds_read_b64_tr_b16 a[188:189], v209 offset:26112
  ds_read_b64_tr_b16 a[190:191], v209 offset:26752
  buffer_load_dwordx4 v13, s[32:35], s101 offen offset:0 lds
  v_mfma_f32_32x32x16_bf16 v[80:95], a[172:175], a[108:111], v[80:95]
  ds_read_b64_tr_b16 a[160:161], v209 offset:10816
  ds_read_b64_tr_b16 a[162:163], v209 offset:11456
  s_add_u32 m0, s94, 4096
  s_waitcnt lgkmcnt(6)
  v_mfma_f32_32x32x16_bf16 v[96:111], a[176:179], a[96:99], v[96:111]
  ds_read_b64_tr_b16 a[164:165], v209 offset:15936
  ds_read_b64_tr_b16 a[166:167], v209 offset:16576
  buffer_load_dwordx4 v14, s[32:35], s101 offen offset:0 lds
  s_add_u32 s82, s74, 1
  s_waitcnt vmcnt(10)
  v_cmp_ne_u32 vcc, s82, v27
  s_nop 0
  s_cbranch_vccnz L_slow10
L_back11:
  s_add_u32 s82, s74, 1
  s_waitcnt vmcnt(9)
  v_cmp_ne_u32 vcc, s82, v45
  s_nop 0
  s_cbranch_vccnz L_slow13
L_back14:
  buffer_load_dwordx2 v[128:129], v216, s[48:51], 0 offen sc1
  v_mfma_f32_32x32x16_bf16 v[96:111], a[180:183], a[100:103], v[96:111]
  ds_read_b64_tr_b16 a[168:169], v209 offset:21056
  ds_read_b64_tr_b16 a[170:171], v209 offset:21696
  buffer_load_dwordx4 v[132:135], v217, s[48:51], 0 offen sc1
  s_waitcnt lgkmcnt(6)
  v_mfma_f32_32x32x16_bf16 v[96:111], a[184:187], a[104:107], v[96:111]
  ds_read_b64_tr_b16 a[172:173], v209 offset:26176
  ds_read_b64_tr_b16 a[174:175], v209 offset:26816
  buffer_load_dwordx4 v[136:139], v218, s[48:51], 0 offen sc1
  s_barrier
  v_mfma_f32_32x32x16_bf16 v[96:111], a[188:191], a[108:111], v[96:111]
  ds_read_b64_tr_b16 a[176:177], v209 offset:28672
  ds_read_b64_tr_b16 a[178:179], v209 offset:29312
  ds_read_b128 a[112:115], v6 offset:4096
  buffer_load_dwordx4 v[140:143], v219, s[48:51], 0 offen sc1
  s_add_u32 s100, s76, 1152
  s_add_u32 m0, s86, 0
  s_waitcnt lgkmcnt(7)
  v_mfma_f32_32x32x16_bf16 v[112:127], a[160:163], a[96:99], v[112:127]
  ds_read_b64_tr_b16 a[180:181], v209 offset:33792
  ds_read_b64_tr_b16 a[182:183], v209 offset:34432
  ds_read_b128 a[116:119], v7 offset:4096
  buffer_load_dwordx4 v2, s[28:31], s100 offen offset:0 lds
  buffer_load_dwordx4 v[144:147], v220, s[48:51], 0 offen sc1
  v_mfma_f32_32x32x16_bf16 v[112:127], a[164:167], a[100:103], v[112:127]
  ds_read_b64_tr_b16 a[184:185], v209 offset:38912
  ds_read_b64_tr_b16 a[186:187], v209 offset:39552
  ds_read_b128 a[120:123], v8 offset:4096
  s_waitcnt lgkmcnt(9)
  v_mfma_f32_32x32x16_bf16 v[112:127], a[168:171], a[104:107], v[112:127]
  ds_read_b64_tr_b16 a[188:189], v209 offset:44032
  ds_read_b64_tr_b16 a[190:191], v209 offset:44672
  ds_read_b128 a[124:127], v9 offset:4096
  buffer_load_dwordx4 v3, s[28:31], s100 offen offset:1024 lds
  v_mfma_f32_32x32x16_bf16 v[112:127], a[172:175], a[108:111], v[112:127]
  ds_read_b64_tr_b16 a[160:161], v209 offset:28736
  ds_read_b64_tr_b16 a[162:163], v209 offset:29376
  s_waitcnt lgkmcnt(9)
  v_mfma_f32_32x32x16_bf16 v[48:63], a[176:179], a[112:115], v[48:63]
  ds_read_b64_tr_b16 a[164:165], v209 offset:33856
  ds_read_b64_tr_b16 a[166:167], v209 offset:34496
  buffer_load_dwordx4 v4, s[28:31], s100 offen offset:2048 lds
  s_waitcnt lgkmcnt(10)
  v_mfma_f32_32x32x16_bf16 v[48:63], a[180:183], a[116:119], v[48:63]
  ds_read_b64_tr_b16 a[168:169], v209 offset:38976
  ds_read_b64_tr_b16 a[170:171], v209 offset:39616
  s_waitcnt lgkmcnt(7)
  v_mfma_f32_32x32x16_bf16 v[48:63], a[184:187], a[120:123], v[48:63]
  ds_read_b64_tr_b16 a[172:173], v209 offset:44096
  ds_read_b64_tr_b16 a[174:175], v209 offset:44736
  buffer_load_dwordx4 v5, s[28:31], s100 offen offset:3072 lds
  s_waitcnt lgkmcnt(8)
  v_mfma_f32_32x32x16_bf16 v[48:63], a[188:191], a[124:127], v[48:63]
  ds_read_b64_tr_b16 a[176:177], v211 offset:28672
  ds_read_b64_tr_b16 a[178:179], v211 offset:29312
  s_add_u32 s101, s90, 2211840
  s_add_u32 m0, s94, 20480
  s_waitcnt lgkmcnt(6)
  v_mfma_f32_32x32x16_bf16 v[64:79], a[160:163], a[112:115], v[64:79]
  ds_read_b64_tr_b16 a[180:181], v211 offset:33792
  ds_read_b64_tr_b16 a[182:183], v211 offset:34432
  buffer_load_dwordx4 v10, s[32:35], s101 offen offset:0 lds
  v_mfma_f32_32x32x16_bf16 v[64:79], a[164:167], a[116:119], v[64:79]
  ds_read_b64_tr_b16 a[184:185], v211 offset:38912
  ds_read_b64_tr_b16 a[186:187], v211 offset:39552
  s_add_u32 m0, s94, 21504
  s_waitcnt lgkmcnt(6)
  v_mfma_f32_32x32x16_bf16 v[64:79], a[168:171], a[120:123], v[64:79]
  ds_read_b64_tr_b16 a[188:189], v211 offset:44032
  ds_read_b64_tr_b16 a[190:191], v211 offset:44672
  buffer_load_dwordx4 v11, s[32:35], s101 offen offset:0 lds
  v_mfma_f32_32x32x16_bf16 v[64:79], a[172:175], a[124:127], v[64:79]
  ds_read_b64_tr_b16 a[160:161], v209 offset:31232
  ds_read_b64_tr_b16 a[162:163], v209 offset:31872
  s_add_u32 m0, s94, 22528
  s_waitcnt lgkmcnt(6)
  v_mfma_f32_32x32x16_bf16 v[80:95], a[176:179], a[112:115], v[80:95]
  ds_read_b64_tr_b16 a[164:165], v209 offset:36352
  ds_read_b64_tr_b16 a[166:167], v209 offset:36992
  buffer_load_dwordx4 v12, s[32:35], s101 offen offset:0 lds
  v_mfma_f32_32x32x16_bf16 v[80:95], a[180:183], a[116:119], v[80:95]
  ds_read_b64_tr_b16 a[168:169], v209 offset:41472
  ds_read_b64_tr_b16 a[170:171], v209 offset:42112
  s_add_u32 m0, s94, 23552
  s_waitcnt lgkmcnt(6)
  v_mfma_f32_32x32x16_bf16 v[80:95], a[184:187], a[120:123], v[80:95]
  ds_read_b64_tr_b16 a[172:173], v209 offset:46592
  ds_read_b64_tr_b16 a[174:175], v209 offset:47232
  buffer_load_dwordx4 v13, s[32:35], s101 offen offset:0 lds
  v_mfma_f32_32x32x16_bf16 v[80:95], a[188:191], a[124:127], v[80:95]
  ds_read_b64_tr_b16 a[176:177], v209 offset:31296
  ds_read_b64_tr_b16 a[178:179], v209 offset:31936
  s_add_u32 m0, s94, 24576
  s_waitcnt lgkmcnt(6)
  v_mfma_f32_32x32x16_bf16 v[96:111], a[160:163], a[112:115], v[96:111]
  ds_read_b64_tr_b16 a[180:181], v209 offset:36416
  ds_read_b64_tr_b16 a[182:183], v209 offset:37056
  buffer_load_dwordx4 v14, s[32:35], s101 offen offset:0 lds
  v_mfma_f32_32x32x16_bf16 v[96:111], a[164:167], a[116:119], v[96:111]
  ds_read_b64_tr_b16 a[184:185], v209 offset:41536
  ds_read_b64_tr_b16 a[186:187], v209 offset:42176
  s_waitcnt vmcnt(11)
  v_add_f32 v132, v132, v136
  v_add_f32 v156, 925353388, v129
  v_add_f32 v133, v133, v137
  v_rsq_f32 v32, v156
  s_waitcnt lgkmcnt(6)
  v_mfma_f32_32x32x16_bf16 v[96:111], a[168:171], a[120:123], v[96:111]
  ds_read_b64_tr_b16 a[188:189], v209 offset:46656
  ds_read_b64_tr_b16 a[190:191], v209 offset:47296
  v_add_f32 v134, v134, v138
  v_mul_f32 v157, v129, v32
  v_add_f32 v135, v135, v139
  v_mul_f32 v157, v157, v32
  s_barrier
  v_mfma_f32_32x32x16_bf16 v[96:111], a[172:175], a[124:127], v[96:111]
  ds_read_b64_tr_b16 a[160:161], v208 offset:0
  ds_read_b64_tr_b16 a[162:163], v208 offset:640
  ds_read_b128 a[128:131], v6 offset:8192
  s_waitcnt vmcnt(10)
  v_add_f32 v132, v132, v140
  v_add_f32 v157, 925353388, v157
  v_add_f32 v133, v133, v141
  v_rsq_f32 v157, v157
  s_add_u32 s101, s3, 0
  s_add_u32 m0, s91, 40960
  s_waitcnt lgkmcnt(7)
  v_mfma_f32_32x32x16_bf16 v[112:127], a[176:179], a[112:115], v[112:127]
  ds_read_b64_tr_b16 a[164:165], v208 offset:5120
  ds_read_b64_tr_b16 a[166:167], v208 offset:5760
  ds_read_b128 a[132:135], v7 offset:8192
  buffer_load_dwordx4 v46, s[36:39], s101 offen offset:0 lds
  v_mfma_f32_32x32x16_bf16 v[112:127], a[180:183], a[116:119], v[112:127]
  ds_read_b64_tr_b16 a[168:169], v208 offset:10240
  ds_read_b64_tr_b16 a[170:171], v208 offset:10880
  ds_read_b128 a[136:139], v8 offset:8192
  v_add_f32 v134, v134, v142
  v_mul_f32 v34, 1069066811, v32
  v_add_f32 v135, v135, v143
  s_waitcnt lgkmcnt(9)
  v_mfma_f32_32x32x16_bf16 v[112:127], a[184:187], a[120:123], v[112:127]
  ds_read_b64_tr_b16 a[172:173], v208 offset:15360
  ds_read_b64_tr_b16 a[174:175], v208 offset:16000
  ds_read_b128 a[140:143], v9 offset:8192
  v_mul_f32 v157, v157, v32
  s_waitcnt vmcnt(9)
  v_add_f32 v132, v132, v144
  v_rcp_f32 v44, v157
  v_mfma_f32_32x32x16_bf16 v[112:127], a[188:191], a[124:127], v[112:127]
  ds_read_b64_tr_b16 a[176:177], v208 offset:64
  ds_read_b64_tr_b16 a[178:179], v208 offset:704
  v_add_f32 v133, v133, v145
  v_mul_f32 v36, 3222493025, v157
  v_add_f32 v134, v134, v146
  v_mul_f32 v158, v157, v157
  s_waitcnt lgkmcnt(9)
  v_mfma_f32_32x32x16_bf16 v[48:63], a[160:163], a[128:131], v[48:63]
  ds_read_b64_tr_b16 a[180:181], v208 offset:5184
  ds_read_b64_tr_b16 a[182:183], v208 offset:5824
  buffer_load_dwordx4 v47, s[36:39], s101 offen offset:1024 lds
  v_add_f32 v135, v135, v147
  v_mul_f32 v158, v158, v157
  s_waitcnt lgkmcnt(10)
  v_mfma_f32_32x32x16_bf16 v[48:63], a[164:167], a[132:135], v[48:63]
  ds_read_b64_tr_b16 a[184:185], v208 offset:10304
  ds_read_b64_tr_b16 a[186:187], v208 offset:10944
  v_permlane32_swap_b32 v132, v134
  v_mul_f32 v38, 3184710632, v158
  v_permlane32_swap_b32 v133, v135
  v_sub_f32 v128, 0, v128
  v_add_f32 v132, v132, v134
  s_waitcnt lgkmcnt(7)
  v_mfma_f32_32x32x16_bf16 v[48:63], a[168:171], a[136:139], v[48:63]
  ds_read_b64_tr_b16 a[188:189], v208 offset:15424
  ds_read_b64_tr_b16 a[190:191], v208 offset:16064
  v_cvt_pk_bf16_f32 v156, v128, v128
  v_add_f32 v133, v133, v135
  v_and_b32 v156, 0xffff0000, v156
  s_nop 0
  v_permlane16_swap_b32 v132, v133
  s_waitcnt lgkmcnt(8)
  v_mfma_f32_32x32x16_bf16 v[48:63], a[172:175], a[140:143], v[48:63]
  ds_read_b64_tr_b16 a[160:161], v210 offset:0
  ds_read_b64_tr_b16 a[162:163], v210 offset:640
  v_sub_f32 v158, v128, v156
  v_add_f32 v132, v132, v133
  v_cvt_pk_bf16_f32 v40, v156, v158
  v_cvt_pk_bf16_f32 v152, v132, v132
  v_cvt_pk_bf16_f32 v156, v44, v44
  s_waitcnt lgkmcnt(6)
  v_mfma_f32_32x32x16_bf16 v[64:79], a[176:179], a[128:131], v[64:79]
  ds_read_b64_tr_b16 a[164:165], v210 offset:5120
  ds_read_b64_tr_b16 a[166:167], v210 offset:5760
  v_and_b32 v160, 0xffff0000, v152
  v_and_b32 v156, 0xffff0000, v156
  v_sub_f32 v160, v132, v160
  v_sub_f32 v158, v44, v156
  s_add_u32 s101, s3, 221184
  s_add_u32 m0, s91, 49152
  v_mfma_f32_32x32x16_bf16 v[64:79], a[180:183], a[132:135], v[64:79]
  ds_read_b64_tr_b16 a[168:169], v210 offset:10240
  ds_read_b64_tr_b16 a[170:171], v210 offset:10880
  buffer_load_dwordx4 v46, s[36:39], s101 offen offset:0 lds
  v_cvt_pk_bf16_f32 v153, v160, v160
  v_cvt_pk_bf16_f32 v42, v156, v158
  s_waitcnt lgkmcnt(6)
  v_mfma_f32_32x32x16_bf16 v[64:79], a[184:187], a[136:139], v[64:79]
  ds_read_b64_tr_b16 a[172:173], v210 offset:15360
  ds_read_b64_tr_b16 a[174:175], v210 offset:16000
  v_lshl_or_b32 v154, v178, 16, v178
  v_and_b32 v156, 0xffff0000, v42
  v_mov_b32 v155, v178
  v_sub_f32 v158, v158, v156
  v_mfma_f32_32x32x16_bf16 v[64:79], a[188:191], a[140:143], v[64:79]
  ds_read_b64_tr_b16 a[176:177], v208 offset:2560
  ds_read_b64_tr_b16 a[178:179], v208 offset:3200
  ds_write_b128 v222, v[152:155]
  v_cvt_pk_bf16_f32 v43, v158, 0
  v_not_b32 v159, v29
  v_and_b32 v40, v40, v159
  v_and_b32 v42, v42, v159
  s_waitcnt lgkmcnt(7)
  v_mfma_f32_32x32x16_bf16 v[80:95], a[160:163], a[128:131], v[80:95]
  ds_read_b64_tr_b16 a[180:181], v208 offset:7680
  ds_read_b64_tr_b16 a[182:183], v208 offset:8320
  v_and_b32 v43, v43, v159
  v_mov_b32 v41, v40
  v_mfma_f32_32x32x16_bf16 v[80:95], a[164:167], a[132:135], v[80:95]
  ds_read_b64_tr_b16 a[184:185], v208 offset:12800
  ds_read_b64_tr_b16 a[186:187], v208 offset:13440
  s_waitcnt lgkmcnt(7)
  v_mfma_f32_32x32x16_bf16 v[80:95], a[168:171], a[136:139], v[80:95]
  ds_read_b64_tr_b16 a[188:189], v208 offset:17920
  ds_read_b64_tr_b16 a[190:191], v208 offset:18560
  buffer_load_dwordx4 v47, s[36:39], s101 offen offset:1024 lds
  v_mfma_f32_32x32x16_bf16 v[80:95], a[172:175], a[140:143], v[80:95]
  ds_read_b64_tr_b16 a[160:161], v208 offset:2624
  ds_read_b64_tr_b16 a[162:163], v208 offset:3264
  s_waitcnt lgkmcnt(6)
  v_mfma_f32_32x32x16_bf16 v[96:111], a[176:179], a[128:131], v[96:111]
  ds_read_b64_tr_b16 a[164:165], v208 offset:7744
  ds_read_b64_tr_b16 a[166:167], v208 offset:8384
  v_mfma_f32_32x32x16_bf16 v[96:111], a[180:183], a[132:135], v[96:111]
  ds_read_b64_tr_b16 a[168:169], v208 offset:12864
  ds_read_b64_tr_b16 a[170:171], v208 offset:13504
  s_waitcnt lgkmcnt(6)
  v_mfma_f32_32x32x16_bf16 v[96:111], a[184:187], a[136:139], v[96:111]
  ds_read_b64_tr_b16 a[172:173], v208 offset:17984
  ds_read_b64_tr_b16 a[174:175], v208 offset:18624
  s_waitcnt vmcnt(4)
  s_barrier
  v_mfma_f32_32x32x16_bf16 v[96:111], a[188:191], a[140:143], v[96:111]
  ds_read_b64_tr_b16 a[176:177], v208 offset:20480
  ds_read_b64_tr_b16 a[178:179], v208 offset:21120
  ds_read_b128 a[144:147], v6 offset:0
  s_add_u32 s101, s3, 442368
  s_add_u32 m0, s91, 57344
  s_waitcnt lgkmcnt(7)
  v_mfma_f32_32x32x16_bf16 v[112:127], a[160:163], a[128:131], v[112:127]
  ds_read_b64_tr_b16 a[180:181], v208 offset:25600
  ds_read_b64_tr_b16 a[182:183], v208 offset:26240
  ds_read_b128 a[148:151], v7 offset:0
  buffer_load_dwordx4 v46, s[36:39], s101 offen offset:0 lds
  v_mfma_f32_32x32x16_bf16 v[112:127], a[164:167], a[132:135], v[112:127]
  ds_read_b64_tr_b16 a[184:185], v208 offset:30720
  ds_read_b64_tr_b16 a[186:187], v208 offset:31360
  ds_read_b128 a[152:155], v8 offset:0
  s_waitcnt lgkmcnt(9)
  v_mfma_f32_32x32x16_bf16 v[112:127], a[168:171], a[136:139], v[112:127]
  ds_read_b64_tr_b16 a[188:189], v209 offset:3072
  ds_read_b64_tr_b16 a[190:191], v209 offset:3712
  ds_read_b128 a[156:159], v9 offset:0
  v_mfma_f32_32x32x16_bf16 v[112:127], a[172:175], a[140:143], v[112:127]
  ds_read_b64_tr_b16 a[160:161], v208 offset:20544
  ds_read_b64_tr_b16 a[162:163], v208 offset:21184
  s_waitcnt lgkmcnt(9)
  v_mfma_f32_32x32x16_bf16 v[48:63], a[176:179], a[144:147], v[48:63]
  ds_read_b64_tr_b16 a[164:165], v208 offset:25664
  ds_read_b64_tr_b16 a[166:167], v208 offset:26304
  buffer_load_dwordx4 v47, s[36:39], s101 offen offset:1024 lds
  s_waitcnt lgkmcnt(10)
  v_mfma_f32_32x32x16_bf16 v[48:63], a[180:183], a[148:151], v[48:63]
  ds_read_b64_tr_b16 a[168:169], v208 offset:30784
  ds_read_b64_tr_b16 a[170:171], v208 offset:31424
  s_waitcnt lgkmcnt(7)
  v_mfma_f32_32x32x16_bf16 v[48:63], a[184:187], a[152:155], v[48:63]
  ds_read_b64_tr_b16 a[172:173], v209 offset:3136
  ds_read_b64_tr_b16 a[174:175], v209 offset:3776
  s_waitcnt lgkmcnt(8)
  v_mfma_f32_32x32x16_bf16 v[48:63], a[188:191], a[156:159], v[48:63]
  ds_read_b64_tr_b16 a[176:177], v210 offset:20480
  ds_read_b64_tr_b16 a[178:179], v210 offset:21120
  s_add_u32 s101, s3, 663552
  s_add_u32 m0, s91, 65536
  s_waitcnt lgkmcnt(6)
  v_mfma_f32_32x32x16_bf16 v[64:79], a[160:163], a[144:147], v[64:79]
  ds_read_b64_tr_b16 a[180:181], v210 offset:25600
  ds_read_b64_tr_b16 a[182:183], v210 offset:26240
  buffer_load_dwordx4 v46, s[36:39], s101 offen offset:0 lds
  v_mfma_f32_32x32x16_bf16 v[64:79], a[164:167], a[148:151], v[64:79]
  ds_read_b64_tr_b16 a[184:185], v210 offset:30720
  ds_read_b64_tr_b16 a[186:187], v210 offset:31360
  s_waitcnt lgkmcnt(6)
  v_mfma_f32_32x32x16_bf16 v[64:79], a[168:171], a[152:155], v[64:79]
  ds_read_b64_tr_b16 a[188:189], v211 offset:3072
  ds_read_b64_tr_b16 a[190:191], v211 offset:3712
  v_mfma_f32_32x32x16_bf16 v[64:79], a[172:175], a[156:159], v[64:79]
  ds_read_b64_tr_b16 a[160:161], v208 offset:23040
  ds_read_b64_tr_b16 a[162:163], v208 offset:23680
  s_waitcnt lgkmcnt(6)
  v_mfma_f32_32x32x16_bf16 v[80:95], a[176:179], a[144:147], v[80:95]
  ds_read_b64_tr_b16 a[164:165], v208 offset:28160
  ds_read_b64_tr_b16 a[166:167], v208 offset:28800
  buffer_load_dwordx4 v47, s[36:39], s101 offen offset:1024 lds
  v_mfma_f32_32x32x16_bf16 v[80:95], a[180:183], a[148:151], v[80:95]
  ds_read_b64_tr_b16 a[168:169], v209 offset:512
  ds_read_b64_tr_b16 a[170:171], v209 offset:1152
  s_waitcnt lgkmcnt(6)
  v_mfma_f32_32x32x16_bf16 v[80:95], a[184:187], a[152:155], v[80:95]
  ds_read_b64_tr_b16 a[172:173], v209 offset:5632
  ds_read_b64_tr_b16 a[174:175], v209 offset:6272
  v_mfma_f32_32x32x16_bf16 v[80:95], a[188:191], a[156:159], v[80:95]
  ds_read_b64_tr_b16 a[176:177], v208 offset:23104
  ds_read_b64_tr_b16 a[178:179], v208 offset:23744
  s_add_u32 s101, s3, 884736
  s_add_u32 m0, s91, 73728
  s_waitcnt lgkmcnt(6)
  v_mfma_f32_32x32x16_bf16 v[96:111], a[160:163], a[144:147], v[96:111]
  ds_read_b64_tr_b16 a[180:181], v208 offset:28224
  ds_read_b64_tr_b16 a[182:183], v208 offset:28864
  buffer_load_dwordx4 v46, s[36:39], s101 offen offset:0 lds
  v_mfma_f32_32x32x16_bf16 v[96:111], a[164:167], a[148:151], v[96:111]
  ds_read_b64_tr_b16 a[184:185], v209 offset:576
  ds_read_b64_tr_b16 a[186:187], v209 offset:1216
  s_barrier
  s_waitcnt lgkmcnt(6)
  v_mfma_f32_32x32x16_bf16 v[96:111], a[168:171], a[152:155], v[96:111]
  ds_read_b64_tr_b16 a[188:189], v209 offset:5696
  ds_read_b64_tr_b16 a[190:191], v209 offset:6336
  v_mfma_f32_32x32x16_bf16 v[96:111], a[172:175], a[156:159], v[96:111]
  ds_read_b128 a[160:163], v19 offset:0
  v_lshlrev_b32 v224, 16, v226
  v_and_b32 v225, 0xffff0000, v226
  v_lshlrev_b32 v226, 16, v227
  v_and_b32 v227, 0xffff0000, v227
  v_lshlrev_b32 v228, 16, v230
  s_waitcnt lgkmcnt(5)
  v_mfma_f32_32x32x16_bf16 v[112:127], a[176:179], a[144:147], v[112:127]
  ds_read_b128 a[164:167], v19 offset:512
  buffer_load_dwordx4 v47, s[36:39], s101 offen offset:1024 lds
  v_and_b32 v229, 0xffff0000, v230
  v_lshlrev_b32 v230, 16, v231
  v_mfma_f32_32x32x16_bf16 v[112:127], a[180:183], a[148:151], v[112:127]
  ds_read_b128 a[168:171], v19 offset:1024
  v_and_b32 v231, 0xffff0000, v231
  v_lshlrev_b32 v232, 16, v234
  v_and_b32 v233, 0xffff0000, v234
  v_lshlrev_b32 v234, 16, v235
  v_and_b32 v235, 0xffff0000, v235
  s_waitcnt lgkmcnt(3)
  v_mfma_f32_32x32x16_bf16 v[112:127], a[184:187], a[152:155], v[112:127]
  ds_read_b128 a[172:175], v19 offset:1536
  v_lshlrev_b32 v236, 16, v238
  v_and_b32 v237, 0xffff0000, v238
  v_lshlrev_b32 v238, 16, v239
  v_and_b32 v239, 0xffff0000, v239
  v_mfma_f32_32x32x16_bf16 v[112:127], a[188:191], a[156:159], v[112:127]
  ds_read_b128 a[176:179], v19 offset:2048
  v_lshlrev_b32 v240, 16, v242
  v_and_b32 v241, 0xffff0000, v242
  v_lshlrev_b32 v242, 16, v243
  v_and_b32 v243, 0xffff0000, v243
  s_sub_u32 s79, s9, s10
  v_add_u32 v2, s79, v185
  v_add_u32 v3, s79, v186
  v_add_u32 v4, s79, v187
  v_add_u32 v5, s79, v188
  s_waitcnt vmcnt(8)
  s_barrier
  s_waitcnt lgkmcnt(3)
  v_mfma_f32_32x32x16_bf16 v[48:63], a[160:163], v[40:43], v[48:63]
  ds_read_b64_tr_b16 a[180:181], v212 offset:8192
  ds_read_b64_tr_b16 a[182:183], v212 offset:8704
  v_mfma_f32_32x32x16_bf16 v[64:79], a[164:167], v[40:43], v[64:79]
  ds_read_b64_tr_b16 a[184:185], v212 offset:10240
  ds_read_b64_tr_b16 a[186:187], v212 offset:10752
  s_waitcnt lgkmcnt(5)
  v_mfma_f32_32x32x16_bf16 v[80:95], a[168:171], v[40:43], v[80:95]
  ds_read_b64_tr_b16 a[188:189], v212 offset:12288
  ds_read_b64_tr_b16 a[190:191], v212 offset:12800
  v_mfma_f32_32x32x16_bf16 v[96:111], a[172:175], v[40:43], v[96:111]
  ds_read_b64_tr_b16 a[160:161], v212 offset:14336
  ds_read_b64_tr_b16 a[162:163], v212 offset:14848
  s_waitcnt lgkmcnt(6)
  v_mfma_f32_32x32x16_bf16 v[112:127], a[176:179], v[40:43], v[112:127]
  ds_read_b64_tr_b16 a[164:165], v213 offset:8192
  ds_read_b64_tr_b16 a[166:167], v213 offset:8704
  s_barrier
  s_add_u32 s101, s3, 1105920
  s_add_u32 m0, s91, 0
  s_nop 0
  buffer_load_dwordx4 v46, s[36:39], s101 offen offset:0 lds
  v_mov_b32 v254, 0x3f803f80
  v_mov_b32 v255, 0x3f803f80
  ds_write_b64 v25, v[254:255]
  v_pk_mul_f32 v[244:245], v[48:49], v[34:35] op_sel_hi:[1,0]
  v_pk_mul_f32 v[246:247], v[50:51], v[34:35] op_sel_hi:[1,0]
  v_pk_fma_f32 v[48:49], v[48:49], v[32:33], 1.0 op_sel_hi:[1,0,0]
  v_pk_fma_f32 v[50:51], v[50:51], v[32:33], 1.0 op_sel_hi:[1,0,0]
  v_exp_f32_e64 v244, v244 clamp
  v_exp_f32_e64 v245, v245 clamp
  v_exp_f32_e64 v246, v246 clamp
  v_exp_f32_e64 v247, v247 clamp
  v_max_f32 v244, v244, v48
  v_max_f32 v245, v245, v49
  v_max_f32 v246, v246, v50
  buffer_load_dwordx4 v47, s[36:39], s101 offen offset:1024 lds
  v_max_f32 v247, v247, v51
  v_pk_add_f32 v[244:245], v[244:245], s[84:85] op_sel_hi:[1,0]
  v_pk_add_f32 v[246:247], v[246:247], s[84:85] op_sel_hi:[1,0]
  v_cvt_pk_bf16_f32 v48, v244, v245
  v_cvt_pk_bf16_f32 v49, v246, v247
  ds_write_b64 v20, v[48:49] offset:0
  v_pk_mul_f32 v[248:249], v[52:53], v[34:35] op_sel_hi:[1,0]
  v_pk_mul_f32 v[250:251], v[54:55], v[34:35] op_sel_hi:[1,0]
  v_pk_fma_f32 v[52:53], v[52:53], v[32:33], 1.0 op_sel_hi:[1,0,0]
  v_pk_fma_f32 v[54:55], v[54:55], v[32:33], 1.0 op_sel_hi:[1,0,0]
  v_exp_f32_e64 v248, v248 clamp
  v_exp_f32_e64 v249, v249 clamp
  v_exp_f32_e64 v250, v250 clamp
  s_add_u32 s101, s3, 1327104
  s_add_u32 m0, s91, 8192
  s_nop 0
  buffer_load_dwordx4 v46, s[36:39], s101 offen offset:0 lds
  v_exp_f32_e64 v251, v251 clamp
  v_max_f32 v248, v248, v52
  v_max_f32 v249, v249, v53
  v_max_f32 v250, v250, v54
  v_max_f32 v251, v251, v55
  v_pk_add_f32 v[248:249], v[248:249], s[84:85] op_sel_hi:[1,0]
  v_pk_add_f32 v[250:251], v[250:251], s[84:85] op_sel_hi:[1,0]
  v_cvt_pk_bf16_f32 v52, v248, v249
  v_cvt_pk_bf16_f32 v53, v250, v251
  ds_write_b64 v20, v[52:53] offset:16
  v_pk_mul_f32 v[244:245], v[56:57], v[34:35] op_sel_hi:[1,0]
  v_pk_mul_f32 v[246:247], v[58:59], v[34:35] op_sel_hi:[1,0]
  v_pk_fma_f32 v[56:57], v[56:57], v[32:33], 1.0 op_sel_hi:[1,0,0]
  v_pk_fma_f32 v[58:59], v[58:59], v[32:33], 1.0 op_sel_hi:[1,0,0]
  buffer_load_dwordx4 v47, s[36:39], s101 offen offset:1024 lds
  v_exp_f32_e64 v244, v244 clamp
  v_exp_f32_e64 v245, v245 clamp
  v_exp_f32_e64 v246, v246 clamp
  v_exp_f32_e64 v247, v247 clamp
  v_max_f32 v244, v244, v56
  v_max_f32 v245, v245, v57
  v_max_f32 v246, v246, v58
  v_max_f32 v247, v247, v59
  v_pk_add_f32 v[244:245], v[244:245], s[84:85] op_sel_hi:[1,0]
  v_pk_add_f32 v[246:247], v[246:247], s[84:85] op_sel_hi:[1,0]
  v_cvt_pk_bf16_f32 v56, v244, v245
  v_cvt_pk_bf16_f32 v57, v246, v247
  ds_write_b64 v20, v[56:57] offset:32
  s_add_u32 s101, s3, 1548288
  s_add_u32 m0, s91, 16384
  s_nop 0
  buffer_load_dwordx4 v46, s[36:39], s101 offen offset:0 lds
  v_pk_mul_f32 v[248:249], v[60:61], v[34:35] op_sel_hi:[1,0]
  v_pk_mul_f32 v[250:251], v[62:63], v[34:35] op_sel_hi:[1,0]
  v_pk_fma_f32 v[60:61], v[60:61], v[32:33], 1.0 op_sel_hi:[1,0,0]
  v_pk_fma_f32 v[62:63], v[62:63], v[32:33], 1.0 op_sel_hi:[1,0,0]
  v_exp_f32_e64 v248, v248 clamp
  v_exp_f32_e64 v249, v249 clamp
  v_exp_f32_e64 v250, v250 clamp
  v_exp_f32_e64 v251, v251 clamp
  v_max_f32 v248, v248, v60
  v_max_f32 v249, v249, v61
  v_max_f32 v250, v250, v62
  v_max_f32 v251, v251, v63
  v_pk_add_f32 v[248:249], v[248:249], s[84:85] op_sel_hi:[1,0]
  buffer_load_dwordx4 v47, s[36:39], s101 offen offset:1024 lds
  v_pk_add_f32 v[250:251], v[250:251], s[84:85] op_sel_hi:[1,0]
  v_cvt_pk_bf16_f32 v60, v248, v249
  v_cvt_pk_bf16_f32 v61, v250, v251
  ds_write_b64 v20, v[60:61] offset:48
  v_pk_mul_f32 v[244:245], v[64:65], v[34:35] op_sel_hi:[1,0]
  v_pk_mul_f32 v[246:247], v[66:67], v[34:35] op_sel_hi:[1,0]
  v_pk_fma_f32 v[64:65], v[64:65], v[32:33], 1.0 op_sel_hi:[1,0,0]
  v_pk_fma_f32 v[66:67], v[66:67], v[32:33], 1.0 op_sel_hi:[1,0,0]
  v_exp_f32_e64 v244, v244 clamp
  v_exp_f32_e64 v245, v245 clamp
  v_exp_f32_e64 v246, v246 clamp
  v_exp_f32_e64 v247, v247 clamp
  v_max_f32 v244, v244, v64
  v_max_f32 v245, v245, v65
  s_add_u32 s101, s3, 1769472
  s_add_u32 m0, s91, 24576
  s_nop 0
  buffer_load_dwordx4 v46, s[36:39], s101 offen offset:0 lds
  v_max_f32 v246, v246, v66
  v_max_f32 v247, v247, v67
  v_pk_add_f32 v[244:245], v[244:245], s[84:85] op_sel_hi:[1,0]
  v_pk_add_f32 v[246:247], v[246:247], s[84:85] op_sel_hi:[1,0]
  v_cvt_pk_bf16_f32 v64, v244, v245
  v_cvt_pk_bf16_f32 v65, v246, v247
  ds_write_b64 v20, v[64:65] offset:64
  v_pk_mul_f32 v[248:249], v[68:69], v[34:35] op_sel_hi:[1,0]
  v_pk_mul_f32 v[250:251], v[70:71], v[34:35] op_sel_hi:[1,0]
  v_pk_fma_f32 v[68:69], v[68:69], v[32:33], 1.0 op_sel_hi:[1,0,0]
  v_pk_fma_f32 v[70:71], v[70:71], v[32:33], 1.0 op_sel_hi:[1,0,0]
  v_exp_f32_e64 v248, v248 clamp
  v_exp_f32_e64 v249, v249 clamp
  buffer_load_dwordx4 v47, s[36:39], s101 offen offset:1024 lds
  v_exp_f32_e64 v250, v250 clamp
  v_exp_f32_e64 v251, v251 clamp
  v_max_f32 v248, v248, v68
  v_max_f32 v249, v249, v69
  v_max_f32 v250, v250, v70
  v_max_f32 v251, v251, v71
  v_pk_add_f32 v[248:249], v[248:249], s[84:85] op_sel_hi:[1,0]
  v_pk_add_f32 v[250:251], v[250:251], s[84:85] op_sel_hi:[1,0]
  v_cvt_pk_bf16_f32 v68, v248, v249
  v_cvt_pk_bf16_f32 v69, v250, v251
  ds_write_b64 v20, v[68:69] offset:80
  v_pk_mul_f32 v[244:245], v[72:73], v[34:35] op_sel_hi:[1,0]
  v_pk_mul_f32 v[246:247], v[74:75], v[34:35] op_sel_hi:[1,0]
  v_pk_fma_f32 v[72:73], v[72:73], v[32:33], 1.0 op_sel_hi:[1,0,0]
  s_add_u32 s101, s3, 1990656
  s_add_u32 m0, s91, 32768
  s_nop 0
  buffer_load_dwordx4 v46, s[36:39], s101 offen offset:0 lds
  v_pk_fma_f32 v[74:75], v[74:75], v[32:33], 1.0 op_sel_hi:[1,0,0]
  v_exp_f32_e64 v244, v244 clamp
  v_exp_f32_e64 v245, v245 clamp
  v_exp_f32_e64 v246, v246 clamp
  v_exp_f32_e64 v247, v247 clamp
  v_max_f32 v244, v244, v72
  v_max_f32 v245, v245, v73
  v_max_f32 v246, v246, v74
  v_max_f32 v247, v247, v75
  v_pk_add_f32 v[244:245], v[244:245], s[84:85] op_sel_hi:[1,0]
  v_pk_add_f32 v[246:247], v[246:247], s[84:85] op_sel_hi:[1,0]
  v_cvt_pk_bf16_f32 v72, v244, v245
  v_cvt_pk_bf16_f32 v73, v246, v247
  buffer_load_dwordx4 v47, s[36:39], s101 offen offset:1024 lds
  s_waitcnt lgkmcnt(8)
  ds_write_b64 v20, v[72:73] offset:96
  v_pk_mul_f32 v[248:249], v[76:77], v[34:35] op_sel_hi:[1,0]
  v_pk_mul_f32 v[250:251], v[78:79], v[34:35] op_sel_hi:[1,0]
  v_pk_fma_f32 v[76:77], v[76:77], v[32:33], 1.0 op_sel_hi:[1,0,0]
  v_pk_fma_f32 v[78:79], v[78:79], v[32:33], 1.0 op_sel_hi:[1,0,0]
  v_exp_f32_e64 v248, v248 clamp
  v_exp_f32_e64 v249, v249 clamp
  v_exp_f32_e64 v250, v250 clamp
  v_exp_f32_e64 v251, v251 clamp
  v_max_f32 v248, v248, v76
  v_max_f32 v249, v249, v77
  v_max_f32 v250, v250, v78
  v_max_f32 v251, v251, v79
  s_add_u32 m0, s94, 143360
  s_nop 0
  buffer_load_dwordx4 v180, s[44:47], s21 offen offset:0 lds
  v_pk_add_f32 v[248:249], v[248:249], s[84:85] op_sel_hi:[1,0]
  v_pk_add_f32 v[250:251], v[250:251], s[84:85] op_sel_hi:[1,0]
  v_cvt_pk_bf16_f32 v76, v248, v249
  v_cvt_pk_bf16_f32 v77, v250, v251
  ds_write_b64 v20, v[76:77] offset:112
  v_pk_mul_f32 v[244:245], v[80:81], v[34:35] op_sel_hi:[1,0]
  v_pk_mul_f32 v[246:247], v[82:83], v[34:35] op_sel_hi:[1,0]
  v_pk_fma_f32 v[80:81], v[80:81], v[32:33], 1.0 op_sel_hi:[1,0,0]
  v_pk_fma_f32 v[82:83], v[82:83], v[32:33], 1.0 op_sel_hi:[1,0,0]
  v_exp_f32_e64 v244, v244 clamp
  v_exp_f32_e64 v245, v245 clamp
  v_exp_f32_e64 v246, v246 clamp
  v_exp_f32_e64 v247, v247 clamp
  v_max_f32 v244, v244, v80
  buffer_load_dwordx4 v181, s[44:47], s21 offen offset:1024 lds
  v_max_f32 v245, v245, v81
  v_max_f32 v246, v246, v82
  v_max_f32 v247, v247, v83
  v_pk_add_f32 v[244:245], v[244:245], s[84:85] op_sel_hi:[1,0]
  v_pk_add_f32 v[246:247], v[246:247], s[84:85] op_sel_hi:[1,0]
  v_cvt_pk_bf16_f32 v80, v244, v245
  v_cvt_pk_bf16_f32 v81, v246, v247
  ds_write_b64 v20, v[80:81] offset:128
  v_pk_mul_f32 v[248:249], v[84:85], v[34:35] op_sel_hi:[1,0]
  v_pk_mul_f32 v[250:251], v[86:87], v[34:35] op_sel_hi:[1,0]
  v_pk_fma_f32 v[84:85], v[84:85], v[32:33], 1.0 op_sel_hi:[1,0,0]
  v_pk_fma_f32 v[86:87], v[86:87], v[32:33], 1.0 op_sel_hi:[1,0,0]
  v_exp_f32_e64 v248, v248 clamp
  buffer_load_dwordx4 v182, s[44:47], s21 offen offset:2048 lds
  v_exp_f32_e64 v249, v249 clamp
  v_exp_f32_e64 v250, v250 clamp
  v_exp_f32_e64 v251, v251 clamp
  v_max_f32 v248, v248, v84
  v_max_f32 v249, v249, v85
  v_max_f32 v250, v250, v86
  v_max_f32 v251, v251, v87
  v_pk_add_f32 v[248:249], v[248:249], s[84:85] op_sel_hi:[1,0]
  v_pk_add_f32 v[250:251], v[250:251], s[84:85] op_sel_hi:[1,0]
  v_cvt_pk_bf16_f32 v84, v248, v249
  v_cvt_pk_bf16_f32 v85, v250, v251
  ds_write_b64 v20, v[84:85] offset:144
  v_pk_mul_f32 v[244:245], v[88:89], v[32:33] op_sel_hi:[1,0]
  buffer_load_dwordx4 v183, s[44:47], s21 offen offset:3072 lds
  v_pk_mul_f32 v[246:247], v[90:91], v[32:33] op_sel_hi:[1,0]
  v_cvt_pk_bf16_f32 v88, v244, v245
  v_cvt_pk_bf16_f32 v89, v246, v247
  ds_write_b64 v20, v[88:89] offset:288
  v_pk_mul_f32 v[248:249], v[92:93], v[32:33] op_sel_hi:[1,0]
  v_pk_mul_f32 v[250:251], v[94:95], v[32:33] op_sel_hi:[1,0]
  v_cvt_pk_bf16_f32 v92, v248, v249
  v_cvt_pk_bf16_f32 v93, v250, v251
  ds_write_b64 v20, v[92:93] offset:304
  v_pk_mul_f32 v[244:245], v[96:97], v[32:33] op_sel_hi:[1,0]
  v_pk_mul_f32 v[246:247], v[98:99], v[32:33] op_sel_hi:[1,0]
  v_cvt_pk_bf16_f32 v96, v244, v245
  v_cvt_pk_bf16_f32 v97, v246, v247
  ds_write_b64 v20, v[96:97] offset:160
  s_add_u32 m0, s94, 147456
  s_nop 0
  buffer_load_dwordx4 v184, s[44:47], s21 offen offset:0 lds
  v_pk_mul_f32 v[248:249], v[100:101], v[32:33] op_sel_hi:[1,0]
  v_pk_mul_f32 v[250:251], v[102:103], v[32:33] op_sel_hi:[1,0]
  v_cvt_pk_bf16_f32 v100, v248, v249
  v_cvt_pk_bf16_f32 v101, v250, v251
  s_waitcnt lgkmcnt(8)
  ds_write_b64 v20, v[100:101] offset:176
  v_pk_mul_f32 v[244:245], v[104:105], v[32:33] op_sel_hi:[1,0]
  v_pk_mul_f32 v[246:247], v[106:107], v[32:33] op_sel_hi:[1,0]
  v_cvt_pk_bf16_f32 v104, v244, v245
  v_cvt_pk_bf16_f32 v105, v246, v247
  ds_write_b64 v20, v[104:105] offset:192
  v_pk_mul_f32 v[248:249], v[108:109], v[32:33] op_sel_hi:[1,0]
  v_pk_mul_f32 v[250:251], v[110:111], v[32:33] op_sel_hi:[1,0]
  v_cvt_pk_bf16_f32 v108, v248, v249
  v_cvt_pk_bf16_f32 v109, v250, v251
  ds_write_b64 v20, v[108:109] offset:208
  v_pk_mul_f32 v[244:245], v[112:113], v[32:33] op_sel_hi:[1,0]
  v_pk_mul_f32 v[246:247], v[114:115], v[32:33] op_sel_hi:[1,0]
  v_cvt_pk_bf16_f32 v112, v244, v245
  v_cvt_pk_bf16_f32 v113, v246, v247
  ds_write_b64 v20, v[112:113] offset:224
  v_pk_mul_f32 v[248:249], v[116:117], v[32:33] op_sel_hi:[1,0]
  v_pk_mul_f32 v[250:251], v[118:119], v[32:33] op_sel_hi:[1,0]
  v_cvt_pk_bf16_f32 v116, v248, v249
  v_cvt_pk_bf16_f32 v117, v250, v251
  ds_write_b64 v20, v[116:117] offset:240
  v_pk_mul_f32 v[244:245], v[120:121], v[32:33] op_sel_hi:[1,0]
  v_pk_mul_f32 v[246:247], v[122:123], v[32:33] op_sel_hi:[1,0]
  v_cvt_pk_bf16_f32 v120, v244, v245
  v_cvt_pk_bf16_f32 v121, v246, v247
  ds_write_b64 v20, v[120:121] offset:256
  v_pk_mul_f32 v[248:249], v[124:125], v[32:33] op_sel_hi:[1,0]
  v_pk_mul_f32 v[250:251], v[126:127], v[32:33] op_sel_hi:[1,0]
  v_cvt_pk_bf16_f32 v124, v248, v249
  v_cvt_pk_bf16_f32 v125, v250, v251
  ds_write_b64 v20, v[124:125] offset:272
  s_waitcnt lgkmcnt(0)
  s_barrier
  ds_read_b64_tr_b16 v[80:81], v22 offset:0
  ds_read_b64_tr_b16 v[82:83], v22 offset:1312
  ds_read_b64_tr_b16 v[84:85], v23 offset:0
  ds_read_b64_tr_b16 v[86:87], v23 offset:1312
  ds_read_b64_tr_b16 v[88:89], v22 offset:5248
  ds_read_b64_tr_b16 v[90:91], v22 offset:6560
  ds_read_b64_tr_b16 v[92:93], v23 offset:5248
  ds_read_b64_tr_b16 v[94:95], v23 offset:6560
  ds_read_b64_tr_b16 v[96:97], v22 offset:10496
  ds_read_b64_tr_b16 v[98:99], v22 offset:11808
  ds_read_b64_tr_b16 v[100:101], v23 offset:10496
  ds_read_b64_tr_b16 v[102:103], v23 offset:11808
  s_waitcnt lgkmcnt(8)
  v_mfma_f32_32x32x16_bf16 v[64:79], v[84:87], v[80:83], 0
  ds_read_b64_tr_b16 v[104:105], v22 offset:15744
  ds_read_b64_tr_b16 v[106:107], v22 offset:17056
  ds_read_b64_tr_b16 v[108:109], v23 offset:15744
  ds_read_b64_tr_b16 v[110:111], v23 offset:17056
  s_waitcnt lgkmcnt(8)
  v_mfma_f32_32x32x16_bf16 v[64:79], v[92:95], v[88:91], v[64:79]
  ds_read_b64_tr_b16 v[80:81], v22 offset:20992
  ds_read_b64_tr_b16 v[82:83], v22 offset:22304
  ds_read_b64_tr_b16 v[84:85], v23 offset:20992
  ds_read_b64_tr_b16 v[86:87], v23 offset:22304
  s_waitcnt lgkmcnt(8)
  v_mfma_f32_32x32x16_bf16 v[64:79], v[100:103], v[96:99], v[64:79]
  ds_read_b64_tr_b16 v[88:89], v22 offset:26240
  ds_read_b64_tr_b16 v[90:91], v22 offset:27552
  ds_read_b64_tr_b16 v[92:93], v23 offset:26240
  ds_read_b64_tr_b16 v[94:95], v23 offset:27552
  s_waitcnt lgkmcnt(8)
  v_mfma_f32_32x32x16_bf16 v[64:79], v[108:111], v[104:107], v[64:79]
  ds_read_b64_tr_b16 v[96:97], v22 offset:31488
  ds_read_b64_tr_b16 v[98:99], v22 offset:32800
  ds_read_b64_tr_b16 v[100:101], v23 offset:31488
  ds_read_b64_tr_b16 v[102:103], v23 offset:32800
  s_waitcnt lgkmcnt(8)
  v_mfma_f32_32x32x16_bf16 v[64:79], v[84:87], v[80:83], v[64:79]
  ds_read_b64_tr_b16 v[104:105], v22 offset:36736
  ds_read_b64_tr_b16 v[106:107], v22 offset:38048
  ds_read_b64_tr_b16 v[108:109], v23 offset:36736
  ds_read_b64_tr_b16 v[110:111], v23 offset:38048
  s_waitcnt lgkmcnt(8)
  v_mfma_f32_32x32x16_bf16 v[64:79], v[92:95], v[88:91], v[64:79]
  s_waitcnt lgkmcnt(4)
  v_mfma_f32_32x32x16_bf16 v[64:79], v[100:103], v[96:99], v[64:79]
  s_waitcnt lgkmcnt(0)
  v_mfma_f32_32x32x16_bf16 v[64:79], v[108:111], v[104:107], v[64:79]
  s_nop 11
  v_cvt_pk_bf16_f32 v64, v64, v65
  v_cvt_pk_bf16_f32 v65, v66, v67
  buffer_store_dwordx2 v[64:65], v24, s[48:51], 0 offen offset:0 sc1
  v_cvt_pk_bf16_f32 v68, v68, v69
  v_cvt_pk_bf16_f32 v69, v70, v71
  buffer_store_dwordx2 v[68:69], v24, s[48:51], 0 offen offset:384 sc1
  v_cvt_pk_bf16_f32 v72, v72, v73
  v_cvt_pk_bf16_f32 v73, v74, v75
  buffer_store_dwordx2 v[72:73], v24, s[48:51], 0 offen offset:768 sc1
  v_mfma_f32_32x32x16_bf16 v[128:143], a[180:183], a[0:3], 0
  ds_read_b64_tr_b16 a[168:169], v213 offset:10240
  ds_read_b64_tr_b16 a[170:171], v213 offset:10752
  v_mfma_f32_32x32x16_bf16 v[128:143], a[184:187], a[4:7], v[128:143]
  ds_read_b64_tr_b16 a[172:173], v213 offset:12288
  ds_read_b64_tr_b16 a[174:175], v213 offset:12800
  v_mfma_f32_32x32x16_bf16 v[128:143], a[188:191], a[8:11], v[128:143]
  ds_read_b64_tr_b16 a[176:177], v213 offset:14336
  ds_read_b64_tr_b16 a[178:179], v213 offset:14848
  s_waitcnt vmcnt(24)
  s_barrier
  v_mfma_f32_32x32x16_bf16 v[128:143], a[160:163], a[12:15], v[128:143]
  ds_read_b64_tr_b16 a[180:181], v212 offset:16384
  ds_read_b64_tr_b16 a[182:183], v212 offset:16896
  v_mfma_f32_32x32x16_bf16 v[144:159], a[164:167], a[0:3], 0
  ds_read_b64_tr_b16 a[184:185], v212 offset:18432
  ds_read_b64_tr_b16 a[186:187], v212 offset:18944
  s_waitcnt lgkmcnt(6)
  v_mfma_f32_32x32x16_bf16 v[144:159], a[168:171], a[4:7], v[144:159]
  ds_read_b64_tr_b16 a[188:189], v212 offset:20480
  ds_read_b64_tr_b16 a[190:191], v212 offset:20992
  v_mfma_f32_32x32x16_bf16 v[144:159], a[172:175], a[8:11], v[144:159]
  ds_read_b64_tr_b16 a[160:161], v212 offset:22528
  ds_read_b64_tr_b16 a[162:163], v212 offset:23040
  s_waitcnt lgkmcnt(6)
  v_mfma_f32_32x32x16_bf16 v[144:159], a[176:179], a[12:15], v[144:159]
  ds_read_b64_tr_b16 a[164:165], v213 offset:16384
  ds_read_b64_tr_b16 a[166:167], v213 offset:16896
  s_add_u32 s14, s21, 40960
  s_add_u32 m0, s94, 81920
  v_mfma_f32_32x32x16_bf16 v[128:143], a[180:183], a[16:19], v[128:143]
  ds_read_b64_tr_b16 a[168:169], v213 offset:18432
  ds_read_b64_tr_b16 a[170:171], v213 offset:18944
  buffer_load_dwordx4 v180, s[44:47], s14 offen offset:0 lds
  s_waitcnt lgkmcnt(6)
  v_mfma_f32_32x32x16_bf16 v[128:143], a[184:187], a[20:23], v[128:143]
  ds_read_b64_tr_b16 a[172:173], v213 offset:20480
  ds_read_b64_tr_b16 a[174:175], v213 offset:20992
  v_mfma_f32_32x32x16_bf16 v[128:143], a[188:191], a[24:27], v[128:143]
  ds_read_b64_tr_b16 a[176:177], v213 offset:22528
  ds_read_b64_tr_b16 a[178:179], v213 offset:23040
  buffer_load_dwordx4 v181, s[44:47], s14 offen offset:1024 lds
  s_waitcnt vmcnt(24)
  s_barrier
  s_waitcnt lgkmcnt(6)
  v_mfma_f32_32x32x16_bf16 v[128:143], a[160:163], a[28:31], v[128:143]
  ds_read_b64_tr_b16 a[180:181], v212 offset:24576
  ds_read_b64_tr_b16 a[182:183], v212 offset:25088
  v_mfma_f32_32x32x16_bf16 v[144:159], a[164:167], a[16:19], v[144:159]
  ds_read_b64_tr_b16 a[184:185], v212 offset:26624
  ds_read_b64_tr_b16 a[186:187], v212 offset:27136
  buffer_load_dwordx4 v182, s[44:47], s14 offen offset:2048 lds
  s_waitcnt lgkmcnt(6)
  v_mfma_f32_32x32x16_bf16 v[144:159], a[168:171], a[20:23], v[144:159]
  ds_read_b64_tr_b16 a[188:189], v212 offset:28672
  ds_read_b64_tr_b16 a[190:191], v212 offset:29184
  v_mfma_f32_32x32x16_bf16 v[144:159], a[172:175], a[24:27], v[144:159]
  ds_read_b64_tr_b16 a[160:161], v212 offset:30720
  ds_read_b64_tr_b16 a[162:163], v212 offset:31232
  buffer_load_dwordx4 v183, s[44:47], s14 offen offset:3072 lds
  s_waitcnt lgkmcnt(6)
  v_mfma_f32_32x32x16_bf16 v[144:159], a[176:179], a[28:31], v[144:159]
  ds_read_b64_tr_b16 a[164:165], v213 offset:24576
  ds_read_b64_tr_b16 a[166:167], v213 offset:25088
  s_add_u32 m0, s94, 86016
  v_mfma_f32_32x32x16_bf16 v[128:143], a[180:183], a[32:35], v[128:143]
  ds_read_b64_tr_b16 a[168:169], v213 offset:26624
  ds_read_b64_tr_b16 a[170:171], v213 offset:27136
  buffer_load_dwordx4 v184, s[44:47], s14 offen offset:0 lds
  s_waitcnt lgkmcnt(6)
  v_mfma_f32_32x32x16_bf16 v[128:143], a[184:187], a[36:39], v[128:143]
  ds_read_b64_tr_b16 a[172:173], v213 offset:28672
  ds_read_b64_tr_b16 a[174:175], v213 offset:29184
  s_add_u32 s14, s21, 81920
  s_add_u32 m0, s94, 102400
  v_mfma_f32_32x32x16_bf16 v[128:143], a[188:191], a[40:43], v[128:143]
  ds_read_b64_tr_b16 a[176:177], v213 offset:30720
  ds_read_b64_tr_b16 a[178:179], v213 offset:31232
  buffer_load_dwordx4 v180, s[44:47], s14 offen offset:0 lds
  s_waitcnt vmcnt(26)
  s_barrier
  s_waitcnt lgkmcnt(6)
  v_mfma_f32_32x32x16_bf16 v[128:143], a[160:163], a[44:47], v[128:143]
  ds_read_b64_tr_b16 a[180:181], v212 offset:32768
  ds_read_b64_tr_b16 a[182:183], v212 offset:33280
  v_mfma_f32_32x32x16_bf16 v[144:159], a[164:167], a[32:35], v[144:159]
  ds_read_b64_tr_b16 a[184:185], v212 offset:34816
  ds_read_b64_tr_b16 a[186:187], v212 offset:35328
  buffer_load_dwordx4 v181, s[44:47], s14 offen offset:1024 lds
  s_waitcnt vmcnt(10)
  ds_read_b64_tr_b16 a[0:1], v191 offset:12288
  s_waitcnt vmcnt(7)
  s_mov_b64 exec, 1
  ds_add_rtn_u32 v26, v200, v201 offset:8
  s_mov_b64 exec, -1
  s_waitcnt lgkmcnt(8)
  v_mfma_f32_32x32x16_bf16 v[144:159], a[168:171], a[36:39], v[144:159]
  ds_read_b64_tr_b16 a[188:189], v212 offset:36864
  ds_read_b64_tr_b16 a[190:191], v212 offset:37376
  ds_read_b64_tr_b16 a[2:3], v191 offset:13568
  v_mfma_f32_32x32x16_bf16 v[144:159], a[172:175], a[40:43], v[144:159]
  ds_read_b64_tr_b16 a[160:161], v212 offset:38912
  ds_read_b64_tr_b16 a[162:163], v212 offset:39424
  buffer_load_dwordx4 v182, s[44:47], s14 offen offset:2048 lds
  ds_read_b64_tr_b16 a[4:5], v191 offset:12320
  s_waitcnt lgkmcnt(10)
  v_mfma_f32_32x32x16_bf16 v[144:159], a[176:179], a[44:47], v[144:159]
  ds_read_b64_tr_b16 a[164:165], v213 offset:32768
  ds_read_b64_tr_b16 a[166:167], v213 offset:33280
  ds_read_b64_tr_b16 a[6:7], v191 offset:13600
  s_waitcnt lgkmcnt(9)
  v_readfirstlane_b32 s82, v26
  s_nop 0
  s_cmp_lg_u32 s82, 3
  s_cbranch_scc1 L_sig29
  s_add_u32 s82, s74, 2
  v_mov_b32 v26, s82
  s_mov_b32 s82, 5308416
  buffer_store_dword v26, v206, s[48:51], s82 offen sc1
L_sig29:
  v_mfma_f32_32x32x16_bf16 v[128:143], a[180:183], a[48:51], v[128:143]
  ds_read_b64_tr_b16 a[168:169], v213 offset:34816
  ds_read_b64_tr_b16 a[170:171], v213 offset:35328
  buffer_load_dwordx4 v183, s[44:47], s14 offen offset:3072 lds
  ds_read_b64_tr_b16 a[8:9], v191 offset:12352
  s_waitcnt lgkmcnt(10)
  v_mfma_f32_32x32x16_bf16 v[128:143], a[184:187], a[52:55], v[128:143]
  ds_read_b64_tr_b16 a[172:173], v213 offset:36864
  ds_read_b64_tr_b16 a[174:175], v213 offset:37376
  ds_read_b64_tr_b16 a[10:11], v191 offset:13632
  s_add_u32 m0, s94, 106496
  v_mfma_f32_32x32x16_bf16 v[128:143], a[188:191], a[56:59], v[128:143]
  ds_read_b64_tr_b16 a[176:177], v213 offset:38912
  ds_read_b64_tr_b16 a[178:179], v213 offset:39424
  buffer_load_dwordx4 v184, s[44:47], s14 offen offset:0 lds
  s_waitcnt lgkmcnt(8)
  ds_read_b64_tr_b16 a[12:13], v191 offset:12384
  s_barrier
  v_mfma_f32_32x32x16_bf16 v[128:143], a[160:163], a[60:63], v[128:143]
  ds_read_b64_tr_b16 a[180:181], v212 offset:40960
  ds_read_b64_tr_b16 a[182:183], v212 offset:41472
  ds_read_b64_tr_b16 a[14:15], v191 offset:13664
  v_mfma_f32_32x32x16_bf16 v[144:159], a[164:167], a[48:51], v[144:159]
  ds_read_b64_tr_b16 a[184:185], v212 offset:43008
  ds_read_b64_tr_b16 a[186:187], v212 offset:43520
  ds_read_b64_tr_b16 a[16:17], v191 offset:12416
  s_waitcnt lgkmcnt(10)
  v_mfma_f32_32x32x16_bf16 v[144:159], a[168:171], a[52:55], v[144:159]
  ds_read_b64_tr_b16 a[188:189], v212 offset:45056
  ds_read_b64_tr_b16 a[190:191], v212 offset:45568
  ds_read_b64_tr_b16 a[18:19], v191 offset:13696
  v_mfma_f32_32x32x16_bf16 v[144:159], a[172:175], a[56:59], v[144:159]
  ds_read_b64_tr_b16 a[160:161], v212 offset:47104
  ds_read_b64_tr_b16 a[162:163], v212 offset:47616
  s_waitcnt lgkmcnt(9)
  v_mfma_f32_32x32x16_bf16 v[144:159], a[176:179], a[60:63], v[144:159]
  ds_read_b64_tr_b16 a[164:165], v213 offset:40960
  ds_read_b64_tr_b16 a[166:167], v213 offset:41472
  s_add_u32 s14, s21, 122880
  s_add_u32 m0, s94, 40960
  v_mfma_f32_32x32x16_bf16 v[128:143], a[180:183], a[64:67], v[128:143]
  ds_read_b64_tr_b16 a[168:169], v213 offset:43008
  ds_read_b64_tr_b16 a[170:171], v213 offset:43520
  buffer_load_dwordx4 v180, s[44:47], s14 offen offset:0 lds
  s_waitcnt lgkmcnt(7)
  v_mfma_f32_32x32x16_bf16 v[128:143], a[184:187], a[68:71], v[128:143]
  ds_read_b64_tr_b16 a[172:173], v213 offset:45056
  ds_read_b64_tr_b16 a[174:175], v213 offset:45568
  buffer_load_dwordx4 v181, s[44:47], s14 offen offset:1024 lds
  v_mfma_f32_32x32x16_bf16 v[128:143], a[188:191], a[72:75], v[128:143]
  ds_read_b64_tr_b16 a[176:177], v213 offset:47104
  ds_read_b64_tr_b16 a[178:179], v213 offset:47616
  s_barrier
  s_waitcnt lgkmcnt(6)
  v_mfma_f32_32x32x16_bf16 v[128:143], a[160:163], a[76:79], v[128:143]
  ds_read_b64_tr_b16 a[180:181], v214 offset:0
  ds_read_b64_tr_b16 a[182:183], v214 offset:512
  buffer_load_dwordx4 v182, s[44:47], s14 offen offset:2048 lds
  v_mfma_f32_32x32x16_bf16 v[144:159], a[164:167], a[64:67], v[144:159]
  ds_read_b64_tr_b16 a[184:185], v214 offset:2048
  ds_read_b64_tr_b16 a[186:187], v214 offset:2560
  buffer_load_dwordx4 v183, s[44:47], s14 offen offset:3072 lds
  s_waitcnt lgkmcnt(6)
  v_mfma_f32_32x32x16_bf16 v[144:159], a[168:171], a[68:71], v[144:159]
  ds_read_b64_tr_b16 a[188:189], v214 offset:4096
  ds_read_b64_tr_b16 a[190:191], v214 offset:4608
  s_add_u32 m0, s94, 45056
  v_mfma_f32_32x32x16_bf16 v[144:159], a[172:175], a[72:75], v[144:159]
  ds_read_b64_tr_b16 a[160:161], v214 offset:6144
  ds_read_b64_tr_b16 a[162:163], v214 offset:6656
  buffer_load_dwordx4 v184, s[44:47], s14 offen offset:0 lds
  s_waitcnt lgkmcnt(6)
  v_mfma_f32_32x32x16_bf16 v[144:159], a[176:179], a[76:79], v[144:159]
  ds_read_b64_tr_b16 a[164:165], v215 offset:0
  ds_read_b64_tr_b16 a[166:167], v215 offset:512
  s_add_u32 m0, s94, 143360
  v_mfma_f32_32x32x16_bf16 v[128:143], a[180:183], a[80:83], v[128:143]
  ds_read_b64_tr_b16 a[168:169], v215 offset:2048
  ds_read_b64_tr_b16 a[170:171], v215 offset:2560
  buffer_load_dwordx4 v180, s[44:47], s23 offen offset:0 lds
  s_waitcnt lgkmcnt(6)
  v_mfma_f32_32x32x16_bf16 v[128:143], a[184:187], a[84:87], v[128:143]
  ds_read_b64_tr_b16 a[172:173], v215 offset:4096
  ds_read_b64_tr_b16 a[174:175], v215 offset:4608
  buffer_load_dwordx4 v181, s[44:47], s23 offen offset:1024 lds
  v_mfma_f32_32x32x16_bf16 v[128:143], a[188:191], a[88:91], v[128:143]
  ds_read_b64_tr_b16 a[176:177], v215 offset:6144
  ds_read_b64_tr_b16 a[178:179], v215 offset:6656
  s_barrier
  s_waitcnt lgkmcnt(6)
  v_mfma_f32_32x32x16_bf16 v[128:143], a[160:163], a[92:95], v[128:143]
  ds_read_b64_tr_b16 a[180:181], v214 offset:8192
  ds_read_b64_tr_b16 a[182:183], v214 offset:8704
  buffer_load_dwordx4 v182, s[44:47], s23 offen offset:2048 lds
  v_mfma_f32_32x32x16_bf16 v[144:159], a[164:167], a[80:83], v[144:159]
  ds_read_b64_tr_b16 a[184:185], v214 offset:10240
  ds_read_b64_tr_b16 a[186:187], v214 offset:10752
  buffer_load_dwordx4 v183, s[44:47], s23 offen offset:3072 lds
  s_waitcnt lgkmcnt(6)
  v_mfma_f32_32x32x16_bf16 v[144:159], a[168:171], a[84:87], v[144:159]
  ds_read_b64_tr_b16 a[188:189], v214 offset:12288
  ds_read_b64_tr_b16 a[190:191], v214 offset:12800
  s_add_u32 m0, s94, 147456
  v_mfma_f32_32x32x16_bf16 v[144:159], a[172:175], a[88:91], v[144:159]
  ds_read_b64_tr_b16 a[160:161], v214 offset:14336
  ds_read_b64_tr_b16 a[162:163], v214 offset:14848
  buffer_load_dwordx4 v184, s[44:47], s23 offen offset:0 lds
  s_waitcnt lgkmcnt(6)
  v_mfma_f32_32x32x16_bf16 v[144:159], a[176:179], a[92:95], v[144:159]
  ds_read_b64_tr_b16 a[164:165], v215 offset:8192
  ds_read_b64_tr_b16 a[166:167], v215 offset:8704
  s_add_u32 m0, s94, 61440
  v_mfma_f32_32x32x16_bf16 v[128:143], a[180:183], a[96:99], v[128:143]
  ds_read_b64_tr_b16 a[168:169], v215 offset:10240
  ds_read_b64_tr_b16 a[170:171], v215 offset:10752
  buffer_load_dwordx4 v180, s[44:47], s22 offen offset:0 lds
  s_waitcnt lgkmcnt(6)
  v_mfma_f32_32x32x16_bf16 v[128:143], a[184:187], a[100:103], v[128:143]
  ds_read_b64_tr_b16 a[172:173], v215 offset:12288
  ds_read_b64_tr_b16 a[174:175], v215 offset:12800
  v_mfma_f32_32x32x16_bf16 v[128:143], a[188:191], a[104:107], v[128:143]
  ds_read_b64_tr_b16 a[176:177], v215 offset:14336
  ds_read_b64_tr_b16 a[178:179], v215 offset:14848
  buffer_load_dwordx4 v181, s[44:47], s22 offen offset:1024 lds
  s_barrier
  s_waitcnt lgkmcnt(6)
  v_mfma_f32_32x32x16_bf16 v[128:143], a[160:163], a[108:111], v[128:143]
  ds_read_b64_tr_b16 a[180:181], v214 offset:16384
  ds_read_b64_tr_b16 a[182:183], v214 offset:16896
  v_mfma_f32_32x32x16_bf16 v[144:159], a[164:167], a[96:99], v[144:159]
  ds_read_b64_tr_b16 a[184:185], v214 offset:18432
  ds_read_b64_tr_b16 a[186:187], v214 offset:18944
  buffer_load_dwordx4 v182, s[44:47], s22 offen offset:2048 lds
  s_waitcnt lgkmcnt(6)
  v_mfma_f32_32x32x16_bf16 v[144:159], a[168:171], a[100:103], v[144:159]
  ds_read_b64_tr_b16 a[188:189], v214 offset:20480
  ds_read_b64_tr_b16 a[190:191], v214 offset:20992
  v_mfma_f32_32x32x16_bf16 v[144:159], a[172:175], a[104:107], v[144:159]
  ds_read_b64_tr_b16 a[160:161], v214 offset:22528
  ds_read_b64_tr_b16 a[162:163], v214 offset:23040
  s_waitcnt lgkmcnt(6)
  v_mfma_f32_32x32x16_bf16 v[144:159], a[176:179], a[108:111], v[144:159]
  ds_read_b64_tr_b16 a[164:165], v215 offset:16384
  ds_read_b64_tr_b16 a[166:167], v215 offset:16896
  buffer_load_dwordx4 v183, s[44:47], s22 offen offset:3072 lds
  v_mfma_f32_32x32x16_bf16 v[128:143], a[180:183], a[112:115], v[128:143]
  ds_read_b64_tr_b16 a[168:169], v215 offset:18432
  ds_read_b64_tr_b16 a[170:171], v215 offset:18944
  s_waitcnt vmcnt(19)
  ds_read_b64_tr_b16 a[20:21], v190 offset:16384
  s_add_u32 m0, s94, 65536
  s_waitcnt lgkmcnt(7)
  v_mfma_f32_32x32x16_bf16 v[128:143], a[184:187], a[116:119], v[128:143]
  ds_read_b64_tr_b16 a[172:173], v215 offset:20480
  ds_read_b64_tr_b16 a[174:175], v215 offset:20992
  buffer_load_dwordx4 v184, s[44:47], s22 offen offset:0 lds
  ds_read_b64_tr_b16 a[22:23], v190 offset:17664
  v_mfma_f32_32x32x16_bf16 v[128:143], a[188:191], a[120:123], v[128:143]
  ds_read_b64_tr_b16 a[176:177], v215 offset:22528
  ds_read_b64_tr_b16 a[178:179], v215 offset:23040
  ds_read_b64_tr_b16 a[24:25], v190 offset:16416
  s_barrier
  s_waitcnt lgkmcnt(9)
  v_mfma_f32_32x32x16_bf16 v[128:143], a[160:163], a[124:127], v[128:143]
  ds_read_b64_tr_b16 a[180:181], v214 offset:24576
  ds_read_b64_tr_b16 a[182:183], v214 offset:25088
  ds_read_b64_tr_b16 a[26:27], v190 offset:17696
  v_mfma_f32_32x32x16_bf16 v[144:159], a[164:167], a[112:115], v[144:159]
  ds_read_b64_tr_b16 a[184:185], v214 offset:26624
  ds_read_b64_tr_b16 a[186:187], v214 offset:27136
  ds_read_b64_tr_b16 a[28:29], v190 offset:16448
  s_waitcnt lgkmcnt(10)
  v_mfma_f32_32x32x16_bf16 v[144:159], a[168:171], a[116:119], v[144:159]
  ds_read_b64_tr_b16 a[188:189], v214 offset:28672
  ds_read_b64_tr_b16 a[190:191], v214 offset:29184
  ds_read_b64_tr_b16 a[30:31], v190 offset:17728
  v_mfma_f32_32x32x16_bf16 v[144:159], a[172:175], a[120:123], v[144:159]
  ds_read_b64_tr_b16 a[160:161], v214 offset:30720
  ds_read_b64_tr_b16 a[162:163], v214 offset:31232
  s_waitcnt lgkmcnt(8)
  ds_read_b64_tr_b16 a[32:33], v190 offset:16480
  v_mfma_f32_32x32x16_bf16 v[144:159], a[176:179], a[124:127], v[144:159]
  ds_read_b64_tr_b16 a[164:165], v215 offset:24576
  ds_read_b64_tr_b16 a[166:167], v215 offset:25088
  ds_read_b64_tr_b16 a[34:35], v190 offset:17760
  v_mfma_f32_32x32x16_bf16 v[128:143], a[180:183], a[128:131], v[128:143]
  ds_read_b64_tr_b16 a[168:169], v215 offset:26624
  ds_read_b64_tr_b16 a[170:171], v215 offset:27136
  ds_read_b64_tr_b16 a[36:37], v190 offset:16512
  s_waitcnt lgkmcnt(10)
  v_mfma_f32_32x32x16_bf16 v[128:143], a[184:187], a[132:135], v[128:143]
  ds_read_b64_tr_b16 a[172:173], v215 offset:28672
  ds_read_b64_tr_b16 a[174:175], v215 offset:29184
  ds_read_b64_tr_b16 a[38:39], v190 offset:17792
  v_mfma_f32_32x32x16_bf16 v[128:143], a[188:191], a[136:139], v[128:143]
  ds_read_b64_tr_b16 a[176:177], v215 offset:30720
  ds_read_b64_tr_b16 a[178:179], v215 offset:31232
  s_barrier
  s_waitcnt lgkmcnt(9)
  v_mfma_f32_32x32x16_bf16 v[128:143], a[160:163], a[140:143], v[128:143]
  ds_read_b64_tr_b16 a[180:181], v214 offset:32768
  ds_read_b64_tr_b16 a[182:183], v214 offset:33280
  s_add_u32 s14, s22, 40960
  s_add_u32 m0, s94, 81920
  v_mfma_f32_32x32x16_bf16 v[144:159], a[164:167], a[128:131], v[144:159]
  ds_read_b64_tr_b16 a[184:185], v214 offset:34816
  ds_read_b64_tr_b16 a[186:187], v214 offset:35328
  s_waitcnt lgkmcnt(6)
  buffer_load_dwordx4 v180, s[44:47], s14 offen offset:0 lds
  v_mfma_f32_32x32x16_bf16 v[144:159], a[168:171], a[132:135], v[144:159]
  ds_read_b64_tr_b16 a[188:189], v214 offset:36864
  ds_read_b64_tr_b16 a[190:191], v214 offset:37376
  v_mfma_f32_32x32x16_bf16 v[144:159], a[172:175], a[136:139], v[144:159]
  ds_read_b64_tr_b16 a[160:161], v214 offset:38912
  ds_read_b64_tr_b16 a[162:163], v214 offset:39424
  buffer_load_dwordx4 v181, s[44:47], s14 offen offset:1024 lds
  s_waitcnt lgkmcnt(6)
  v_mfma_f32_32x32x16_bf16 v[144:159], a[176:179], a[140:143], v[144:159]
  ds_read_b128 a[164:167], v19 offset:2560
  s_waitcnt vmcnt(17)
  ds_read_b64_tr_b16 a[40:41], v190 offset:36864
  v_mfma_f32_32x32x16_bf16 v[128:143], a[180:183], a[144:147], v[128:143]
  ds_read_b64_tr_b16 a[168:169], v215 offset:32768
  ds_read_b64_tr_b16 a[170:171], v215 offset:33280
  ds_read_b64_tr_b16 a[42:43], v190 offset:38144
  buffer_load_dwordx4 v182, s[44:47], s14 offen offset:2048 lds
  s_waitcnt lgkmcnt(7)
  v_mfma_f32_32x32x16_bf16 v[128:143], a[184:187], a[148:151], v[128:143]
  ds_read_b64_tr_b16 a[172:173], v215 offset:34816
  ds_read_b64_tr_b16 a[174:175], v215 offset:35328
  ds_read_b64_tr_b16 a[44:45], v190 offset:36896
  v_mfma_f32_32x32x16_bf16 v[128:143], a[188:191], a[152:155], v[128:143]
  ds_read_b64_tr_b16 a[176:177], v215 offset:36864
  ds_read_b64_tr_b16 a[178:179], v215 offset:37376
  ds_read_b64_tr_b16 a[46:47], v190 offset:38176
  s_waitcnt lgkmcnt(10)
  v_mfma_f32_32x32x16_bf16 v[128:143], a[160:163], a[156:159], v[128:143]
  ds_read_b64_tr_b16 a[180:181], v215 offset:38912
  ds_read_b64_tr_b16 a[182:183], v215 offset:39424
  ds_read_b64_tr_b16 a[48:49], v190 offset:36928
  buffer_load_dwordx4 v183, s[44:47], s14 offen offset:3072 lds
  v_mfma_f32_32x32x16_bf16 v[128:143], a[164:167], v[40:43], v[128:143]
  ds_read_b128 a[184:187], v19 offset:3072
  ds_read_b64_tr_b16 a[50:51], v190 offset:38208
  s_add_u32 m0, s94, 86016
  s_waitcnt lgkmcnt(9)
  v_mfma_f32_32x32x16_bf16 v[144:159], a[168:171], a[144:147], v[144:159]
  ds_read_b64_tr_b16 a[52:53], v190 offset:36960
  buffer_load_dwordx4 v184, s[44:47], s14 offen offset:0 lds
  v_mfma_f32_32x32x16_bf16 v[144:159], a[172:175], a[148:151], v[144:159]
  ds_read_b64_tr_b16 a[54:55], v190 offset:38240
  s_waitcnt lgkmcnt(5)
  v_mfma_f32_32x32x16_bf16 v[144:159], a[176:179], a[152:155], v[144:159]
  ds_read_b64_tr_b16 a[56:57], v190 offset:36992
  v_mfma_f32_32x32x16_bf16 v[144:159], a[180:183], a[156:159], v[144:159]
  ds_read_b64_tr_b16 a[58:59], v190 offset:38272
  s_waitcnt lgkmcnt(5)
  v_mfma_f32_32x32x16_bf16 v[144:159], a[184:187], v[40:43], v[144:159]
  s_barrier
  s_waitcnt vmcnt(15)
  ds_read_b64_tr_b16 a[60:61], v189 offset:40960
  v_pk_mul_f32 v[244:245], v[128:129], v[128:129]
  v_pk_mul_f32 v[246:247], v[130:131], v[130:131]
  v_pk_fma_f32 v[244:245], v[244:245], v[38:39], v[36:37] op_sel_hi:[1,0,0]
  v_pk_fma_f32 v[246:247], v[246:247], v[38:39], v[36:37] op_sel_hi:[1,0,0]
  v_pk_mul_f32 v[244:245], v[244:245], v[128:129]
  v_pk_mul_f32 v[246:247], v[246:247], v[130:131]
  ds_read_b64_tr_b16 a[62:63], v189 offset:42240
  v_exp_f32 v244, v244
  v_exp_f32 v245, v245
  v_exp_f32 v246, v246
  v_exp_f32 v247, v247
  v_pk_fma_f32 v[244:245], v[244:245], v[44:45], v[44:45] op_sel_hi:[1,0,0]
  ds_read_b64_tr_b16 a[64:65], v189 offset:40992
  v_pk_fma_f32 v[246:247], v[246:247], v[44:45], v[44:45] op_sel_hi:[1,0,0]
  v_rcp_f32 v244, v244
  v_rcp_f32 v245, v245
  v_rcp_f32 v246, v246
  v_rcp_f32 v247, v247
  v_pk_mul_f32 v[244:245], v[244:245], v[128:129]
  ds_read_b64_tr_b16 a[66:67], v189 offset:42272
  v_pk_mul_f32 v[246:247], v[246:247], v[130:131]
  v_cvt_pk_bf16_f32 v128, v244, v245
  v_cvt_pk_bf16_f32 v129, v246, v247
  v_pk_mul_f32 v[248:249], v[132:133], v[132:133]
  v_pk_mul_f32 v[250:251], v[134:135], v[134:135]
  ds_read_b64_tr_b16 a[68:69], v189 offset:41024
  v_pk_fma_f32 v[248:249], v[248:249], v[38:39], v[36:37] op_sel_hi:[1,0,0]
  v_pk_fma_f32 v[250:251], v[250:251], v[38:39], v[36:37] op_sel_hi:[1,0,0]
  v_pk_mul_f32 v[248:249], v[248:249], v[132:133]
  v_pk_mul_f32 v[250:251], v[250:251], v[134:135]
  v_exp_f32 v248, v248
  v_exp_f32 v249, v249
  ds_read_b64_tr_b16 a[70:71], v189 offset:42304
  v_exp_f32 v250, v250
  v_exp_f32 v251, v251
  v_pk_fma_f32 v[248:249], v[248:249], v[44:45], v[44:45] op_sel_hi:[1,0,0]
  v_pk_fma_f32 v[250:251], v[250:251], v[44:45], v[44:45] op_sel_hi:[1,0,0]
  v_rcp_f32 v248, v248
  ds_read_b64_tr_b16 a[72:73], v189 offset:41056
  v_rcp_f32 v249, v249
  v_rcp_f32 v250, v250
  v_rcp_f32 v251, v251
  v_pk_mul_f32 v[248:249], v[248:249], v[132:133]
  v_pk_mul_f32 v[250:251], v[250:251], v[134:135]
  v_cvt_pk_bf16_f32 v130, v248, v249
  ds_read_b64_tr_b16 a[74:75], v189 offset:42336
  v_cvt_pk_bf16_f32 v131, v250, v251
  buffer_store_dwordx4 v[128:131], v15, s[48:51], s85 offen offset:0 sc1
  v_pk_mul_f32 v[244:245], v[136:137], v[136:137]
  v_pk_mul_f32 v[246:247], v[138:139], v[138:139]
  v_pk_fma_f32 v[244:245], v[244:245], v[38:39], v[36:37] op_sel_hi:[1,0,0]
  ds_read_b64_tr_b16 a[76:77], v189 offset:41088
  v_pk_fma_f32 v[246:247], v[246:247], v[38:39], v[36:37] op_sel_hi:[1,0,0]
  v_pk_mul_f32 v[244:245], v[244:245], v[136:137]
  v_pk_mul_f32 v[246:247], v[246:247], v[138:139]
  v_exp_f32 v244, v244
  v_exp_f32 v245, v245
  v_exp_f32 v246, v246
  ds_read_b64_tr_b16 a[78:79], v189 offset:42368
  v_exp_f32 v247, v247
  v_pk_fma_f32 v[244:245], v[244:245], v[44:45], v[44:45] op_sel_hi:[1,0,0]
  v_pk_fma_f32 v[246:247], v[246:247], v[44:45], v[44:45] op_sel_hi:[1,0,0]
  v_rcp_f32 v244, v244
  v_rcp_f32 v245, v245
  s_waitcnt vmcnt(11) lgkmcnt(8)
  ds_read_b64_tr_b16 a[80:81], v191 offset:12288
  v_rcp_f32 v246, v246
  v_rcp_f32 v247, v247
  v_pk_mul_f32 v[244:245], v[244:245], v[136:137]
  v_pk_mul_f32 v[246:247], v[246:247], v[138:139]
  v_cvt_pk_bf16_f32 v136, v244, v245
  v_cvt_pk_bf16_f32 v137, v246, v247
  ds_read_b64_tr_b16 a[82:83], v191 offset:13568
  v_pk_mul_f32 v[248:249], v[140:141], v[140:141]
  v_pk_mul_f32 v[250:251], v[142:143], v[142:143]
  v_pk_fma_f32 v[248:249], v[248:249], v[38:39], v[36:37] op_sel_hi:[1,0,0]
  v_pk_fma_f32 v[250:251], v[250:251], v[38:39], v[36:37] op_sel_hi:[1,0,0]
  v_pk_mul_f32 v[248:249], v[248:249], v[140:141]
  ds_read_b64_tr_b16 a[84:85], v191 offset:12320
  v_pk_mul_f32 v[250:251], v[250:251], v[142:143]
  v_exp_f32 v248, v248
  v_exp_f32 v249, v249
  v_exp_f32 v250, v250
  v_exp_f32 v251, v251
  v_pk_fma_f32 v[248:249], v[248:249], v[44:45], v[44:45] op_sel_hi:[1,0,0]
  ds_read_b64_tr_b16 a[86:87], v191 offset:13600
  v_pk_fma_f32 v[250:251], v[250:251], v[44:45], v[44:45] op_sel_hi:[1,0,0]
  v_rcp_f32 v248, v248
  v_rcp_f32 v249, v249
  v_rcp_f32 v250, v250
  v_rcp_f32 v251, v251
  ds_read_b64_tr_b16 a[88:89], v191 offset:12352
  v_pk_mul_f32 v[248:249], v[248:249], v[140:141]
  v_pk_mul_f32 v[250:251], v[250:251], v[142:143]
  v_cvt_pk_bf16_f32 v138, v248, v249
  v_cvt_pk_bf16_f32 v139, v250, v251
  buffer_store_dwordx4 v[136:139], v15, s[48:51], s85 offen offset:512 sc1
  ds_read_b64_tr_b16 a[90:91], v191 offset:13632
  v_pk_mul_f32 v[244:245], v[144:145], v[144:145]
  v_pk_mul_f32 v[246:247], v[146:147], v[146:147]
  v_pk_fma_f32 v[244:245], v[244:245], v[38:39], v[36:37] op_sel_hi:[1,0,0]
  v_pk_fma_f32 v[246:247], v[246:247], v[38:39], v[36:37] op_sel_hi:[1,0,0]
  v_pk_mul_f32 v[244:245], v[244:245], v[144:145]
  v_pk_mul_f32 v[246:247], v[246:247], v[146:147]
  ds_read_b64_tr_b16 a[92:93], v191 offset:12384
  v_exp_f32 v244, v244
  v_exp_f32 v245, v245
  v_exp_f32 v246, v246
  v_exp_f32 v247, v247
  v_pk_fma_f32 v[244:245], v[244:245], v[44:45], v[44:45] op_sel_hi:[1,0,0]
  s_waitcnt lgkmcnt(8)
  ds_read_b64_tr_b16 a[94:95], v191 offset:13664
  v_pk_fma_f32 v[246:247], v[246:247], v[44:45], v[44:45] op_sel_hi:[1,0,0]
  v_rcp_f32 v244, v244
  v_rcp_f32 v245, v245
  v_rcp_f32 v246, v246
  v_rcp_f32 v247, v247
  v_pk_mul_f32 v[244:245], v[244:245], v[144:145]
  ds_read_b64_tr_b16 a[96:97], v191 offset:12416
  v_pk_mul_f32 v[246:247], v[246:247], v[146:147]
  v_cvt_pk_bf16_f32 v144, v244, v245
  v_cvt_pk_bf16_f32 v145, v246, v247
  v_pk_mul_f32 v[248:249], v[148:149], v[148:149]
  v_pk_mul_f32 v[250:251], v[150:151], v[150:151]
  ds_read_b64_tr_b16 a[98:99], v191 offset:13696
  v_pk_fma_f32 v[248:249], v[248:249], v[38:39], v[36:37] op_sel_hi:[1,0,0]
  v_pk_fma_f32 v[250:251], v[250:251], v[38:39], v[36:37] op_sel_hi:[1,0,0]
  v_pk_mul_f32 v[248:249], v[248:249], v[148:149]
  v_pk_mul_f32 v[250:251], v[250:251], v[150:151]
  v_exp_f32 v248, v248
  v_exp_f32 v249, v249
  s_waitcnt vmcnt(7)
  ds_read_b64_tr_b16 a[100:101], v189 offset:61440
  v_exp_f32 v250, v250
  v_exp_f32 v251, v251
  v_pk_fma_f32 v[248:249], v[248:249], v[44:45], v[44:45] op_sel_hi:[1,0,0]
  v_pk_fma_f32 v[250:251], v[250:251], v[44:45], v[44:45] op_sel_hi:[1,0,0]
  v_rcp_f32 v248, v248
  ds_read_b64_tr_b16 a[102:103], v189 offset:62720
  v_rcp_f32 v249, v249
  v_rcp_f32 v250, v250
  v_rcp_f32 v251, v251
  v_pk_mul_f32 v[248:249], v[248:249], v[148:149]
  v_pk_mul_f32 v[250:251], v[250:251], v[150:151]
  v_cvt_pk_bf16_f32 v146, v248, v249
  ds_read_b64_tr_b16 a[104:105], v189 offset:61472
  v_cvt_pk_bf16_f32 v147, v250, v251
  buffer_store_dwordx4 v[144:147], v15, s[48:51], s85 offen offset:1024 sc1
  v_pk_mul_f32 v[244:245], v[152:153], v[152:153]
  v_pk_mul_f32 v[246:247], v[154:155], v[154:155]
  v_pk_fma_f32 v[244:245], v[244:245], v[38:39], v[36:37] op_sel_hi:[1,0,0]
  ds_read_b64_tr_b16 a[106:107], v189 offset:62752
  v_pk_fma_f32 v[246:247], v[246:247], v[38:39], v[36:37] op_sel_hi:[1,0,0]
  v_pk_mul_f32 v[244:245], v[244:245], v[152:153]
  v_pk_mul_f32 v[246:247], v[246:247], v[154:155]
  v_exp_f32 v244, v244
  v_exp_f32 v245, v245
  v_exp_f32 v246, v246
  s_waitcnt lgkmcnt(8)
  ds_read_b64_tr_b16 a[108:109], v189 offset:61504
  v_exp_f32 v247, v247
  v_pk_fma_f32 v[244:245], v[244:245], v[44:45], v[44:45] op_sel_hi:[1,0,0]
  v_pk_fma_f32 v[246:247], v[246:247], v[44:45], v[44:45] op_sel_hi:[1,0,0]
  v_rcp_f32 v244, v244
  v_rcp_f32 v245, v245
  ds_read_b64_tr_b16 a[110:111], v189 offset:62784
  v_rcp_f32 v246, v246
  v_rcp_f32 v247, v247
  v_pk_mul_f32 v[244:245], v[244:245], v[152:153]
  v_pk_mul_f32 v[246:247], v[246:247], v[154:155]
  v_cvt_pk_bf16_f32 v152, v244, v245
  v_cvt_pk_bf16_f32 v153, v246, v247
  ds_read_b64_tr_b16 a[112:113], v189 offset:61536
  v_pk_mul_f32 v[248:249], v[156:157], v[156:157]
  v_pk_mul_f32 v[250:251], v[158:159], v[158:159]
  v_pk_fma_f32 v[248:249], v[248:249], v[38:39], v[36:37] op_sel_hi:[1,0,0]
  v_pk_fma_f32 v[250:251], v[250:251], v[38:39], v[36:37] op_sel_hi:[1,0,0]
  v_pk_mul_f32 v[248:249], v[248:249], v[156:157]
  ds_read_b64_tr_b16 a[114:115], v189 offset:62816
  v_pk_mul_f32 v[250:251], v[250:251], v[158:159]
  v_exp_f32 v248, v248
  v_exp_f32 v249, v249
  v_exp_f32 v250, v250
  v_exp_f32 v251, v251
  v_pk_fma_f32 v[248:249], v[248:249], v[44:45], v[44:45] op_sel_hi:[1,0,0]
  ds_read_b64_tr_b16 a[116:117], v189 offset:61568
  v_pk_fma_f32 v[250:251], v[250:251], v[44:45], v[44:45] op_sel_hi:[1,0,0]
  v_rcp_f32 v248, v248
  v_rcp_f32 v249, v249
  v_rcp_f32 v250, v250
  v_rcp_f32 v251, v251
  ds_read_b64_tr_b16 a[118:119], v189 offset:62848
  v_pk_mul_f32 v[248:249], v[248:249], v[156:157]
  v_pk_mul_f32 v[250:251], v[250:251], v[158:159]
  v_cvt_pk_bf16_f32 v154, v248, v249
  v_cvt_pk_bf16_f32 v155, v250, v251
  buffer_store_dwordx4 v[152:155], v15, s[48:51], s85 offen offset:1536 sc1
  s_waitcnt vmcnt(4)
  ds_read_b64_tr_b16 a[120:121], v190 offset:16384
  s_waitcnt lgkmcnt(8)
  ds_read_b64_tr_b16 a[122:123], v190 offset:17664
  ds_read_b64_tr_b16 a[124:125], v190 offset:16416
  ds_read_b64_tr_b16 a[126:127], v190 offset:17696
  ds_read_b64_tr_b16 a[128:129], v190 offset:16448
  ds_read_b64_tr_b16 a[130:131], v190 offset:17728
  ds_read_b64_tr_b16 a[132:133], v190 offset:16480
  ds_read_b64_tr_b16 a[134:135], v190 offset:17760
  s_waitcnt lgkmcnt(8)
  ds_read_b64_tr_b16 a[136:137], v190 offset:16512
  ds_read_b64_tr_b16 a[138:139], v190 offset:17792
  s_add_u32 s14, s24, 163840
  s_add_u32 m0, s94, 102400
  s_nop 0
  buffer_load_dwordx4 v180, s[40:43], s14 offen offset:0 lds
  buffer_load_dwordx4 v181, s[40:43], s14 offen offset:1024 lds
  s_waitcnt vmcnt(2)
  s_mov_b64 exec, 1
  ds_add_rtn_u32 v26, v200, v201 offset:16
  s_mov_b64 exec, -1
  s_waitcnt lgkmcnt(0)
  v_readfirstlane_b32 s82, v26
  s_nop 0
  s_cmp_lg_u32 s82, 3
  s_cbranch_scc1 L_sig16
  s_add_u32 s82, s74, 4
  v_mov_b32 v26, s82
  s_mov_b32 s82, 5373952
  buffer_store_dword v26, v206, s[48:51], s82 offen sc1
L_sig16:
  buffer_load_dwordx4 v182, s[40:43], s14 offen offset:2048 lds
  buffer_load_dwordx4 v183, s[40:43], s14 offen offset:3072 lds
  s_add_u32 m0, s94, 106496
  s_nop 0
  buffer_load_dwordx4 v184, s[40:43], s14 offen offset:0 lds
  s_add_u32 s14, s24, 327680
  s_add_u32 m0, s94, 40960
  s_nop 0
  buffer_load_dwordx4 v180, s[40:43], s14 offen offset:0 lds
  buffer_load_dwordx4 v181, s[40:43], s14 offen offset:1024 lds
  buffer_load_dwordx4 v182, s[40:43], s14 offen offset:2048 lds
  buffer_load_dwordx4 v183, s[40:43], s14 offen offset:3072 lds
  s_add_u32 m0, s94, 45056
  s_nop 0
  buffer_load_dwordx4 v184, s[40:43], s14 offen offset:0 lds
  s_add_u32 s14, s24, 491520
  s_add_u32 m0, s94, 61440
  s_nop 0
  buffer_load_dwordx4 v180, s[40:43], s14 offen offset:0 lds
  buffer_load_dwordx4 v181, s[40:43], s14 offen offset:1024 lds
  buffer_load_dwordx4 v182, s[40:43], s14 offen offset:2048 lds
  buffer_load_dwordx4 v183, s[40:43], s14 offen offset:3072 lds
  s_add_u32 m0, s94, 65536
  s_nop 0
  buffer_load_dwordx4 v184, s[40:43], s14 offen offset:0 lds
  s_add_u32 m0, s94, 81920
  s_nop 0
  buffer_load_dwordx4 v180, s[40:43], s24 offen offset:0 lds
  buffer_load_dwordx4 v181, s[40:43], s24 offen offset:1024 lds
  buffer_load_dwordx4 v182, s[40:43], s24 offen offset:2048 lds
  buffer_load_dwordx4 v183, s[40:43], s24 offen offset:3072 lds
  s_add_u32 m0, s94, 86016
  s_nop 0
  buffer_load_dwordx4 v184, s[40:43], s24 offen offset:0 lds
  s_mov_b32 s82, 5308416
  buffer_load_dword v27, v205, s[48:51], s82 offen sc1
  s_add_u32 s82, s74, 2
  s_waitcnt vmcnt(0)
  v_cmp_ne_u32 vcc, s82, v27
  s_nop 0
  s_cbranch_vccnz L_slow17
L_back18:
  buffer_load_dwordx4 a[196:199], v3, s[48:51], s17 offen offset:0 sc1
  buffer_load_dwordx4 a[200:203], v4, s[48:51], s17 offen offset:0 sc1
  buffer_load_dwordx4 a[204:207], v5, s[48:51], s17 offen offset:0 sc1
  buffer_load_dwordx4 a[192:195], v2, s[48:51], s17 offen offset:0 sc1
  buffer_load_dwordx4 a[212:215], v3, s[48:51], s17 offen offset:1024 sc1
  buffer_load_dwordx4 a[216:219], v4, s[48:51], s17 offen offset:1024 sc1
  buffer_load_dwordx4 a[220:223], v5, s[48:51], s17 offen offset:1024 sc1
  buffer_load_dwordx4 a[208:211], v2, s[48:51], s17 offen offset:1024 sc1
  buffer_load_dwordx4 a[228:231], v3, s[48:51], s17 offen offset:2048 sc1
  buffer_load_dwordx4 a[232:235], v4, s[48:51], s17 offen offset:2048 sc1
  buffer_load_dwordx4 a[236:239], v5, s[48:51], s17 offen offset:2048 sc1
  buffer_load_dwordx4 a[224:227], v2, s[48:51], s17 offen offset:2048 sc1
  buffer_load_dwordx4 a[244:247], v3, s[48:51], s17 offen offset:3072 sc1
  buffer_load_dwordx4 a[248:251], v4, s[48:51], s17 offen offset:3072 sc1
  buffer_load_dwordx4 a[252:255], v5, s[48:51], s17 offen offset:3072 sc1
  buffer_load_dwordx4 a[240:243], v2, s[48:51], s17 offen offset:3072 sc1
  s_waitcnt vmcnt(15)
  v_mfma_f32_16x16x32_bf16 v[68:71], a[0:3], a[196:199], 0
  v_mfma_f32_16x16x32_bf16 v[72:75], a[4:7], a[196:199], 0
  v_mfma_f32_16x16x32_bf16 v[76:79], a[8:11], a[196:199], 0
  v_mfma_f32_16x16x32_bf16 v[80:83], a[12:15], a[196:199], 0
  v_mfma_f32_16x16x32_bf16 v[84:87], a[16:19], a[196:199], 0
  buffer_load_dwordx4 a[196:199], v3, s[48:51], s19 offen offset:0 sc1
  s_waitcnt vmcnt(15)
  v_mfma_f32_16x16x32_bf16 v[88:91], a[0:3], a[200:203], 0
  v_mfma_f32_16x16x32_bf16 v[92:95], a[4:7], a[200:203], 0
  v_mfma_f32_16x16x32_bf16 v[96:99], a[8:11], a[200:203], 0
  v_mfma_f32_16x16x32_bf16 v[100:103], a[12:15], a[200:203], 0
  v_mfma_f32_16x16x32_bf16 v[104:107], a[16:19], a[200:203], 0
  buffer_load_dwordx4 a[200:203], v4, s[48:51], s19 offen offset:0 sc1
  s_waitcnt vmcnt(15)
  v_mfma_f32_16x16x32_bf16 v[108:111], a[0:3], a[204:207], 0
  v_mfma_f32_16x16x32_bf16 v[208:211], a[4:7], a[204:207], 0
  v_mfma_f32_16x16x32_bf16 v[212:215], a[8:11], a[204:207], 0
  v_mfma_f32_16x16x32_bf16 v[216:219], a[12:15], a[204:207], 0
  v_mfma_f32_16x16x32_bf16 v[220:223], a[16:19], a[204:207], 0
  buffer_load_dwordx4 a[204:207], v5, s[48:51], s19 offen offset:0 sc1
  s_waitcnt vmcnt(15)
  v_mfma_f32_16x16x32_bf16 v[48:51], a[0:3], a[192:195], 0
  v_mfma_f32_16x16x32_bf16 v[52:55], a[4:7], a[192:195], 0
  v_mfma_f32_16x16x32_bf16 v[56:59], a[8:11], a[192:195], 0
  v_mfma_f32_16x16x32_bf16 v[60:63], a[12:15], a[192:195], 0
  v_mfma_f32_16x16x32_bf16 v[64:67], a[16:19], a[192:195], 0
  buffer_load_dwordx4 a[192:195], v2, s[48:51], s19 offen offset:0 sc1
  s_waitcnt vmcnt(15)
  v_mfma_f32_16x16x32_bf16 v[68:71], a[20:23], a[212:215], v[68:71]
  v_mfma_f32_16x16x32_bf16 v[72:75], a[24:27], a[212:215], v[72:75]
  v_mfma_f32_16x16x32_bf16 v[76:79], a[28:31], a[212:215], v[76:79]
  v_mfma_f32_16x16x32_bf16 v[80:83], a[32:35], a[212:215], v[80:83]
  s_mov_b32 s82, 5373952
  buffer_load_dword v27, v33, s[48:51], s82 offen sc1
  v_mfma_f32_16x16x32_bf16 v[84:87], a[36:39], a[212:215], v[84:87]
  buffer_load_dwordx4 a[212:215], v186, s[48:51], s17 offen offset:0 sc1
  s_waitcnt vmcnt(16)
  v_mfma_f32_16x16x32_bf16 v[88:91], a[20:23], a[216:219], v[88:91]
  v_mfma_f32_16x16x32_bf16 v[92:95], a[24:27], a[216:219], v[92:95]
  v_mfma_f32_16x16x32_bf16 v[96:99], a[28:31], a[216:219], v[96:99]
  v_mfma_f32_16x16x32_bf16 v[100:103], a[32:35], a[216:219], v[100:103]
  v_mfma_f32_16x16x32_bf16 v[104:107], a[36:39], a[216:219], v[104:107]
  buffer_load_dwordx4 a[216:219], v187, s[48:51], s17 offen offset:0 sc1
  s_waitcnt vmcnt(16)
  v_mfma_f32_16x16x32_bf16 v[108:111], a[20:23], a[220:223], v[108:111]
  v_mfma_f32_16x16x32_bf16 v[208:211], a[24:27], a[220:223], v[208:211]
  v_mfma_f32_16x16x32_bf16 v[212:215], a[28:31], a[220:223], v[212:215]
  v_mfma_f32_16x16x32_bf16 v[216:219], a[32:35], a[220:223], v[216:219]
  v_mfma_f32_16x16x32_bf16 v[220:223], a[36:39], a[220:223], v[220:223]
  buffer_load_dwordx4 a[220:223], v188, s[48:51], s17 offen offset:0 sc1
  s_waitcnt vmcnt(16)
  v_mfma_f32_16x16x32_bf16 v[48:51], a[20:23], a[208:211], v[48:51]
  v_mfma_f32_16x16x32_bf16 v[52:55], a[24:27], a[208:211], v[52:55]
  v_mfma_f32_16x16x32_bf16 v[56:59], a[28:31], a[208:211], v[56:59]
  v_mfma_f32_16x16x32_bf16 v[60:63], a[32:35], a[208:211], v[60:63]
  v_mfma_f32_16x16x32_bf16 v[64:67], a[36:39], a[208:211], v[64:67]
  buffer_load_dwordx4 a[208:211], v185, s[48:51], s17 offen offset:0 sc1
  s_waitcnt vmcnt(16)
  v_mfma_f32_16x16x32_bf16 v[68:71], a[40:43], a[228:231], v[68:71]
  v_mfma_f32_16x16x32_bf16 v[72:75], a[44:47], a[228:231], v[72:75]
  v_mfma_f32_16x16x32_bf16 v[76:79], a[48:51], a[228:231], v[76:79]
  v_mfma_f32_16x16x32_bf16 v[80:83], a[52:55], a[228:231], v[80:83]
  v_mfma_f32_16x16x32_bf16 v[84:87], a[56:59], a[228:231], v[84:87]
  buffer_load_dwordx4 a[228:231], v186, s[48:51], s17 offen offset:1024 sc1
  s_waitcnt vmcnt(16)
  v_mfma_f32_16x16x32_bf16 v[88:91], a[40:43], a[232:235], v[88:91]
  v_mfma_f32_16x16x32_bf16 v[92:95], a[44:47], a[232:235], v[92:95]
  v_mfma_f32_16x16x32_bf16 v[96:99], a[48:51], a[232:235], v[96:99]
  v_mfma_f32_16x16x32_bf16 v[100:103], a[52:55], a[232:235], v[100:103]
  v_mfma_f32_16x16x32_bf16 v[104:107], a[56:59], a[232:235], v[104:107]
  buffer_load_dwordx4 a[232:235], v187, s[48:51], s17 offen offset:1024 sc1
  s_waitcnt vmcnt(16)
  v_mfma_f32_16x16x32_bf16 v[108:111], a[40:43], a[236:239], v[108:111]
  v_mfma_f32_16x16x32_bf16 v[208:211], a[44:47], a[236:239], v[208:211]
  v_mfma_f32_16x16x32_bf16 v[212:215], a[48:51], a[236:239], v[212:215]
  v_mfma_f32_16x16x32_bf16 v[216:219], a[52:55], a[236:239], v[216:219]
  v_mfma_f32_16x16x32_bf16 v[220:223], a[56:59], a[236:239], v[220:223]
  buffer_load_dwordx4 a[236:239], v188, s[48:51], s17 offen offset:1024 sc1
  s_waitcnt vmcnt(16)
  v_mfma_f32_16x16x32_bf16 v[48:51], a[40:43], a[224:227], v[48:51]
  v_mfma_f32_16x16x32_bf16 v[52:55], a[44:47], a[224:227], v[52:55]
  v_mfma_f32_16x16x32_bf16 v[56:59], a[48:51], a[224:227], v[56:59]
  v_mfma_f32_16x16x32_bf16 v[60:63], a[52:55], a[224:227], v[60:63]
  v_mfma_f32_16x16x32_bf16 v[64:67], a[56:59], a[224:227], v[64:67]
  buffer_load_dwordx4 a[224:227], v185, s[48:51], s17 offen offset:1024 sc1
  s_waitcnt vmcnt(16)
  v_mfma_f32_16x16x32_bf16 v[68:71], a[60:63], a[244:247], v[68:71]
  v_mfma_f32_16x16x32_bf16 v[72:75], a[64:67], a[244:247], v[72:75]
  v_mfma_f32_16x16x32_bf16 v[76:79], a[68:71], a[244:247], v[76:79]
  v_mfma_f32_16x16x32_bf16 v[80:83], a[72:75], a[244:247], v[80:83]
  s_add_u32 s82, s74, 4
  s_waitcnt vmcnt(8)
  v_cmp_ne_u32 vcc, s82, v27
  s_nop 0
  s_cbranch_vccnz L_slow20
L_back21:
  v_mfma_f32_16x16x32_bf16 v[84:87], a[76:79], a[244:247], v[84:87]
  buffer_load_dwordx4 a[244:247], v3, s[48:51], s18 offen offset:0 sc1
  v_mfma_f32_16x16x32_bf16 v[88:91], a[60:63], a[248:251], v[88:91]
  v_mfma_f32_16x16x32_bf16 v[92:95], a[64:67], a[248:251], v[92:95]
  v_mfma_f32_16x16x32_bf16 v[96:99], a[68:71], a[248:251], v[96:99]
  v_mfma_f32_16x16x32_bf16 v[100:103], a[72:75], a[248:251], v[100:103]
  v_mfma_f32_16x16x32_bf16 v[104:107], a[76:79], a[248:251], v[104:107]
  buffer_load_dwordx4 a[248:251], v4, s[48:51], s18 offen offset:0 sc1
  v_mfma_f32_16x16x32_bf16 v[108:111], a[60:63], a[252:255], v[108:111]
  v_mfma_f32_16x16x32_bf16 v[208:211], a[64:67], a[252:255], v[208:211]
  v_mfma_f32_16x16x32_bf16 v[212:215], a[68:71], a[252:255], v[212:215]
  v_mfma_f32_16x16x32_bf16 v[216:219], a[72:75], a[252:255], v[216:219]
  v_mfma_f32_16x16x32_bf16 v[220:223], a[76:79], a[252:255], v[220:223]
  buffer_load_dwordx4 a[252:255], v5, s[48:51], s18 offen offset:0 sc1
  v_mfma_f32_16x16x32_bf16 v[48:51], a[60:63], a[240:243], v[48:51]
  v_mfma_f32_16x16x32_bf16 v[52:55], a[64:67], a[240:243], v[52:55]
  v_mfma_f32_16x16x32_bf16 v[56:59], a[68:71], a[240:243], v[56:59]
  v_mfma_f32_16x16x32_bf16 v[60:63], a[72:75], a[240:243], v[60:63]
  v_mfma_f32_16x16x32_bf16 v[64:67], a[76:79], a[240:243], v[64:67]
  buffer_load_dwordx4 a[240:243], v2, s[48:51], s18 offen offset:0 sc1
  v_mfma_f32_16x16x32_bf16 v[68:71], a[80:83], a[196:199], v[68:71]
  v_mfma_f32_16x16x32_bf16 v[72:75], a[84:87], a[196:199], v[72:75]
  v_mfma_f32_16x16x32_bf16 v[76:79], a[88:91], a[196:199], v[76:79]
  v_mfma_f32_16x16x32_bf16 v[80:83], a[92:95], a[196:199], v[80:83]
  v_mfma_f32_16x16x32_bf16 v[84:87], a[96:99], a[196:199], v[84:87]
  buffer_load_dwordx4 a[196:199], v3, s[48:51], s18 offen offset:1024 sc1
  v_mfma_f32_16x16x32_bf16 v[88:91], a[80:83], a[200:203], v[88:91]
  v_mfma_f32_16x16x32_bf16 v[92:95], a[84:87], a[200:203], v[92:95]
  v_mfma_f32_16x16x32_bf16 v[96:99], a[88:91], a[200:203], v[96:99]
  v_mfma_f32_16x16x32_bf16 v[100:103], a[92:95], a[200:203], v[100:103]
  v_mfma_f32_16x16x32_bf16 v[104:107], a[96:99], a[200:203], v[104:107]
  buffer_load_dwordx4 a[200:203], v4, s[48:51], s18 offen offset:1024 sc1
  v_mfma_f32_16x16x32_bf16 v[108:111], a[80:83], a[204:207], v[108:111]
  v_mfma_f32_16x16x32_bf16 v[208:211], a[84:87], a[204:207], v[208:211]
  v_mfma_f32_16x16x32_bf16 v[212:215], a[88:91], a[204:207], v[212:215]
  v_mfma_f32_16x16x32_bf16 v[216:219], a[92:95], a[204:207], v[216:219]
  v_mfma_f32_16x16x32_bf16 v[220:223], a[96:99], a[204:207], v[220:223]
  buffer_load_dwordx4 a[204:207], v5, s[48:51], s18 offen offset:1024 sc1
  v_mfma_f32_16x16x32_bf16 v[48:51], a[80:83], a[192:195], v[48:51]
  v_mfma_f32_16x16x32_bf16 v[52:55], a[84:87], a[192:195], v[52:55]
  v_mfma_f32_16x16x32_bf16 v[56:59], a[88:91], a[192:195], v[56:59]
  v_mfma_f32_16x16x32_bf16 v[60:63], a[92:95], a[192:195], v[60:63]
  v_mfma_f32_16x16x32_bf16 v[64:67], a[96:99], a[192:195], v[64:67]
  buffer_load_dwordx4 a[192:195], v2, s[48:51], s18 offen offset:1024 sc1
  s_waitcnt vmcnt(15)
  v_mfma_f32_16x16x32_bf16 a[140:143], a[0:3], a[212:215], 0
  v_mfma_f32_16x16x32_bf16 a[144:147], a[4:7], a[212:215], 0
  v_mfma_f32_16x16x32_bf16 a[148:151], a[8:11], a[212:215], 0
  v_mfma_f32_16x16x32_bf16 a[152:155], a[12:15], a[212:215], 0
  v_mfma_f32_16x16x32_bf16 a[156:159], a[16:19], a[212:215], 0
  buffer_load_dwordx4 a[212:215], v186, s[48:51], s17 offen offset:2048 sc1
  s_waitcnt vmcnt(15)
  v_mfma_f32_16x16x32_bf16 a[160:163], a[0:3], a[216:219], 0
  v_mfma_f32_16x16x32_bf16 a[164:167], a[4:7], a[216:219], 0
  v_mfma_f32_16x16x32_bf16 a[168:171], a[8:11], a[216:219], 0
  v_mfma_f32_16x16x32_bf16 a[172:175], a[12:15], a[216:219], 0
  v_mfma_f32_16x16x32_bf16 a[176:179], a[16:19], a[216:219], 0
  buffer_load_dwordx4 a[216:219], v187, s[48:51], s17 offen offset:2048 sc1
  s_waitcnt vmcnt(15)
  v_mfma_f32_16x16x32_bf16 a[180:183], a[0:3], a[220:223], 0
  v_mfma_f32_16x16x32_bf16 a[184:187], a[4:7], a[220:223], 0
  v_mfma_f32_16x16x32_bf16 a[188:191], a[8:11], a[220:223], 0
  v_mfma_f32_16x16x32_bf16 v[6:9], a[12:15], a[220:223], 0
  v_mfma_f32_16x16x32_bf16 v[10:13], a[16:19], a[220:223], 0
  buffer_load_dwordx4 a[220:223], v188, s[48:51], s17 offen offset:2048 sc1
  s_waitcnt vmcnt(15)
  v_mfma_f32_16x16x32_bf16 v[224:227], a[0:3], a[208:211], v[224:227]
  v_mfma_f32_16x16x32_bf16 v[228:231], a[4:7], a[208:211], v[228:231]
  v_mfma_f32_16x16x32_bf16 v[232:235], a[8:11], a[208:211], v[232:235]
  v_mfma_f32_16x16x32_bf16 v[236:239], a[12:15], a[208:211], v[236:239]
  v_mfma_f32_16x16x32_bf16 v[240:243], a[16:19], a[208:211], v[240:243]
  buffer_load_dwordx4 a[208:211], v185, s[48:51], s17 offen offset:2048 sc1
  s_waitcnt vmcnt(15)
  v_mfma_f32_16x16x32_bf16 a[140:143], a[20:23], a[228:231], a[140:143]
  v_mfma_f32_16x16x32_bf16 a[144:147], a[24:27], a[228:231], a[144:147]
  v_mfma_f32_16x16x32_bf16 a[148:151], a[28:31], a[228:231], a[148:151]
  v_mfma_f32_16x16x32_bf16 a[152:155], a[32:35], a[228:231], a[152:155]
  v_mfma_f32_16x16x32_bf16 a[156:159], a[36:39], a[228:231], a[156:159]
  buffer_load_dwordx4 a[228:231], v186, s[48:51], s17 offen offset:3072 sc1
  s_waitcnt vmcnt(15)
  v_mfma_f32_16x16x32_bf16 a[160:163], a[20:23], a[232:235], a[160:163]
  v_mfma_f32_16x16x32_bf16 a[164:167], a[24:27], a[232:235], a[164:167]
  v_mfma_f32_16x16x32_bf16 a[168:171], a[28:31], a[232:235], a[168:171]
  v_mfma_f32_16x16x32_bf16 a[172:175], a[32:35], a[232:235], a[172:175]
  v_mfma_f32_16x16x32_bf16 a[176:179], a[36:39], a[232:235], a[176:179]
  buffer_load_dwordx4 a[232:235], v187, s[48:51], s17 offen offset:3072 sc1
  s_waitcnt vmcnt(15)
  v_mfma_f32_16x16x32_bf16 a[180:183], a[20:23], a[236:239], a[180:183]
  v_mfma_f32_16x16x32_bf16 a[184:187], a[24:27], a[236:239], a[184:187]
  v_mfma_f32_16x16x32_bf16 a[188:191], a[28:31], a[236:239], a[188:191]
  v_mfma_f32_16x16x32_bf16 v[6:9], a[32:35], a[236:239], v[6:9]
  v_mfma_f32_16x16x32_bf16 v[10:13], a[36:39], a[236:239], v[10:13]
  buffer_load_dwordx4 a[236:239], v188, s[48:51], s17 offen offset:3072 sc1
  s_waitcnt vmcnt(15)
  v_mfma_f32_16x16x32_bf16 v[224:227], a[20:23], a[224:227], v[224:227]
  v_mfma_f32_16x16x32_bf16 v[228:231], a[24:27], a[224:227], v[228:231]
  v_mfma_f32_16x16x32_bf16 v[232:235], a[28:31], a[224:227], v[232:235]
  v_mfma_f32_16x16x32_bf16 v[236:239], a[32:35], a[224:227], v[236:239]
  v_mfma_f32_16x16x32_bf16 v[240:243], a[36:39], a[224:227], v[240:243]
  buffer_load_dwordx4 a[224:227], v185, s[48:51], s17 offen offset:3072 sc1
  s_waitcnt vmcnt(15)
  v_mfma_f32_16x16x32_bf16 v[68:71], a[100:103], a[244:247], v[68:71]
  v_mfma_f32_16x16x32_bf16 v[72:75], a[104:107], a[244:247], v[72:75]
  v_mfma_f32_16x16x32_bf16 v[76:79], a[108:111], a[244:247], v[76:79]
  v_mfma_f32_16x16x32_bf16 v[80:83], a[112:115], a[244:247], v[80:83]
  v_mfma_f32_16x16x32_bf16 v[84:87], a[116:119], a[244:247], v[84:87]
  buffer_load_dwordx4 a[244:247], v186, s[48:51], s19 offen offset:0 sc1
  s_waitcnt vmcnt(15)
  v_mfma_f32_16x16x32_bf16 v[88:91], a[100:103], a[248:251], v[88:91]
  v_mfma_f32_16x16x32_bf16 v[92:95], a[104:107], a[248:251], v[92:95]
  v_mfma_f32_16x16x32_bf16 v[96:99], a[108:111], a[248:251], v[96:99]
  v_mfma_f32_16x16x32_bf16 v[100:103], a[112:115], a[248:251], v[100:103]
  v_mfma_f32_16x16x32_bf16 v[104:107], a[116:119], a[248:251], v[104:107]
  buffer_load_dwordx4 a[248:251], v187, s[48:51], s19 offen offset:0 sc1
  s_waitcnt vmcnt(15)
  v_mfma_f32_16x16x32_bf16 v[108:111], a[100:103], a[252:255], v[108:111]
  v_mfma_f32_16x16x32_bf16 v[208:211], a[104:107], a[252:255], v[208:211]
  v_mfma_f32_16x16x32_bf16 v[212:215], a[108:111], a[252:255], v[212:215]
  v_mfma_f32_16x16x32_bf16 v[216:219], a[112:115], a[252:255], v[216:219]
  v_mfma_f32_16x16x32_bf16 v[220:223], a[116:119], a[252:255], v[220:223]
  buffer_load_dwordx4 a[252:255], v188, s[48:51], s19 offen offset:0 sc1
  s_waitcnt vmcnt(15)
  v_mfma_f32_16x16x32_bf16 v[48:51], a[100:103], a[240:243], v[48:51]
  v_mfma_f32_16x16x32_bf16 v[52:55], a[104:107], a[240:243], v[52:55]
  v_mfma_f32_16x16x32_bf16 v[56:59], a[108:111], a[240:243], v[56:59]
  v_mfma_f32_16x16x32_bf16 v[60:63], a[112:115], a[240:243], v[60:63]
  v_mfma_f32_16x16x32_bf16 v[64:67], a[116:119], a[240:243], v[64:67]
  buffer_load_dwordx4 a[240:243], v185, s[48:51], s19 offen offset:0 sc1
  s_waitcnt vmcnt(15)
  v_mfma_f32_16x16x32_bf16 v[68:71], a[120:123], a[196:199], v[68:71]
  v_mfma_f32_16x16x32_bf16 v[72:75], a[124:127], a[196:199], v[72:75]
  v_mfma_f32_16x16x32_bf16 v[76:79], a[128:131], a[196:199], v[76:79]
  v_mfma_f32_16x16x32_bf16 v[80:83], a[132:135], a[196:199], v[80:83]
  s_mov_b32 s82, 5406720
  buffer_load_dword v27, v205, s[48:51], s82 offen sc1
  v_mfma_f32_16x16x32_bf16 v[84:87], a[136:139], a[196:199], v[84:87]
  buffer_load_dwordx4 a[196:199], v186, s[48:51], s18 offen offset:0 sc1
  s_waitcnt vmcnt(16)
  v_mfma_f32_16x16x32_bf16 v[88:91], a[120:123], a[200:203], v[88:91]
  v_mfma_f32_16x16x32_bf16 v[92:95], a[124:127], a[200:203], v[92:95]
  v_mfma_f32_16x16x32_bf16 v[96:99], a[128:131], a[200:203], v[96:99]
  v_mfma_f32_16x16x32_bf16 v[100:103], a[132:135], a[200:203], v[100:103]
  ds_write_b128 v192, v[68:71] offset:0
  ds_write_b128 v192, v[72:75] offset:1024
  ds_write_b128 v192, v[76:79] offset:2048
  v_mfma_f32_16x16x32_bf16 v[104:107], a[136:139], a[200:203], v[104:107]
  buffer_load_dwordx4 a[200:203], v187, s[48:51], s18 offen offset:0 sc1
  ds_write_b128 v192, v[80:83] offset:3072
  s_waitcnt vmcnt(16)
  v_mfma_f32_16x16x32_bf16 v[108:111], a[120:123], a[204:207], v[108:111]
  ds_write_b128 v192, v[84:87] offset:4096
  v_mfma_f32_16x16x32_bf16 v[208:211], a[124:127], a[204:207], v[208:211]
  v_mfma_f32_16x16x32_bf16 v[212:215], a[128:131], a[204:207], v[212:215]
  v_mfma_f32_16x16x32_bf16 v[216:219], a[132:135], a[204:207], v[216:219]
  ds_write_b128 v192, v[88:91] offset:20480
  ds_write_b128 v192, v[92:95] offset:21504
  ds_write_b128 v192, v[96:99] offset:22528
  v_mfma_f32_16x16x32_bf16 v[220:223], a[136:139], a[204:207], v[220:223]
  buffer_load_dwordx4 a[204:207], v188, s[48:51], s18 offen offset:0 sc1
  ds_write_b128 v192, v[100:103] offset:23552
  s_waitcnt vmcnt(16)
  v_mfma_f32_16x16x32_bf16 v[48:51], a[120:123], a[192:195], v[48:51]
  ds_write_b128 v192, v[104:107] offset:24576
  v_mfma_f32_16x16x32_bf16 v[52:55], a[124:127], a[192:195], v[52:55]
  v_mfma_f32_16x16x32_bf16 v[56:59], a[128:131], a[192:195], v[56:59]
  v_mfma_f32_16x16x32_bf16 v[60:63], a[132:135], a[192:195], v[60:63]
  ds_write_b128 v207, v[108:111] offset:12288
  ds_write_b128 v207, v[208:211] offset:13312
  ds_write_b128 v207, v[212:215] offset:14336
  v_mfma_f32_16x16x32_bf16 v[64:67], a[136:139], a[192:195], v[64:67]
  buffer_load_dwordx4 a[192:195], v185, s[48:51], s18 offen offset:0 sc1
  ds_write_b128 v207, v[216:219] offset:15360
  s_waitcnt vmcnt(16)
  v_mfma_f32_16x16x32_bf16 a[140:143], a[40:43], a[212:215], a[140:143]
  ds_write_b128 v207, v[220:223] offset:16384
  v_mfma_f32_16x16x32_bf16 a[144:147], a[44:47], a[212:215], a[144:147]
  v_mfma_f32_16x16x32_bf16 a[148:151], a[48:51], a[212:215], a[148:151]
  v_mfma_f32_16x16x32_bf16 a[152:155], a[52:55], a[212:215], a[152:155]
  v_mfma_f32_16x16x32_bf16 a[156:159], a[56:59], a[212:215], a[156:159]
  buffer_load_dwordx4 a[212:215], v186, s[48:51], s18 offen offset:1024 sc1
  s_waitcnt vmcnt(16)
  v_mfma_f32_16x16x32_bf16 a[160:163], a[40:43], a[216:219], a[160:163]
  v_mfma_f32_16x16x32_bf16 a[164:167], a[44:47], a[216:219], a[164:167]
  v_mfma_f32_16x16x32_bf16 a[168:171], a[48:51], a[216:219], a[168:171]
  s_waitcnt lgkmcnt(0)
  s_barrier
  v_mfma_f32_16x16x32_bf16 a[172:175], a[52:55], a[216:219], a[172:175]
  ds_read_b128 v[68:71], v194 offset:0
  ds_read_b128 v[72:75], v194 offset:1024
  ds_read_b128 v[76:79], v194 offset:2048
  v_mfma_f32_16x16x32_bf16 a[176:179], a[56:59], a[216:219], a[176:179]
  buffer_load_dwordx4 a[216:219], v187, s[48:51], s18 offen offset:1024 sc1
  ds_read_b128 v[80:83], v194 offset:3072
  s_waitcnt vmcnt(16)
  v_mfma_f32_16x16x32_bf16 a[180:183], a[40:43], a[220:223], a[180:183]
  ds_read_b128 v[84:87], v194 offset:4096
  ds_read_b128 v[88:91], v195 offset:0
  v_mfma_f32_16x16x32_bf16 a[184:187], a[44:47], a[220:223], a[184:187]
  ds_read_b128 v[92:95], v195 offset:1024
  ds_read_b128 v[96:99], v195 offset:2048
  ds_read_b128 v[100:103], v195 offset:3072
  v_mfma_f32_16x16x32_bf16 a[188:191], a[48:51], a[220:223], a[188:191]
  ds_read_b128 v[104:107], v195 offset:4096
  ds_read_b128 v[108:111], v196 offset:0
  v_mfma_f32_16x16x32_bf16 v[6:9], a[52:55], a[220:223], v[6:9]
  ds_read_b128 v[208:211], v196 offset:1024
  ds_read_b128 v[212:215], v196 offset:2048
  v_mfma_f32_16x16x32_bf16 v[10:13], a[56:59], a[220:223], v[10:13]
  buffer_load_dwordx4 a[220:223], v188, s[48:51], s18 offen offset:1024 sc1
  ds_read_b128 v[216:219], v196 offset:3072
  ds_read_b128 v[220:223], v196 offset:4096
  s_waitcnt vmcnt(16)
  v_mfma_f32_16x16x32_bf16 v[224:227], a[40:43], a[208:211], v[224:227]
  s_waitcnt lgkmcnt(14)
  v_add_f32 v48, v48, v68
  v_add_f32 v49, v49, v69
  v_mfma_f32_16x16x32_bf16 v[228:231], a[44:47], a[208:211], v[228:231]
  v_add_f32 v50, v50, v70
  v_add_f32 v51, v51, v71
  v_mfma_f32_16x16x32_bf16 v[232:235], a[48:51], a[208:211], v[232:235]
  s_waitcnt lgkmcnt(13)
  v_add_f32 v52, v52, v72
  v_add_f32 v53, v53, v73
  v_mfma_f32_16x16x32_bf16 v[236:239], a[52:55], a[208:211], v[236:239]
  v_add_f32 v54, v54, v74
  v_add_f32 v55, v55, v75
  s_waitcnt lgkmcnt(12)
  v_add_f32 v56, v56, v76
  v_mfma_f32_16x16x32_bf16 v[240:243], a[56:59], a[208:211], v[240:243]
  buffer_load_dwordx4 a[208:211], v185, s[48:51], s18 offen offset:1024 sc1
  v_add_f32 v57, v57, v77
  s_waitcnt vmcnt(16)
  v_mfma_f32_16x16x32_bf16 a[140:143], a[60:63], a[228:231], a[140:143]
  v_add_f32 v58, v58, v78
  v_add_f32 v59, v59, v79
  v_mfma_f32_16x16x32_bf16 a[144:147], a[64:67], a[228:231], a[144:147]
  s_waitcnt lgkmcnt(11)
  v_add_f32 v60, v60, v80
  v_add_f32 v61, v61, v81
  v_add_f32 v62, v62, v82
  v_mfma_f32_16x16x32_bf16 a[148:151], a[68:71], a[228:231], a[148:151]
  v_add_f32 v63, v63, v83
  s_waitcnt lgkmcnt(10)
  v_add_f32 v64, v64, v84
  v_mfma_f32_16x16x32_bf16 a[152:155], a[72:75], a[228:231], a[152:155]
  v_add_f32 v65, v65, v85
  v_add_f32 v66, v66, v86
  s_add_u32 s82, s74, 5
  s_waitcnt vmcnt(8)
  v_cmp_ne_u32 vcc, s82, v27
  s_nop 0
  s_cbranch_vccnz L_slow23
L_back24:
  s_add_u32 s15, s20, 0
  v_mfma_f32_16x16x32_bf16 a[156:159], a[76:79], a[228:231], a[156:159]
  buffer_load_dwordx4 a[228:231], v186, s[48:51], s15 offen offset:0 sc1
  v_add_f32 v67, v67, v87
  v_mfma_f32_16x16x32_bf16 a[160:163], a[60:63], a[232:235], a[160:163]
  s_waitcnt lgkmcnt(9)
  v_add_f32 v48, v48, v88
  v_add_f32 v49, v49, v89
  v_mfma_f32_16x16x32_bf16 a[164:167], a[64:67], a[232:235], a[164:167]
  v_add_f32 v50, v50, v90
  v_add_f32 v51, v51, v91
  v_mfma_f32_16x16x32_bf16 a[168:171], a[68:71], a[232:235], a[168:171]
  s_waitcnt lgkmcnt(8)
  v_add_f32 v52, v52, v92
  v_add_f32 v53, v53, v93
  v_mfma_f32_16x16x32_bf16 a[172:175], a[72:75], a[232:235], a[172:175]
  v_add_f32 v54, v54, v94
  v_add_f32 v55, v55, v95
  s_waitcnt lgkmcnt(7)
  v_add_f32 v56, v56, v96
  v_mfma_f32_16x16x32_bf16 a[176:179], a[76:79], a[232:235], a[176:179]
  buffer_load_dwordx4 a[232:235], v187, s[48:51], s15 offen offset:0 sc1
  v_add_f32 v57, v57, v97
  v_mfma_f32_16x16x32_bf16 a[180:183], a[60:63], a[236:239], a[180:183]
  v_add_f32 v58, v58, v98
  v_add_f32 v59, v59, v99
  v_mfma_f32_16x16x32_bf16 a[184:187], a[64:67], a[236:239], a[184:187]
  s_waitcnt lgkmcnt(6)
  v_add_f32 v60, v60, v100
  v_add_f32 v61, v61, v101
  v_add_f32 v62, v62, v102
  v_mfma_f32_16x16x32_bf16 a[188:191], a[68:71], a[236:239], a[188:191]
  v_add_f32 v63, v63, v103
  s_waitcnt lgkmcnt(5)
  v_add_f32 v64, v64, v104
  v_mfma_f32_16x16x32_bf16 v[6:9], a[72:75], a[236:239], v[6:9]
  v_add_f32 v65, v65, v105
  v_add_f32 v66, v66, v106
  v_mfma_f32_16x16x32_bf16 v[10:13], a[76:79], a[236:239], v[10:13]
  buffer_load_dwordx4 a[236:239], v188, s[48:51], s15 offen offset:0 sc1
  v_add_f32 v67, v67, v107
  s_waitcnt lgkmcnt(4)
  v_add_f32 v48, v48, v108
  v_mfma_f32_16x16x32_bf16 v[224:227], a[60:63], a[224:227], v[224:227]
  v_add_f32 v49, v49, v109
  v_add_f32 v50, v50, v110
  v_mfma_f32_16x16x32_bf16 v[228:231], a[64:67], a[224:227], v[228:231]
  v_add_f32 v51, v51, v111
  s_waitcnt lgkmcnt(3)
  v_add_f32 v52, v52, v208
  v_mfma_f32_16x16x32_bf16 v[232:235], a[68:71], a[224:227], v[232:235]
  v_add_f32 v53, v53, v209
  v_add_f32 v54, v54, v210
  v_mfma_f32_16x16x32_bf16 v[236:239], a[72:75], a[224:227], v[236:239]
  v_add_f32 v55, v55, v211
  s_waitcnt lgkmcnt(2)
  v_add_f32 v56, v56, v212
  v_add_f32 v57, v57, v213
  v_mfma_f32_16x16x32_bf16 v[240:243], a[76:79], a[224:227], v[240:243]
  buffer_load_dwordx4 a[224:227], v185, s[48:51], s15 offen offset:0 sc1
  v_add_f32 v58, v58, v214
  v_mfma_f32_16x16x32_bf16 a[140:143], a[80:83], a[244:247], a[140:143]
  v_add_f32 v59, v59, v215
  s_waitcnt lgkmcnt(1)
  v_add_f32 v60, v60, v216
  v_mfma_f32_16x16x32_bf16 a[144:147], a[84:87], a[244:247], a[144:147]
  v_add_f32 v61, v61, v217
  v_add_f32 v62, v62, v218
  v_add_f32 v63, v63, v219
  v_mfma_f32_16x16x32_bf16 a[148:151], a[88:91], a[244:247], a[148:151]
  s_waitcnt lgkmcnt(0)
  v_add_f32 v64, v64, v220
  v_add_f32 v65, v65, v221
  v_mfma_f32_16x16x32_bf16 a[152:155], a[92:95], a[244:247], a[152:155]
  v_add_f32 v66, v66, v222
  v_add_f32 v67, v67, v223
  s_add_u32 s15, s20, 4096
  v_mfma_f32_16x16x32_bf16 a[156:159], a[96:99], a[244:247], a[156:159]
  buffer_load_dwordx4 a[244:247], v186, s[48:51], s15 offen offset:0 sc1
  v_cvt_pk_bf16_f32 v68, v48, v49
  v_mfma_f32_16x16x32_bf16 a[160:163], a[80:83], a[248:251], a[160:163]
  v_cvt_pk_bf16_f32 v69, v50, v51
  v_cvt_pk_bf16_f32 v70, v52, v53
  v_mfma_f32_16x16x32_bf16 a[164:167], a[84:87], a[248:251], a[164:167]
  v_cvt_pk_bf16_f32 v71, v54, v55
  v_cvt_pk_bf16_f32 v72, v56, v57
  v_mfma_f32_16x16x32_bf16 a[168:171], a[88:91], a[248:251], a[168:171]
  v_cvt_pk_bf16_f32 v73, v58, v59
  v_cvt_pk_bf16_f32 v74, v60, v61
  v_mfma_f32_16x16x32_bf16 a[172:175], a[92:95], a[248:251], a[172:175]
  v_cvt_pk_bf16_f32 v75, v62, v63
  v_cvt_pk_bf16_f32 v76, v64, v65
  v_cvt_pk_bf16_f32 v77, v66, v67
  v_mfma_f32_16x16x32_bf16 a[176:179], a[96:99], a[248:251], a[176:179]
  buffer_load_dwordx4 a[248:251], v187, s[48:51], s15 offen offset:0 sc1
  buffer_store_dwordx4 v[68:71], v37, s[48:51], s16 offen offset:0 sc1
  v_mfma_f32_16x16x32_bf16 a[180:183], a[80:83], a[252:255], a[180:183]
  buffer_store_dwordx4 v[72:75], v37, s[48:51], s16 offen offset:1024 sc1
  buffer_store_dwordx4 v[76:79], v37, s[48:51], s16 offen offset:2048 sc1
  v_mfma_f32_16x16x32_bf16 a[184:187], a[84:87], a[252:255], a[184:187]
  v_mfma_f32_16x16x32_bf16 a[188:191], a[88:91], a[252:255], a[188:191]
  v_mfma_f32_16x16x32_bf16 v[6:9], a[92:95], a[252:255], v[6:9]
  v_mfma_f32_16x16x32_bf16 v[10:13], a[96:99], a[252:255], v[10:13]
  buffer_load_dwordx4 a[252:255], v188, s[48:51], s15 offen offset:0 sc1
  v_mfma_f32_16x16x32_bf16 v[224:227], a[80:83], a[240:243], v[224:227]
  v_add_u32 v194, 102400, v194
  v_add_u32 v195, 20480, v195
  v_mfma_f32_16x16x32_bf16 v[228:231], a[84:87], a[240:243], v[228:231]
  v_add_u32 v196, 4294885376, v196
  v_mfma_f32_16x16x32_bf16 v[232:235], a[88:91], a[240:243], v[232:235]
  v_mfma_f32_16x16x32_bf16 v[236:239], a[92:95], a[240:243], v[236:239]
  v_mfma_f32_16x16x32_bf16 v[240:243], a[96:99], a[240:243], v[240:243]
  buffer_load_dwordx4 a[240:243], v185, s[48:51], s15 offen offset:0 sc1
  s_waitcnt vmcnt(18)
  v_mfma_f32_16x16x32_bf16 a[140:143], a[100:103], a[196:199], a[140:143]
  v_mfma_f32_16x16x32_bf16 a[144:147], a[104:107], a[196:199], a[144:147]
  v_mfma_f32_16x16x32_bf16 a[148:151], a[108:111], a[196:199], a[148:151]
  v_mfma_f32_16x16x32_bf16 a[152:155], a[112:115], a[196:199], a[152:155]
  s_add_u32 s15, s20, 8192
  v_mfma_f32_16x16x32_bf16 a[156:159], a[116:119], a[196:199], a[156:159]
  buffer_load_dwordx4 a[196:199], v186, s[48:51], s15 offen offset:0 sc1
  s_waitcnt vmcnt(18)
  v_mfma_f32_16x16x32_bf16 a[160:163], a[100:103], a[200:203], a[160:163]
  v_mfma_f32_16x16x32_bf16 a[164:167], a[104:107], a[200:203], a[164:167]
  v_mfma_f32_16x16x32_bf16 a[168:171], a[108:111], a[200:203], a[168:171]
  v_mfma_f32_16x16x32_bf16 a[172:175], a[112:115], a[200:203], a[172:175]
  v_mfma_f32_16x16x32_bf16 a[176:179], a[116:119], a[200:203], a[176:179]
  buffer_load_dwordx4 a[200:203], v187, s[48:51], s15 offen offset:0 sc1
  s_waitcnt vmcnt(18)
  v_mfma_f32_16x16x32_bf16 a[180:183], a[100:103], a[204:207], a[180:183]
  v_mfma_f32_16x16x32_bf16 a[184:187], a[104:107], a[204:207], a[184:187]
  v_mfma_f32_16x16x32_bf16 a[188:191], a[108:111], a[204:207], a[188:191]
  v_mfma_f32_16x16x32_bf16 v[6:9], a[112:115], a[204:207], v[6:9]
  v_mfma_f32_16x16x32_bf16 v[10:13], a[116:119], a[204:207], v[10:13]
  buffer_load_dwordx4 a[204:207], v188, s[48:51], s15 offen offset:0 sc1
  s_waitcnt vmcnt(18)
  v_mfma_f32_16x16x32_bf16 v[224:227], a[100:103], a[192:195], v[224:227]
  v_mfma_f32_16x16x32_bf16 v[228:231], a[104:107], a[192:195], v[228:231]
  v_mfma_f32_16x16x32_bf16 v[232:235], a[108:111], a[192:195], v[232:235]
  v_mfma_f32_16x16x32_bf16 v[236:239], a[112:115], a[192:195], v[236:239]
  v_mfma_f32_16x16x32_bf16 v[240:243], a[116:119], a[192:195], v[240:243]
  buffer_load_dwordx4 a[192:195], v185, s[48:51], s15 offen offset:0 sc1
  s_waitcnt vmcnt(18)
  v_mfma_f32_16x16x32_bf16 a[140:143], a[120:123], a[212:215], a[140:143]
  ds_read_b64_tr_b16 v[112:113], v190 offset:16384
  v_mfma_f32_16x16x32_bf16 a[144:147], a[124:127], a[212:215], a[144:147]
  v_mfma_f32_16x16x32_bf16 a[148:151], a[128:131], a[212:215], a[148:151]
  ds_read_b64_tr_b16 v[114:115], v190 offset:17664
  v_mfma_f32_16x16x32_bf16 a[152:155], a[132:135], a[212:215], a[152:155]
  s_add_u32 s15, s20, 12288
  v_mfma_f32_16x16x32_bf16 a[156:159], a[136:139], a[212:215], a[156:159]
  buffer_load_dwordx4 a[212:215], v186, s[48:51], s15 offen offset:0 sc1
  ds_read_b64_tr_b16 v[116:117], v190 offset:16416
  s_waitcnt vmcnt(18)
  v_mfma_f32_16x16x32_bf16 a[160:163], a[120:123], a[216:219], a[160:163]
  v_mfma_f32_16x16x32_bf16 a[164:167], a[124:127], a[216:219], a[164:167]
  ds_read_b64_tr_b16 v[118:119], v190 offset:17696
  v_mfma_f32_16x16x32_bf16 a[168:171], a[128:131], a[216:219], a[168:171]
  v_mfma_f32_16x16x32_bf16 a[172:175], a[132:135], a[216:219], a[172:175]
  ds_read_b64_tr_b16 v[120:121], v190 offset:16448
  v_mfma_f32_16x16x32_bf16 a[176:179], a[136:139], a[216:219], a[176:179]
  buffer_load_dwordx4 a[216:219], v187, s[48:51], s15 offen offset:0 sc1
  s_waitcnt vmcnt(18)
  v_mfma_f32_16x16x32_bf16 a[180:183], a[120:123], a[220:223], a[180:183]
  ds_read_b64_tr_b16 v[122:123], v190 offset:17728
  v_mfma_f32_16x16x32_bf16 a[184:187], a[124:127], a[220:223], a[184:187]
  v_mfma_f32_16x16x32_bf16 a[188:191], a[128:131], a[220:223], a[188:191]
  ds_read_b64_tr_b16 v[124:125], v190 offset:16480
  v_mfma_f32_16x16x32_bf16 v[6:9], a[132:135], a[220:223], v[6:9]
  v_mfma_f32_16x16x32_bf16 v[10:13], a[136:139], a[220:223], v[10:13]
  buffer_load_dwordx4 a[220:223], v188, s[48:51], s15 offen offset:0 sc1
  ds_read_b64_tr_b16 v[126:127], v190 offset:17760
  s_waitcnt vmcnt(18)
  v_mfma_f32_16x16x32_bf16 v[224:227], a[120:123], a[208:211], v[224:227]
  v_mfma_f32_16x16x32_bf16 v[228:231], a[124:127], a[208:211], v[228:231]
  ds_read_b64_tr_b16 v[128:129], v190 offset:16512
  v_mfma_f32_16x16x32_bf16 v[232:235], a[128:131], a[208:211], v[232:235]
  v_mfma_f32_16x16x32_bf16 v[236:239], a[132:135], a[208:211], v[236:239]
  ds_read_b64_tr_b16 v[130:131], v190 offset:17792
  v_mfma_f32_16x16x32_bf16 v[240:243], a[136:139], a[208:211], v[240:243]
  buffer_load_dwordx4 a[208:211], v185, s[48:51], s15 offen offset:0 sc1
  s_waitcnt vmcnt(18) lgkmcnt(8)
  v_mfma_f32_16x16x32_bf16 a[140:143], v[112:115], a[228:231], a[140:143]
  ds_read_b64_tr_b16 v[132:133], v190 offset:36864
  s_add_u32 s14, s24, 655360
  s_add_u32 m0, s94, 81920
  s_waitcnt lgkmcnt(7)
  v_mfma_f32_16x16x32_bf16 a[144:147], v[116:119], a[228:231], a[144:147]
  s_waitcnt lgkmcnt(1)
  buffer_load_dwordx4 v180, s[40:43], s14 offen offset:0 lds
  v_mfma_f32_16x16x32_bf16 a[148:151], v[120:123], a[228:231], a[148:151]
  ds_read_b64_tr_b16 v[134:135], v190 offset:38144
  v_mfma_f32_16x16x32_bf16 a[152:155], v[124:127], a[228:231], a[152:155]
  s_add_u32 s15, s20, 16384
  v_mfma_f32_16x16x32_bf16 a[156:159], v[128:131], a[228:231], a[156:159]
  buffer_load_dwordx4 a[228:231], v186, s[48:51], s15 offen offset:0 sc1
  buffer_load_dwordx4 v181, s[40:43], s14 offen offset:1024 lds
  ds_read_b64_tr_b16 v[136:137], v190 offset:36896
  s_waitcnt vmcnt(20)
  v_mfma_f32_16x16x32_bf16 a[160:163], v[112:115], a[232:235], a[160:163]
  v_mfma_f32_16x16x32_bf16 a[164:167], v[116:119], a[232:235], a[164:167]
  ds_read_b64_tr_b16 v[138:139], v190 offset:38176
  s_add_u32 s82, s74, 6
  v_mov_b32 v26, s82
  s_mov_b32 s82, 5439488
  s_waitcnt vmcnt(13)
  buffer_store_dword v26, v16, s[48:51], s82 offen sc1
  v_mfma_f32_16x16x32_bf16 a[168:171], v[120:123], a[232:235], a[168:171]
  v_mfma_f32_16x16x32_bf16 a[172:175], v[124:127], a[232:235], a[172:175]
  buffer_load_dwordx4 v182, s[40:43], s14 offen offset:2048 lds
  ds_read_b64_tr_b16 v[140:141], v190 offset:36928
  v_mfma_f32_16x16x32_bf16 a[176:179], v[128:131], a[232:235], a[176:179]
  buffer_load_dwordx4 a[232:235], v187, s[48:51], s15 offen offset:0 sc1
  v_mfma_f32_16x16x32_bf16 a[180:183], v[112:115], a[236:239], a[180:183]
  ds_read_b64_tr_b16 v[142:143], v190 offset:38208
  v_mfma_f32_16x16x32_bf16 a[184:187], v[116:119], a[236:239], a[184:187]
  v_mfma_f32_16x16x32_bf16 a[188:191], v[120:123], a[236:239], a[188:191]
  buffer_load_dwordx4 v183, s[40:43], s14 offen offset:3072 lds
  ds_read_b64_tr_b16 v[144:145], v190 offset:36960
  v_mfma_f32_16x16x32_bf16 v[6:9], v[124:127], a[236:239], v[6:9]
  v_mfma_f32_16x16x32_bf16 v[10:13], v[128:131], a[236:239], v[10:13]
  buffer_load_dwordx4 a[236:239], v188, s[48:51], s15 offen offset:0 sc1
  ds_read_b64_tr_b16 v[146:147], v190 offset:38240
  v_mfma_f32_16x16x32_bf16 v[224:227], v[112:115], a[224:227], v[224:227]
  s_add_u32 m0, s94, 86016
  v_mfma_f32_16x16x32_bf16 v[228:231], v[116:119], a[224:227], v[228:231]
  buffer_load_dwordx4 v184, s[40:43], s14 offen offset:0 lds
  ds_read_b64_tr_b16 v[148:149], v190 offset:36992
  v_mfma_f32_16x16x32_bf16 v[232:235], v[120:123], a[224:227], v[232:235]
  v_mfma_f32_16x16x32_bf16 v[236:239], v[124:127], a[224:227], v[236:239]
  ds_read_b64_tr_b16 v[150:151], v190 offset:38272
  v_mfma_f32_16x16x32_bf16 v[240:243], v[128:131], a[224:227], v[240:243]
  buffer_load_dwordx4 a[224:227], v185, s[48:51], s15 offen offset:0 sc1
  s_waitcnt lgkmcnt(8)
  v_mfma_f32_16x16x32_bf16 a[140:143], v[132:135], a[244:247], a[140:143]
  ds_read_b64_tr_b16 v[112:113], v189 offset:40960
  buffer_load_dwordx4 v[152:155], v180, s[28:31], s12 offen offset:0
  s_waitcnt lgkmcnt(7)
  v_mfma_f32_16x16x32_bf16 a[144:147], v[136:139], a[244:247], a[144:147]
  s_waitcnt lgkmcnt(5)
  v_mfma_f32_16x16x32_bf16 a[148:151], v[140:143], a[244:247], a[148:151]
  ds_read_b64_tr_b16 v[114:115], v189 offset:42240
  s_waitcnt lgkmcnt(4)
  v_mfma_f32_16x16x32_bf16 a[152:155], v[144:147], a[244:247], a[152:155]
  buffer_load_dwordx4 v[156:159], v181, s[28:31], s12 offen offset:1024
  s_waitcnt lgkmcnt(2)
  v_mfma_f32_16x16x32_bf16 a[156:159], v[148:151], a[244:247], a[156:159]
  ds_read_b64_tr_b16 v[116:117], v189 offset:40992
  v_mfma_f32_16x16x32_bf16 a[160:163], v[132:135], a[248:251], a[160:163]
  v_mfma_f32_16x16x32_bf16 a[164:167], v[136:139], a[248:251], a[164:167]
  ds_read_b64_tr_b16 v[118:119], v189 offset:42272
  buffer_load_dwordx4 v[160:163], v197, s[28:31], s12 offen offset:2048
  v_mfma_f32_16x16x32_bf16 a[168:171], v[140:143], a[248:251], a[168:171]
  v_mfma_f32_16x16x32_bf16 a[172:175], v[144:147], a[248:251], a[172:175]
  ds_read_b64_tr_b16 v[120:121], v189 offset:41024
  v_mfma_f32_16x16x32_bf16 a[176:179], v[148:151], a[248:251], a[176:179]
  s_waitcnt vmcnt(22)
  v_mfma_f32_16x16x32_bf16 a[180:183], v[132:135], a[252:255], a[180:183]
  ds_read_b64_tr_b16 v[122:123], v189 offset:42304
  v_mfma_f32_16x16x32_bf16 a[184:187], v[136:139], a[252:255], a[184:187]
  v_mfma_f32_16x16x32_bf16 a[188:191], v[140:143], a[252:255], a[188:191]
  ds_read_b64_tr_b16 v[124:125], v189 offset:41056
  v_mfma_f32_16x16x32_bf16 v[6:9], v[144:147], a[252:255], v[6:9]
  v_mfma_f32_16x16x32_bf16 v[10:13], v[148:151], a[252:255], v[10:13]
  ds_read_b64_tr_b16 v[126:127], v189 offset:42336
  s_waitcnt vmcnt(21)
  v_mfma_f32_16x16x32_bf16 v[224:227], v[132:135], a[240:243], v[224:227]
  v_mfma_f32_16x16x32_bf16 v[228:231], v[136:139], a[240:243], v[228:231]
  ds_read_b64_tr_b16 v[128:129], v189 offset:41088
  v_mfma_f32_16x16x32_bf16 v[232:235], v[140:143], a[240:243], v[232:235]
  v_mfma_f32_16x16x32_bf16 v[236:239], v[144:147], a[240:243], v[236:239]
  ds_read_b64_tr_b16 v[130:131], v189 offset:42368
  v_mfma_f32_16x16x32_bf16 v[240:243], v[148:151], a[240:243], v[240:243]
  s_waitcnt vmcnt(20) lgkmcnt(8)
  v_mfma_f32_16x16x32_bf16 a[140:143], v[112:115], a[196:199], a[140:143]
  ds_read_b64_tr_b16 v[132:133], v189 offset:61440
  s_waitcnt lgkmcnt(7)
  v_mfma_f32_16x16x32_bf16 a[144:147], v[116:119], a[196:199], a[144:147]
  s_waitcnt lgkmcnt(5)
  v_mfma_f32_16x16x32_bf16 a[148:151], v[120:123], a[196:199], a[148:151]
  ds_read_b64_tr_b16 v[134:135], v189 offset:62720
  s_waitcnt lgkmcnt(4)
  v_mfma_f32_16x16x32_bf16 a[152:155], v[124:127], a[196:199], a[152:155]
  s_waitcnt lgkmcnt(2)
  v_mfma_f32_16x16x32_bf16 a[156:159], v[128:131], a[196:199], a[156:159]
  ds_read_b64_tr_b16 v[136:137], v189 offset:61472
  s_waitcnt vmcnt(19)
  v_mfma_f32_16x16x32_bf16 a[160:163], v[112:115], a[200:203], a[160:163]
  v_mfma_f32_16x16x32_bf16 a[164:167], v[116:119], a[200:203], a[164:167]
  ds_read_b64_tr_b16 v[138:139], v189 offset:62752
  v_mfma_f32_16x16x32_bf16 a[168:171], v[120:123], a[200:203], a[168:171]
  v_mfma_f32_16x16x32_bf16 a[172:175], v[124:127], a[200:203], a[172:175]
  ds_read_b64_tr_b16 v[140:141], v189 offset:61504
  v_mfma_f32_16x16x32_bf16 a[176:179], v[128:131], a[200:203], a[176:179]
  s_waitcnt vmcnt(18)
  v_mfma_f32_16x16x32_bf16 a[180:183], v[112:115], a[204:207], a[180:183]
  ds_read_b64_tr_b16 v[142:143], v189 offset:62784
  v_mfma_f32_16x16x32_bf16 a[184:187], v[116:119], a[204:207], a[184:187]
  v_mfma_f32_16x16x32_bf16 a[188:191], v[120:123], a[204:207], a[188:191]
  ds_read_b64_tr_b16 v[144:145], v189 offset:61536
  v_mfma_f32_16x16x32_bf16 v[6:9], v[124:127], a[204:207], v[6:9]
  v_mfma_f32_16x16x32_bf16 v[10:13], v[128:131], a[204:207], v[10:13]
  ds_read_b64_tr_b16 v[146:147], v189 offset:62816
  s_waitcnt vmcnt(17)
  v_mfma_f32_16x16x32_bf16 v[224:227], v[112:115], a[192:195], v[224:227]
  v_mfma_f32_16x16x32_bf16 v[228:231], v[116:119], a[192:195], v[228:231]
  ds_read_b64_tr_b16 v[148:149], v189 offset:61568
  v_mfma_f32_16x16x32_bf16 v[232:235], v[120:123], a[192:195], v[232:235]
  v_mfma_f32_16x16x32_bf16 v[236:239], v[124:127], a[192:195], v[236:239]
  ds_read_b64_tr_b16 v[150:151], v189 offset:62848
  v_mfma_f32_16x16x32_bf16 v[240:243], v[128:131], a[192:195], v[240:243]
  s_waitcnt vmcnt(16) lgkmcnt(8)
  v_mfma_f32_16x16x32_bf16 a[140:143], v[132:135], a[212:215], a[140:143]
  s_waitcnt vmcnt(4)
  ds_read_b64_tr_b16 v[112:113], v190 offset:16384
  s_waitcnt lgkmcnt(7)
  v_mfma_f32_16x16x32_bf16 a[144:147], v[136:139], a[212:215], a[144:147]
  s_waitcnt lgkmcnt(5)
  v_mfma_f32_16x16x32_bf16 a[148:151], v[140:143], a[212:215], a[148:151]
  ds_read_b64_tr_b16 v[114:115], v190 offset:17664
  s_waitcnt lgkmcnt(4)
  v_mfma_f32_16x16x32_bf16 a[152:155], v[144:147], a[212:215], a[152:155]
  s_waitcnt lgkmcnt(2)
  v_mfma_f32_16x16x32_bf16 a[156:159], v[148:151], a[212:215], a[156:159]
  ds_read_b64_tr_b16 v[116:117], v190 offset:16416
  v_mfma_f32_16x16x32_bf16 a[160:163], v[132:135], a[216:219], a[160:163]
  v_mfma_f32_16x16x32_bf16 a[164:167], v[136:139], a[216:219], a[164:167]
  ds_read_b64_tr_b16 v[118:119], v190 offset:17696
  v_mfma_f32_16x16x32_bf16 a[168:171], v[140:143], a[216:219], a[168:171]
  v_mfma_f32_16x16x32_bf16 a[172:175], v[144:147], a[216:219], a[172:175]
  ds_read_b64_tr_b16 v[120:121], v190 offset:16448
  v_mfma_f32_16x16x32_bf16 a[176:179], v[148:151], a[216:219], a[176:179]
  s_mov_b32 s82, 5439488
  buffer_load_dword v27, v35, s[48:51], s82 offen sc1
  v_mfma_f32_16x16x32_bf16 a[180:183], v[132:135], a[220:223], a[180:183]
  ds_read_b64_tr_b16 v[122:123], v190 offset:17728
  v_mfma_f32_16x16x32_bf16 a[184:187], v[136:139], a[220:223], a[184:187]
  v_mfma_f32_16x16x32_bf16 a[188:191], v[140:143], a[220:223], a[188:191]
  ds_read_b64_tr_b16 v[124:125], v190 offset:16480
  v_mfma_f32_16x16x32_bf16 v[6:9], v[144:147], a[220:223], v[6:9]
  v_mfma_f32_16x16x32_bf16 v[10:13], v[148:151], a[220:223], v[10:13]
  ds_read_b64_tr_b16 v[126:127], v190 offset:17760
  v_mfma_f32_16x16x32_bf16 v[224:227], v[132:135], a[208:211], v[224:227]
  v_mfma_f32_16x16x32_bf16 v[228:231], v[136:139], a[208:211], v[228:231]
  ds_read_b64_tr_b16 v[128:129], v190 offset:16512
  v_mfma_f32_16x16x32_bf16 v[232:235], v[140:143], a[208:211], v[232:235]
  v_mfma_f32_16x16x32_bf16 v[236:239], v[144:147], a[208:211], v[236:239]
  ds_read_b64_tr_b16 v[130:131], v190 offset:17792
  v_mfma_f32_16x16x32_bf16 v[240:243], v[148:151], a[208:211], v[240:243]
  s_waitcnt lgkmcnt(8)
  v_mfma_f32_16x16x32_bf16 a[140:143], v[112:115], a[228:231], a[140:143]
  s_waitcnt lgkmcnt(6)
  v_mfma_f32_16x16x32_bf16 a[144:147], v[116:119], a[228:231], a[144:147]
  s_waitcnt lgkmcnt(4)
  v_mfma_f32_16x16x32_bf16 a[148:151], v[120:123], a[228:231], a[148:151]
  s_waitcnt lgkmcnt(2)
  v_mfma_f32_16x16x32_bf16 a[152:155], v[124:127], a[228:231], a[152:155]
  s_waitcnt lgkmcnt(0)
  v_mfma_f32_16x16x32_bf16 a[156:159], v[128:131], a[228:231], a[156:159]
  v_mfma_f32_16x16x32_bf16 a[160:163], v[112:115], a[232:235], a[160:163]
  v_mfma_f32_16x16x32_bf16 a[164:167], v[116:119], a[232:235], a[164:167]
  v_mfma_f32_16x16x32_bf16 a[168:171], v[120:123], a[232:235], a[168:171]
  v_mfma_f32_16x16x32_bf16 a[172:175], v[124:127], a[232:235], a[172:175]
  ds_write_b128 v193, a[140:143] offset:36864
  ds_write_b128 v193, a[144:147] offset:37888
  ds_write_b128 v193, a[148:151] offset:38912
  v_mfma_f32_16x16x32_bf16 a[176:179], v[128:131], a[232:235], a[176:179]
  ds_write_b128 v193, a[152:155] offset:39936
  ds_write_b128 v193, a[156:159] offset:40960
  v_mfma_f32_16x16x32_bf16 a[180:183], v[112:115], a[236:239], a[180:183]
  v_mfma_f32_16x16x32_bf16 a[184:187], v[116:119], a[236:239], a[184:187]
  v_mfma_f32_16x16x32_bf16 a[188:191], v[120:123], a[236:239], a[188:191]
  v_mfma_f32_16x16x32_bf16 v[6:9], v[124:127], a[236:239], v[6:9]
  ds_write_b128 v192, a[160:163] offset:40960
  ds_write_b128 v192, a[164:167] offset:41984
  ds_write_b128 v192, a[168:171] offset:43008
  v_mfma_f32_16x16x32_bf16 v[10:13], v[128:131], a[236:239], v[10:13]
  s_add_u32 s82, s74, 6
  s_waitcnt vmcnt(0)
  v_cmp_ne_u32 vcc, s82, v27
  s_nop 0
  s_cbranch_vccnz L_slow26
L_back27:
  s_xor_b32 s79, s2, 2
  s_sub_u32 s79, s79, s2
  s_mul_i32 s79, s79, 12288
  s_add_u32 s16, s16, s79
  buffer_load_dwordx4 v[164:167], v37, s[48:51], s16 offen offset:0 sc1
  buffer_load_dwordx4 v[168:171], v37, s[48:51], s16 offen offset:1024 sc1
  buffer_load_dwordx4 v[172:175], v37, s[48:51], s16 offen offset:2048 sc1
  ds_write_b128 v192, a[172:175] offset:44032
  ds_write_b128 v192, a[176:179] offset:45056
  v_mfma_f32_16x16x32_bf16 v[224:227], v[112:115], a[224:227], v[224:227]
  v_mfma_f32_16x16x32_bf16 v[228:231], v[116:119], a[224:227], v[228:231]
  v_mfma_f32_16x16x32_bf16 v[232:235], v[120:123], a[224:227], v[232:235]
  v_mfma_f32_16x16x32_bf16 v[236:239], v[124:127], a[224:227], v[236:239]
  ds_write_b128 v192, a[180:183] offset:61440
  ds_write_b128 v192, a[184:187] offset:62464
  ds_write_b128 v192, a[188:191] offset:63488
  v_mfma_f32_16x16x32_bf16 v[240:243], v[128:131], a[224:227], v[240:243]
  ds_write_b128 v192, v[6:9] offset:64512
  ds_write_b128 v193, v[10:13] offset:0
  s_waitcnt lgkmcnt(0)
  s_barrier
  ds_read_b128 v[68:71], v194 offset:0
  ds_read_b128 v[72:75], v194 offset:1024
  ds_read_b128 v[76:79], v194 offset:2048
  ds_read_b128 v[80:83], v194 offset:3072
  ds_read_b128 v[84:87], v194 offset:4096
  ds_read_b128 v[88:91], v195 offset:0
  ds_read_b128 v[92:95], v195 offset:1024
  ds_read_b128 v[96:99], v195 offset:2048
  ds_read_b128 v[100:103], v195 offset:3072
  ds_read_b128 v[104:107], v195 offset:4096
  ds_read_b128 v[108:111], v196 offset:0
  ds_read_b128 v[208:211], v196 offset:1024
  ds_read_b128 v[212:215], v196 offset:2048
  ds_read_b128 v[216:219], v196 offset:3072
  ds_read_b128 v[220:223], v196 offset:4096
  s_waitcnt vmcnt(2)
  v_dot2_f32_bf16 v224, v164, s88, v224
  v_dot2_f32_bf16 v225, v164, s89, v225
  v_dot2_f32_bf16 v226, v165, s88, v226
  v_dot2_f32_bf16 v227, v165, s89, v227
  v_dot2_f32_bf16 v228, v166, s88, v228
  v_dot2_f32_bf16 v229, v166, s89, v229
  v_dot2_f32_bf16 v230, v167, s88, v230
  v_dot2_f32_bf16 v231, v167, s89, v231
  s_waitcnt vmcnt(1)
  v_dot2_f32_bf16 v232, v168, s88, v232
  v_dot2_f32_bf16 v233, v168, s89, v233
  v_dot2_f32_bf16 v234, v169, s88, v234
  v_dot2_f32_bf16 v235, v169, s89, v235
  v_dot2_f32_bf16 v236, v170, s88, v236
  v_dot2_f32_bf16 v237, v170, s89, v237
  v_dot2_f32_bf16 v238, v171, s88, v238
  v_dot2_f32_bf16 v239, v171, s89, v239
  s_waitcnt vmcnt(0)
  v_dot2_f32_bf16 v240, v172, s88, v240
  v_dot2_f32_bf16 v241, v172, s89, v241
  v_dot2_f32_bf16 v242, v173, s88, v242
  v_dot2_f32_bf16 v243, v173, s89, v243
  s_waitcnt lgkmcnt(14)
  v_pk_add_f32 v[224:225], v[224:225], v[68:69]
  v_pk_add_f32 v[226:227], v[226:227], v[70:71]
  s_waitcnt lgkmcnt(13)
  v_pk_add_f32 v[228:229], v[228:229], v[72:73]
  v_pk_add_f32 v[230:231], v[230:231], v[74:75]
  s_waitcnt lgkmcnt(12)
  v_pk_add_f32 v[232:233], v[232:233], v[76:77]
  v_pk_add_f32 v[234:235], v[234:235], v[78:79]
  s_waitcnt lgkmcnt(11)
  v_pk_add_f32 v[236:237], v[236:237], v[80:81]
  v_pk_add_f32 v[238:239], v[238:239], v[82:83]
  s_waitcnt lgkmcnt(10)
  v_pk_add_f32 v[240:241], v[240:241], v[84:85]
  v_pk_add_f32 v[242:243], v[242:243], v[86:87]
  s_waitcnt lgkmcnt(9)
  v_pk_add_f32 v[224:225], v[224:225], v[88:89]
  v_pk_add_f32 v[226:227], v[226:227], v[90:91]
  s_waitcnt lgkmcnt(8)
  v_pk_add_f32 v[228:229], v[228:229], v[92:93]
  v_pk_add_f32 v[230:231], v[230:231], v[94:95]
  s_waitcnt lgkmcnt(7)
  v_pk_add_f32 v[232:233], v[232:233], v[96:97]
  v_pk_add_f32 v[234:235], v[234:235], v[98:99]
  s_waitcnt lgkmcnt(6)
  v_pk_add_f32 v[236:237], v[236:237], v[100:101]
  v_pk_add_f32 v[238:239], v[238:239], v[102:103]
  s_waitcnt lgkmcnt(5)
  v_pk_add_f32 v[240:241], v[240:241], v[104:105]
  v_pk_add_f32 v[242:243], v[242:243], v[106:107]
  s_waitcnt lgkmcnt(4)
  v_pk_add_f32 v[224:225], v[224:225], v[108:109]
  v_pk_add_f32 v[226:227], v[226:227], v[110:111]
  s_waitcnt lgkmcnt(3)
  v_pk_add_f32 v[228:229], v[228:229], v[208:209]
  v_pk_add_f32 v[230:231], v[230:231], v[210:211]
  s_waitcnt lgkmcnt(2)
  v_pk_add_f32 v[232:233], v[232:233], v[212:213]
  v_pk_add_f32 v[234:235], v[234:235], v[214:215]
  s_waitcnt lgkmcnt(1)
  v_pk_add_f32 v[236:237], v[236:237], v[216:217]
  v_pk_add_f32 v[238:239], v[238:239], v[218:219]
  s_waitcnt lgkmcnt(0)
  v_pk_add_f32 v[240:241], v[240:241], v[220:221]
  v_pk_add_f32 v[242:243], v[242:243], v[222:223]
  ds_write_b128 v198, v[224:227] offset:0
  ds_write_b128 v198, v[228:231] offset:64
  ds_write_b128 v198, v[232:235] offset:128
  ds_write_b128 v198, v[236:239] offset:192
  ds_write_b128 v198, v[240:243] offset:256
  ds_read_b128 v[48:51], v202 offset:0
  ds_read_b128 v[52:55], v202 offset:16
  ds_read_b128 v[56:59], v203 offset:2048
  ds_read_b128 v[60:63], v203 offset:2064
  ds_read_b128 v[64:67], v204 offset:4096
  ds_read_b128 v[68:71], v204 offset:4112
  s_waitcnt lgkmcnt(5)
  v_dot2_f32_bf16 v48, v152, s88, v48
  v_dot2_f32_bf16 v49, v152, s89, v49
  v_dot2_f32_bf16 v50, v153, s88, v50
  v_dot2_f32_bf16 v51, v153, s89, v51
  s_waitcnt lgkmcnt(4)
  v_dot2_f32_bf16 v52, v154, s88, v52
  v_dot2_f32_bf16 v53, v154, s89, v53
  v_dot2_f32_bf16 v54, v155, s88, v54
  v_dot2_f32_bf16 v55, v155, s89, v55
  s_waitcnt lgkmcnt(3)
  v_dot2_f32_bf16 v56, v156, s88, v56
  v_dot2_f32_bf16 v57, v156, s89, v57
  v_dot2_f32_bf16 v58, v157, s88, v58
  v_dot2_f32_bf16 v59, v157, s89, v59
  s_waitcnt lgkmcnt(2)
  v_dot2_f32_bf16 v60, v158, s88, v60
  v_dot2_f32_bf16 v61, v158, s89, v61
  v_dot2_f32_bf16 v62, v159, s88, v62
  v_dot2_f32_bf16 v63, v159, s89, v63
  v_cvt_pk_bf16_f32 v48, v48, v49
  v_cvt_pk_bf16_f32 v49, v50, v51
  v_cvt_pk_bf16_f32 v50, v52, v53
  v_cvt_pk_bf16_f32 v51, v54, v55
  buffer_store_dwordx4 v[48:51], v180, s[52:55], s12 offen offset:0
  s_waitcnt lgkmcnt(1)
  v_dot2_f32_bf16 v64, v160, s88, v64
  v_dot2_f32_bf16 v65, v160, s89, v65
  v_dot2_f32_bf16 v66, v161, s88, v66
  v_dot2_f32_bf16 v67, v161, s89, v67
  s_waitcnt lgkmcnt(0)
  v_dot2_f32_bf16 v68, v162, s88, v68
  v_dot2_f32_bf16 v69, v162, s89, v69
  v_dot2_f32_bf16 v70, v163, s88, v70
  v_dot2_f32_bf16 v71, v163, s89, v71
  v_cvt_pk_bf16_f32 v56, v56, v57
  v_cvt_pk_bf16_f32 v57, v58, v59
  v_cvt_pk_bf16_f32 v58, v60, v61
  v_cvt_pk_bf16_f32 v59, v62, v63
  buffer_store_dwordx4 v[56:59], v181, s[52:55], s12 offen offset:1024
  s_nop 1
  v_cvt_pk_bf16_f32 v64, v64, v65
  v_cvt_pk_bf16_f32 v65, v66, v67
  v_cvt_pk_bf16_f32 v66, v68, v69
  v_cvt_pk_bf16_f32 v67, v70, v71
  buffer_store_dwordx4 v[64:67], v197, s[52:55], s12 offen offset:2048
  s_endpgm
L_q:
  s_lshl_b32 s79, s72, 7
  s_sub_u32 s3, s3, s79
  s_add_u32 s3, s3, 256
  v_lshrrev_b32 v252, 3, v1
  s_lshl_b32 s79, s68, 4
  v_add_u32 v252, s79, v252
  v_mul_u32_u24 v252, 3456, v252
  v_bfe_u32 v253, v1, 4, 1
  v_lshlrev_b32 v253, 2, v253
  v_and_b32 v254, 7, v1
  v_xor_b32 v253, v253, v254
  v_lshl_add_u32 v46, v253, 4, v252
  v_add_u32 v47, 26624, v46
  s_lshl_b32 s91, s68, 11
  s_add_u32 s101, s3, 0
  s_add_u32 m0, s91, 0
  s_nop 0
  buffer_load_dwordx4 v46, s[36:39], s101 offen offset:0 lds
  buffer_load_dwordx4 v47, s[36:39], s101 offen offset:1024 lds
  s_add_u32 m0, s91, 8064
  s_nop 0
  buffer_load_dwordx4 v46, s[36:39], s101 offen offset:128 lds
  buffer_load_dwordx4 v47, s[36:39], s101 offen offset:1152 lds
  s_lshl_b32 s75, s68, 10
  s_lshr_b32 s79, s70, 2
  s_sub_u32 s79, s70, s79
  s_add_u32 s79, s79, 48
  s_min_u32 s79, s79, 53
  s_lshl_b32 s73, s79, 6
  s_and_b32 s79, s70, 3
  s_cmp_eq_u32 s79, 3
  s_cselect_b32 s83, 1073741824, 0
  s_lshl_b32 s79, s69, 7
  s_lshl_b32 s80, s71, 3
  s_add_u32 s79, s79, s80
  s_lshl_b32 s80, s68, 1
  s_add_u32 s81, s79, s80
  s_mul_i32 s78, s81, 1280
  v_lshrrev_b32 v252, 5, v1
  v_mul_u32_u24 v253, 1280, v252
  v_and_b32 v254, 31, v1
  v_lshl_add_u32 v173, v254, 3, v253
  v_add_u32 v172, s81, v252
  s_cmp_lg_u32 s68, 0
  s_cbranch_scc1 L_s0p31
  s_mov_b32 s40, s12
  s_mov_b32 s41, s13
  s_mov_b32 s44, 3456
  s_mov_b32 s52, 0
  s_add_u32 s46, s3, 0
  s_mov_b32 s92, s46
  s_mov_b32 s42, s12
  s_mov_b32 s43, s13
  s_mov_b32 s45, 3456
  s_mov_b32 s53, 0
  s_add_u32 s47, s3, 64
  s_mov_b32 s93, s47
  s_branch L_s0p30
L_s0p31:
  s_cmp_lg_u32 s68, 1
  s_cbranch_scc1 L_s0p32
  s_mov_b32 s40, s12
  s_mov_b32 s41, s13
  s_mov_b32 s44, 3456
  s_mov_b32 s52, 0
  s_add_u32 s46, s3, 128
  s_mov_b32 s92, s46
  s_mov_b32 s42, s12
  s_mov_b32 s43, s13
  s_mov_b32 s45, 3456
  s_mov_b32 s53, 0
  s_add_u32 s47, s3, 192
  s_mov_b32 s93, s47
  s_branch L_s0p30
L_s0p32:
  s_cmp_lg_u32 s68, 2
  s_cbranch_scc1 L_s0p33
  s_mov_b32 s40, s12
  s_mov_b32 s41, s13
  s_mov_b32 s44, 3456
  s_mov_b32 s52, 0
  s_or_b32 s92, s73, s83
  s_mov_b32 s46, s73
  s_mov_b32 s42, s6
  s_mov_b32 s43, s7
  s_mov_b32 s45, 3840
  s_mov_b32 s53, 0
  s_add_u32 s47, s77, 0
  s_mov_b32 s93, 1073741824
  s_branch L_s0p30
L_s0p33:
  s_mov_b32 s40, s6
  s_mov_b32 s41, s7
  s_mov_b32 s44, 3840
  s_mov_b32 s52, 0
  s_add_u32 s46, s77, 64
  s_mov_b32 s92, 1073741824
  s_mov_b32 s42, s6
  s_mov_b32 s43, s7
  s_mov_b32 s45, 3840
  s_mov_b32 s53, -32
  s_add_u32 s47, s77, 128
  s_mov_b32 s93, 1073741824
L_s0p30:
  v_and_b32 v252, 4, v1
  v_cmp_ne_u32 vcc, 0, v252
  v_mov_b32 v174, s44
  v_mov_b32 v253, s45
  v_cndmask_b32 v174, v174, v253, vcc
  v_mov_b32 v175, 0
  v_mov_b32 v254, s46
  v_mov_b32 v253, s47
  v_cndmask_b32 v254, v254, v253, vcc
  v_mov_b32 v255, s52
  v_mov_b32 v253, s53
  v_cndmask_b32 v255, v255, v253, vcc
  v_mov_b32 v158, s40
  v_mov_b32 v253, s42
  v_cndmask_b32 v158, v158, v253, vcc
  v_mov_b32 v159, s41
  v_mov_b32 v253, s43
  v_cndmask_b32 v159, v159, v253, vcc
  v_bfe_u32 v252, v1, 1, 1
  v_mad_i32_i24 v254, v252, v255, v254
  v_and_b32 v252, 3, v1
  v_lshl_add_u32 v254, v252, 4, v254
  v_lshrrev_b32 v252, 3, v1
  v_mul_u32_u24 v252, 5, v252
  s_mul_i32 s79, s69, 40
  v_add_u32 v252, s79, v252
  v_mad_u32_u24 v254, v252, v174, v254
  v_mov_b32 v255, 0
  v_lshl_add_u64 v[158:159], v[254:255], 0, v[158:159]
  v_lshl_add_u64 v[160:161], v[174:175], 0, v[158:159]
  v_lshl_add_u64 v[162:163], v[174:175], 0, v[160:161]
  v_lshl_add_u64 v[164:165], v[174:175], 0, v[162:163]
  v_lshl_add_u64 v[166:167], v[174:175], 0, v[164:165]
  buffer_load_dwordx2 v[128:129], v173, s[28:31], s78 offen offset:0
  buffer_load_dwordx2 v[130:131], v173, s[28:31], s78 offen offset:256
  buffer_load_dwordx2 v[132:133], v173, s[28:31], s78 offen offset:512
  buffer_load_dwordx2 v[134:135], v173, s[28:31], s78 offen offset:768
  buffer_load_dwordx2 v[136:137], v173, s[28:31], s78 offen offset:1024
  global_load_dwordx4 v[138:141], v[158:159], off
  global_load_dwordx4 v[142:145], v[160:161], off
  global_load_dwordx4 v[146:149], v[162:163], off
  global_load_dwordx4 v[150:153], v[164:165], off
  global_load_dwordx4 v[154:157], v[166:167], off
  v_and_b32 v252, 31, v1
  v_lshrrev_b32 v253, 5, v1
  v_bfe_u32 v254, v1, 1, 3
  v_xor_b32 v254, v254, v253
  v_lshlrev_b32 v254, 4, v254
  v_lshl_add_u32 v254, v252, 7, v254
  v_xor_b32 v6, 0, v254
  v_add_u32 v6, s86, v6
  v_xor_b32 v7, 32, v254
  v_add_u32 v7, s86, v7
  v_xor_b32 v8, 64, v254
  v_add_u32 v8, s86, v8
  v_xor_b32 v9, 96, v254
  v_add_u32 v9, s86, v9
  v_lshrrev_b32 v253, 5, v1
  v_bfe_u32 v252, v1, 2, 2
  v_lshl_add_u32 v252, v253, 3, v252
  v_bfe_u32 v253, v1, 4, 1
  v_and_b32 v254, 3, v1
  v_lshlrev_b32 v254, 3, v254
  v_lshl_add_u32 v254, v253, 5, v254
  v_lshl_add_u32 v254, v252, 7, v254
  v_bfe_u32 v253, v1, 3, 1
  v_lshl_add_u32 v254, v253, 6, v254
  v_add_u32 v212, 0, v254
  v_xor_b32 v213, 64, v212
  s_mov_b32 s48, s24
  s_mov_b32 s49, s25
  s_mov_b32 s50, 20971520
  s_mov_b32 s51, 0x20000
  s_mov_b32 s88, 0x3f80
  s_mov_b32 s89, 0x3f800000
  s_mov_b32 s64, s22
  s_mov_b32 s65, s23
  s_mov_b32 s66, 256
  s_mov_b32 s67, 0x20000
  v_mov_b32 v45, 0
  s_mov_b32 s56, s14
  s_mov_b32 s57, s15
  s_mov_b32 s58, 3456
  s_mov_b32 s59, 0x20000
  s_mov_b32 s40, s8
  s_mov_b32 s41, s9
  s_mov_b32 s42, 819200
  s_mov_b32 s43, 0x20000
  s_mov_b32 s44, s16
  s_mov_b32 s45, s17
  s_mov_b32 s46, 2211840
  s_mov_b32 s47, 0x20000
  s_mov_b32 s52, s20
  s_mov_b32 s53, s21
  s_mov_b32 s54, 2621440
  s_mov_b32 s55, 0x20000
  s_mov_b32 s60, s18
  s_mov_b32 s61, s19
  s_mov_b32 s62, 1280
  s_mov_b32 s63, 0x20000
  v_and_b32 v252, 31, v1
  v_lshrrev_b32 v253, 5, v1
  v_lshlrev_b32 v19, 4, v252
  v_add_u32 v19, 131072, v19
  v_sub_u32 v29, 0, v253
  v_bfe_u32 v254, v1, 4, 1
  v_mul_u32_u24 v254, 75776, v254
  v_and_b32 v255, 15, v1
  v_lshl_add_u32 v255, v253, 4, v255
  v_lshl_add_u32 v15, v255, 4, v254
  s_lshl_b32 s79, s69, 2
  s_add_u32 s79, s79, s68
  s_mul_i32 s85, s79, 151552
  s_add_u32 s85, s85, 8388608
  s_mul_i32 s25, s70, 2560
  s_add_u32 s25, s25, s85
  s_add_u32 s85, s85, 20480
  s_lshl_b32 s79, s73, 4
  s_add_u32 s95, s85, s79
  s_or_b32 s95, s95, s83
  s_lshl_b32 s79, s3, 4
  s_add_u32 s85, s85, s79
  s_lshl_b32 s79, s2, 7
  v_and_b32 v254, 1073741824, v29
  v_lshl_add_u32 v254, v252, 2, v254
  v_add_u32 v206, s79, v254
  s_lshl_b32 s79, s2, 9
  s_lshl_b32 s80, s68, 7
  s_add_u32 s79, s79, s80
  v_add_u32 v16, s79, v254
  v_mov_b32 v201, 0
  v_lshlrev_b32 v200, 2, v1
  v_add_u32 v200, 135680, v200
  ds_write_b32 v200, v201
  v_mov_b32 v201, 1
  s_mov_b32 s84, 897988541
  s_lshl_b32 s79, s2, 2
  s_add_u32 s79, s79, s68
  s_mul_i32 s96, s79, 2176
  s_mul_i32 s97, s79, 896
  v_lshlrev_b32 v179, 7, v1
  s_lshr_b32 s79, s69, 3
  s_and_b32 s80, s69, 7
  s_lshl_b32 s80, s80, 3
  s_add_u32 s79, s79, s80
  s_lshl_b32 s79, s79, 7
  v_and_b32 v252, 48, v1
  v_lshlrev_b32 v252, 4, v252
  v_bfe_u32 v253, v1, 2, 2
  v_lshl_add_u32 v252, v253, 13, v252
  v_add_u32 v17, s79, v252
  s_lshr_b32 s79, s71, 2
  s_lshl_b32 s79, s79, 8
  s_and_b32 s80, s71, 3
  s_lshl_b32 s80, s80, 13
  s_add_u32 s79, s79, s80
  v_and_b32 v252, 32, v1
  v_lshlrev_b32 v252, 2, v252
  v_bfe_u32 v253, v1, 2, 3
  v_lshl_add_u32 v252, v253, 10, v252
  v_add_u32 v18, s79, v252
  v_and_b32 v252, 31, v1
  v_lshlrev_b32 v252, 6, v252
  s_lshl_b32 s79, s69, 2
  s_add_u32 s79, s79, s68
  s_lshl_b32 s79, s79, 11
  s_add_u32 s79, s79, 6291456
  v_add_u32 v216, s79, v252
  v_lshrrev_b32 v252, 4, v1
  v_lshlrev_b32 v252, 10, v252
  v_and_b32 v253, 15, v1
  v_lshl_add_u32 v252, v253, 4, v252
  s_lshl_b32 s79, s71, 14
  s_lshl_b32 s80, s68, 8
  s_add_u32 s79, s79, s80
  s_waitcnt vmcnt(10) lgkmcnt(0)
  s_barrier
  ds_read_b128 a[0:3], v6 offset:0
  ds_read_b128 a[4:7], v7 offset:0
  ds_read_b128 a[8:11], v8 offset:0
  ds_read_b128 a[12:15], v9 offset:0
  ds_read_b64_tr_b16 a[160:161], v212 offset:0
  ds_read_b64_tr_b16 a[162:163], v212 offset:512
  ds_read_b64_tr_b16 a[164:165], v212 offset:2048
  ds_read_b64_tr_b16 a[166:167], v212 offset:2560
  ds_read_b64_tr_b16 a[168:169], v212 offset:4096
  ds_read_b64_tr_b16 a[170:171], v212 offset:4608
  ds_read_b64_tr_b16 a[172:173], v212 offset:6144
  ds_read_b64_tr_b16 a[174:175], v212 offset:6656
  ds_read_b64_tr_b16 a[176:177], v213 offset:0
  ds_read_b64_tr_b16 a[178:179], v213 offset:512
  s_add_u32 s100, s76, 128
  s_add_u32 m0, s86, 4096
  s_waitcnt lgkmcnt(6)
  v_mfma_f32_32x32x16_bf16 v[48:63], a[160:163], a[0:3], 0
  ds_read_b64_tr_b16 a[180:181], v213 offset:2048
  ds_read_b64_tr_b16 a[182:183], v213 offset:2560
  buffer_load_dwordx4 v2, s[28:31], s100 offen offset:0 lds
  buffer_load_dwordx4 v3, s[28:31], s100 offen offset:1024 lds
  s_add_u32 s79, s79, 65536
  v_add_u32 v217, s79, v252
  v_add_u32 v218, 4096, v217
  v_add_u32 v219, 8192, v217
  v_add_u32 v220, 12288, v217
  v_lshlrev_b32 v222, 2, v253
  v_lshrrev_b32 v252, 5, v1
  v_lshl_add_u32 v222, v252, 1, v222
  v_bfe_u32 v252, v1, 4, 1
  v_add_u32 v222, v222, v252
  v_cmp_le_u32 vcc, 32, v222
  v_mov_b32 v252, s92
  v_mov_b32 v253, s93
  v_cndmask_b32 v252, v252, v253, vcc
  v_and_b32 v253, 31, v222
  v_lshl_add_u32 v221, v253, 1, v252
  v_lshlrev_b32 v222, 4, v222
  v_add_u32 v222, s75, v222
  v_add_u32 v222, 131072, v222
  v_lshrrev_b32 v252, 2, v0
  v_and_b32 v253, 3, v1
  v_mul_u32_u24 v252, 3456, v252
  v_lshl_add_u32 v214, v253, 4, v252
  v_lshrrev_b32 v253, 5, v1
  v_bfe_u32 v252, v1, 2, 2
  v_lshl_add_u32 v252, v253, 3, v252
  v_bfe_u32 v253, v1, 4, 1
  v_and_b32 v254, 3, v1
  v_lshlrev_b32 v254, 3, v254
  v_lshl_add_u32 v254, v253, 5, v254
  v_lshl_add_u32 v254, v252, 6, v254
  v_add_u32 v215, 32768, v254
  v_mul_u32_u24 v255, 6554, v1
  s_mov_b32 s80, 3680
  v_lshrrev_b32 v253, 16, v255
  v_mfma_f32_32x32x16_bf16 v[48:63], a[164:167], a[4:7], v[48:63]
  ds_read_b64_tr_b16 a[184:185], v213 offset:4096
  ds_read_b64_tr_b16 a[186:187], v213 offset:4608
  buffer_load_dwordx4 v4, s[28:31], s100 offen offset:2048 lds
  v_mad_u32_u24 v10, v253, s80, v37
  v_add_u32 v253, 419456, v255
  v_lshrrev_b32 v253, 16, v253
  v_mad_u32_u24 v11, v253, s80, v37
  v_add_u32 v253, 838912, v255
  v_lshrrev_b32 v253, 16, v253
  v_mad_u32_u24 v12, v253, s80, v37
  v_add_u32 v253, 1258368, v255
  v_lshrrev_b32 v253, 16, v253
  v_mad_u32_u24 v13, v253, s80, v37
  v_add_u32 v253, 1677824, v255
  v_lshrrev_b32 v253, 16, v253
  v_mad_u32_u24 v14, v253, s80, v37
  v_add_u32 v14, 4096, v14
  s_mul_i32 s79, s68, 122880
  s_add_u32 s90, s77, s79
  v_lshrrev_b32 v253, 5, v1
  v_bfe_u32 v252, v1, 2, 2
  v_lshl_add_u32 v252, v253, 3, v252
  v_bfe_u32 v253, v1, 4, 1
  v_and_b32 v254, 3, v1
  v_lshlrev_b32 v254, 3, v254
  v_mul_u32_u24 v252, 160, v252
  v_add_u32 v252, v252, v254
  v_lshl_add_u32 v208, v253, 5, v252
  v_add_u32 v210, 128, v252
  v_add_u32 v209, 0x8000, v208
  v_add_u32 v211, 0x8000, v210
  s_and_b32 s79, s2, 1
  s_lshl_b32 s79, s79, 3
  s_and_b32 s80, s2, 4
  s_add_u32 s79, s79, s80
  s_lshr_b32 s80, s2, 6
  s_bfe_u32 s81, s2, 65539
  s_xor_b32 s80, s80, s81
  s_add_u32 s4, s79, s80
  s_bfe_u32 s80, s2, 0x30003
  s_mul_i32 s5, s80, 160
  s_waitcnt lgkmcnt(6)
  v_mfma_f32_32x32x16_bf16 v[48:63], a[168:171], a[8:11], v[48:63]
  ds_read_b64_tr_b16 a[188:189], v213 offset:6144
  ds_read_b64_tr_b16 a[190:191], v213 offset:6656
  buffer_load_dwordx4 v5, s[28:31], s100 offen offset:3072 lds
  s_add_u32 s101, s3, 221184
  s_add_u32 m0, s91, 16384
  s_nop 0
  buffer_load_dwordx4 v46, s[36:39], s101 offen offset:0 lds
  s_mov_b32 s15, s80
  s_bfe_u32 s81, s2, 0x10001
  s_lshl_b32 s8, s81, 2
  s_add_u32 s8, s8, s68
  s_and_b32 s79, s68, 1
  s_lshl_b32 s79, s79, 1
  s_mul_i32 s6, s8, 6
  s_sub_u32 s6, s6, s79
  s_sub_u32 s7, s6, s79
  s_add_u32 s6, s6, 4
  s_sub_u32 s13, s8, s81
  s_add_u32 s13, s13, 48
  s_cmp_eq_u32 s68, 3
  s_cselect_b32 s11, 1073741824, 0
  s_lshl_b32 s79, s4, 1
  s_add_u32 s80, s79, s81
  s_mul_i32 s10, s80, 303104
  s_add_u32 s10, s10, 8388608
  s_lshl_b32 s12, s80, 2
  s_add_u32 s12, s12, s68
  s_mul_i32 s12, s12, 20480
  s_add_u32 s12, s12, s5
  s_xor_b32 s80, s80, 1
  s_mul_i32 s9, s80, 303104
  s_add_u32 s9, s9, 8388608
  s_add_u32 s79, s6, 20
  s_lshl_b32 s17, s79, 10
  s_add_u32 s79, s7, 20
  s_lshl_b32 s18, s79, 10
  s_add_u32 s79, s13, 20
  s_lshl_b32 s19, s79, 10
  s_or_b32 s19, s19, s11
  s_lshl_b32 s20, s68, 10
  s_mul_i32 s21, s6, 40960
  s_add_u32 s21, s21, s5
  v_mfma_f32_32x32x16_bf16 v[48:63], a[172:175], a[12:15], v[48:63]
  ds_read_b64_tr_b16 a[160:161], v212 offset:8192
  ds_read_b64_tr_b16 a[162:163], v212 offset:8704
  buffer_load_dwordx4 v47, s[36:39], s101 offen offset:1024 lds
  s_mul_i32 s22, s7, 40960
  s_add_u32 s22, s22, s5
  s_mul_i32 s23, s13, 40960
  s_add_u32 s23, s23, s5
  s_or_b32 s23, s23, s11
  s_mul_i32 s24, s68, 40960
  s_add_u32 s24, s24, s5
  v_mul_u32_u24 v255, 6554, v1
  s_mov_b32 s80, 1120
  s_mul_i32 s79, s68, 5632
  s_add_u32 s79, s79, 141312
  v_lshl_add_u32 v254, v1, 5, s79
  v_lshrrev_b32 v253, 16, v255
  v_mad_u32_u24 v180, v253, s80, v37
  v_lshl_add_u32 v202, v253, 4, v254
  v_add_u32 v253, 419456, v255
  v_lshrrev_b32 v253, 16, v253
  v_mad_u32_u24 v181, v253, s80, v37
  v_lshl_add_u32 v203, v253, 4, v254
  v_add_u32 v253, 838912, v255
  v_lshrrev_b32 v253, 16, v253
  v_mad_u32_u24 v182, v253, s80, v37
  v_lshl_add_u32 v204, v253, 4, v254
  v_add_u32 v253, 1258368, v255
  v_lshrrev_b32 v253, 16, v253
  v_mad_u32_u24 v183, v253, s80, v37
  v_add_u32 v253, 1677824, v255
  v_lshrrev_b32 v253, 16, v253
  v_mad_u32_u24 v184, v253, s80, v37
  v_add_u32 v184, 4096, v184
  v_and_b32 v253, 15, v1
  v_mul_u32_u24 v253, 336, v253
  v_and_b32 v254, 48, v1
  v_add3_u32 v198, v253, v254, s79
  s_add_u32 s79, s68, 0
  s_and_b32 s79, s79, 3
  s_mul_i32 s79, s79, 75776
  s_add_u32 s79, s79, s10
  s_add_u32 m0, s91, 24448
  s_waitcnt lgkmcnt(6)
  v_mfma_f32_32x32x16_bf16 v[64:79], a[176:179], a[0:3], 0
  ds_read_b64_tr_b16 a[164:165], v212 offset:10240
  ds_read_b64_tr_b16 a[166:167], v212 offset:10752
  buffer_load_dwordx4 v46, s[36:39], s101 offen offset:128 lds
  buffer_load_dwordx4 v47, s[36:39], s101 offen offset:1152 lds
  v_add_u32 v185, s79, v37
  s_add_u32 s79, s68, 1
  s_and_b32 s79, s79, 3
  s_mul_i32 s79, s79, 75776
  s_add_u32 s79, s79, s10
  v_add_u32 v186, s79, v37
  s_add_u32 s79, s68, 2
  s_and_b32 s79, s79, 3
  s_mul_i32 s79, s79, 75776
  s_add_u32 s79, s79, s10
  v_add_u32 v187, s79, v37
  s_add_u32 s79, s68, 3
  s_and_b32 s79, s79, 3
  s_mul_i32 s79, s79, 75776
  s_add_u32 s79, s79, s10
  v_add_u32 v188, s79, v37
  v_lshrrev_b32 v252, 5, v1
  v_lshlrev_b32 v252, 4, v252
  v_bfe_u32 v253, v1, 4, 1
  v_lshl_add_u32 v252, v253, 2, v252
  v_bfe_u32 v253, v1, 2, 2
  v_add_u32 v252, v252, v253
  v_mul_u32_u24 v252, 160, v252
  v_and_b32 v253, 3, v1
  v_lshl_add_u32 v252, v253, 3, v252
  v_add_u32 v189, s94, v252
  v_add_u32 v190, 0x10000, v189
  v_add_u32 v191, 0x20000, v189
  s_lshr_b32 s79, s69, 3
  s_and_b32 s80, s69, 7
  s_lshl_b32 s80, s80, 3
  s_add_u32 s79, s79, s80
  s_lshl_b32 s79, s79, 7
  v_subrev_u32 v205, s79, v17
  s_lshr_b32 s79, s4, 3
  s_and_b32 s80, s4, 7
  s_add_u32 s100, s76, 256
  s_add_u32 m0, s86, 8192
  v_mfma_f32_32x32x16_bf16 v[64:79], a[180:183], a[4:7], v[64:79]
  ds_read_b64_tr_b16 a[168:169], v212 offset:12288
  ds_read_b64_tr_b16 a[170:171], v212 offset:12800
  buffer_load_dwordx4 v2, s[28:31], s100 offen offset:0 lds
  s_lshl_b32 s80, s80, 3
  s_add_u32 s79, s79, s80
  s_lshl_b32 s79, s79, 7
  v_add_u32 v205, s79, v205
  v_and_b32 v33, 0xffffdfff, v205
  v_or_b32 v205, 0x2000, v205
  s_mov_b32 s7, 0
  v_add_u32 v192, s94, v37
  v_add_u32 v193, 0x10000, v192
  v_add_u32 v207, 0x20000, v192
  s_sub_u32 s79, s68, 1
  s_and_b32 s79, s79, 3
  s_mul_i32 s79, s79, 5120
  s_add_u32 s79, s79, 20480
  v_add_u32 v194, s79, v37
  s_sub_u32 s79, s68, 2
  s_and_b32 s79, s79, 3
  s_mul_i32 s79, s79, 5120
  s_add_u32 s79, s79, 40960
  v_add_u32 v195, s79, v37
  s_sub_u32 s79, s68, 3
  s_and_b32 s79, s79, 3
  s_mul_i32 s79, s79, 5120
  s_add_u32 s79, s79, 81920
  v_add_u32 v196, s79, v37
  s_xor_b32 s79, s2, 2
  s_lshl_b32 s80, s79, 9
  s_lshl_b32 s81, s68, 7
  s_add_u32 s80, s80, s81
  v_mov_b32 v35, s80
  s_lshl_b32 s16, s2, 2
  s_add_u32 s16, s16, s68
  s_mul_i32 s16, s16, 3072
  s_add_u32 s16, s16, 524288
  v_and_b32 v197, 1073741824, v29
  v_or_b32 v197, v197, v182
  v_lshrrev_b32 v252, 4, v1
  s_waitcnt lgkmcnt(6)
  v_mfma_f32_32x32x16_bf16 v[64:79], a[184:187], a[8:11], v[64:79]
  ds_read_b64_tr_b16 a[172:173], v212 offset:14336
  ds_read_b64_tr_b16 a[174:175], v212 offset:14848
  buffer_load_dwordx4 v3, s[28:31], s100 offen offset:1024 lds
  buffer_load_dwordx4 v4, s[28:31], s100 offen offset:2048 lds
  v_lshlrev_b32 v252, 3, v252
  v_add_u32 v199, s5, v252
  v_subrev_u32 v176, 8192, v18
  s_lshl_b32 s99, s70, 2
  s_add_u32 s99, s99, s68
  s_mul_i32 s99, s99, 20480
  s_add_u32 s99, s99, 4194304
  v_cmp_gt_u32 vcc, 60, v1
  v_lshlrev_b32 v252, 4, v1
  v_mov_b32 v21, 1073741824
  v_cndmask_b32 v21, v21, v252, vcc
  v_lshl_add_u32 v252, v1, 1, 0
  v_mul_u32_u24 v254, 2731, v252
  v_lshrrev_b32 v254, 16, v254
  v_mul_u32_u24 v253, 24, v254
  v_sub_u32 v253, v252, v253
  v_mul_u32_u24 v252, 5, v254
  v_subrev_u32 v252, 4, v252
  v_max_i32 v252, v252, v253
  s_mul_i32 s79, s68, 5
  v_add_u32 v254, s79, v254
  v_lshrrev_b32 v255, 2, v254
  v_lshlrev_b32 v23, 5, v255
  v_and_b32 v255, 1, v254
  v_lshl_add_u32 v23, v255, 4, v23
  v_bfe_u32 v255, v254, 1, 1
  v_lshl_add_u32 v23, v255, 3, v23
  v_add_u32 v23, 81920, v23
  s_mul_i32 s79, s68, 20
  v_add_u32 v254, s79, v253
  s_add_u32 s79, s68, 80
  v_mov_b32 v255, s79
  v_cmp_eq_u32 vcc, 20, v253
  s_nop 1
  v_cndmask_b32 v254, v254, v255, vcc
  v_mul_u32_u24 v254, 176, v254
  v_add_u32 v23, v23, v254
  v_add_u32 v254, 704, v23
  v_cndmask_b32 v25, v23, v254, vcc
  v_mfma_f32_32x32x16_bf16 v[64:79], a[188:191], a[12:15], v[64:79]
  ds_read_b64_tr_b16 a[176:177], v213 offset:8192
  ds_read_b64_tr_b16 a[178:179], v213 offset:8704
  buffer_load_dwordx4 v5, s[28:31], s100 offen offset:3072 lds
  v_cmp_lt_u32 vcc, 20, v252
  v_mov_b32 v254, 135168
  s_nop 0
  v_cndmask_b32 v23, v23, v254, vcc
  v_cndmask_b32 v25, v25, v254, vcc
  v_lshl_add_u32 v252, v1, 1, 1
  v_mul_u32_u24 v254, 2731, v252
  v_lshrrev_b32 v254, 16, v254
  v_mul_u32_u24 v253, 24, v254
  v_sub_u32 v253, v252, v253
  v_mul_u32_u24 v252, 5, v254
  v_subrev_u32 v252, 4, v252
  v_max_i32 v252, v252, v253
  s_mul_i32 s79, s68, 5
  v_add_u32 v254, s79, v254
  v_lshrrev_b32 v255, 2, v254
  v_lshlrev_b32 v24, 5, v255
  v_and_b32 v255, 1, v254
  v_lshl_add_u32 v24, v255, 4, v24
  v_bfe_u32 v255, v254, 1, 1
  v_lshl_add_u32 v24, v255, 3, v24
  v_add_u32 v24, 81920, v24
  s_mul_i32 s79, s68, 20
  v_add_u32 v254, s79, v253
  s_add_u32 s79, s68, 80
  v_mov_b32 v255, s79
  v_cmp_eq_u32 vcc, 20, v253
  s_nop 1
  v_cndmask_b32 v254, v254, v255, vcc
  v_mul_u32_u24 v254, 176, v254
  v_add_u32 v24, v24, v254
  v_add_u32 v254, 704, v24
  v_cndmask_b32 v177, v24, v254, vcc
  v_cmp_lt_u32 vcc, 20, v252
  v_mov_b32 v254, 135168
  s_nop 0
  v_cndmask_b32 v24, v24, v254, vcc
  v_cndmask_b32 v177, v177, v254, vcc
  v_and_b32 v252, 31, v1
  s_add_u32 s101, s3, 442368
  s_add_u32 m0, s91, 32768
  s_waitcnt lgkmcnt(6)
  v_mfma_f32_32x32x16_bf16 v[80:95], a[160:163], a[0:3], 0
  ds_read_b64_tr_b16 a[180:181], v213 offset:10240
  ds_read_b64_tr_b16 a[182:183], v213 offset:10752
  buffer_load_dwordx4 v46, s[36:39], s101 offen offset:0 lds
  buffer_load_dwordx4 v47, s[36:39], s101 offen offset:1024 lds
  s_mov_b32 s87, 0x3f803f80
  s_waitcnt vmcnt(23)
  v_dot2_f32_bf16 v168, v128, s87, 0
  v_dot2_f32_bf16 v169, v128, v128, 0
  v_dot2_f32_bf16 v168, v129, s87, v168
  v_dot2_f32_bf16 v169, v129, v129, v169
  s_waitcnt vmcnt(22)
  v_dot2_f32_bf16 v168, v130, s87, v168
  v_dot2_f32_bf16 v169, v130, v130, v169
  v_dot2_f32_bf16 v168, v131, s87, v168
  v_dot2_f32_bf16 v169, v131, v131, v169
  s_waitcnt vmcnt(21)
  v_dot2_f32_bf16 v168, v132, s87, v168
  v_dot2_f32_bf16 v169, v132, v132, v169
  v_dot2_f32_bf16 v168, v133, s87, v168
  v_dot2_f32_bf16 v169, v133, v133, v169
  s_waitcnt vmcnt(20)
  v_dot2_f32_bf16 v168, v134, s87, v168
  v_dot2_f32_bf16 v169, v134, v134, v169
  v_dot2_f32_bf16 v168, v135, s87, v168
  v_dot2_f32_bf16 v169, v135, v135, v169
  s_waitcnt vmcnt(19)
  v_dot2_f32_bf16 v168, v136, s87, v168
  v_dot2_f32_bf16 v169, v136, v136, v169
  v_dot2_f32_bf16 v168, v137, s87, v168
  v_dot2_f32_bf16 v169, v137, v137, v169
  v_lshlrev_b32 v172, 6, v172
  v_add_u32 v172, 6291456, v172
  v_and_b32 v170, 7, v1
  v_lshl_add_u32 v172, v170, 3, v172
  v_bfe_u32 v170, v1, 3, 2
  v_min_u32 v170, 1, v170
  v_lshl_add_u32 v172, v170, 30, v172
  s_waitcnt vmcnt(18)
  v_dot2_f32_bf16 v158, v138, s88, 0
  v_dot2_f32_bf16 v159, v138, s89, 0
  v_dot2_f32_bf16 v160, v139, s88, 0
  v_dot2_f32_bf16 v161, v139, s89, 0
  v_dot2_f32_bf16 v162, v140, s88, 0
  v_dot2_f32_bf16 v163, v140, s89, 0
  v_dot2_f32_bf16 v164, v141, s88, 0
  s_add_u32 m0, s91, 40832
  v_mfma_f32_32x32x16_bf16 v[80:95], a[164:167], a[4:7], v[80:95]
  ds_read_b64_tr_b16 a[184:185], v213 offset:12288
  ds_read_b64_tr_b16 a[186:187], v213 offset:12800
  buffer_load_dwordx4 v46, s[36:39], s101 offen offset:128 lds
  v_dot2_f32_bf16 v165, v141, s89, 0
  s_waitcnt vmcnt(18)
  v_dot2_f32_bf16 v158, v142, s88, v158
  v_dot2_f32_bf16 v159, v142, s89, v159
  v_dot2_f32_bf16 v160, v143, s88, v160
  v_dot2_f32_bf16 v161, v143, s89, v161
  v_dot2_f32_bf16 v162, v144, s88, v162
  v_dot2_f32_bf16 v163, v144, s89, v163
  v_dot2_f32_bf16 v164, v145, s88, v164
  v_dot2_f32_bf16 v165, v145, s89, v165
  s_waitcnt vmcnt(17)
  v_dot2_f32_bf16 v158, v146, s88, v158
  v_dot2_f32_bf16 v159, v146, s89, v159
  v_dot2_f32_bf16 v160, v147, s88, v160
  v_dot2_f32_bf16 v161, v147, s89, v161
  v_dot2_f32_bf16 v162, v148, s88, v162
  v_dot2_f32_bf16 v163, v148, s89, v163
  v_dot2_f32_bf16 v164, v149, s88, v164
  v_dot2_f32_bf16 v165, v149, s89, v165
  s_waitcnt vmcnt(16)
  v_dot2_f32_bf16 v158, v150, s88, v158
  v_dot2_f32_bf16 v159, v150, s89, v159
  v_dot2_f32_bf16 v160, v151, s88, v160
  v_dot2_f32_bf16 v161, v151, s89, v161
  v_dot2_f32_bf16 v162, v152, s88, v162
  v_dot2_f32_bf16 v163, v152, s89, v163
  v_dot2_f32_bf16 v164, v153, s88, v164
  v_dot2_f32_bf16 v165, v153, s89, v165
  s_waitcnt vmcnt(15)
  v_dot2_f32_bf16 v158, v154, s88, v158
  v_dot2_f32_bf16 v159, v154, s89, v159
  v_dot2_f32_bf16 v160, v155, s88, v160
  v_dot2_f32_bf16 v161, v155, s89, v161
  v_dot2_f32_bf16 v162, v156, s88, v162
  v_dot2_f32_bf16 v163, v156, s89, v163
  v_dot2_f32_bf16 v164, v157, s88, v164
  v_dot2_f32_bf16 v165, v157, s89, v165
  v_add_f32_dpp v168, v168, v168 row_ror:8 row_mask:0xf bank_mask:0xf
  v_and_b32 v174, 7, v1
  v_add_f32_dpp v169, v169, v169 row_ror:8 row_mask:0xf bank_mask:0xf
  v_lshlrev_b32 v174, 5, v174
  v_add_f32_dpp v168, v168, v168 row_ror:4 row_mask:0xf bank_mask:0xf
  v_lshrrev_b32 v175, 5, v1
  v_add_f32_dpp v169, v169, v169 row_ror:4 row_mask:0xf bank_mask:0xf
  v_lshl_add_u32 v174, v175, 4, v174
  v_add_f32_dpp v168, v168, v168 row_ror:2 row_mask:0xf bank_mask:0xf
  v_permlane32_swap_b32 v158, v162
  v_add_f32_dpp v169, v169, v169 row_ror:2 row_mask:0xf bank_mask:0xf
  v_permlane32_swap_b32 v159, v163
  v_add_f32_dpp v168, v168, v168 row_ror:1 row_mask:0xf bank_mask:0xf
  v_permlane32_swap_b32 v160, v164
  v_add_f32_dpp v169, v169, v169 row_ror:1 row_mask:0xf bank_mask:0xf
  v_permlane32_swap_b32 v161, v165
  v_mov_b32 v170, v168
  v_add_f32 v158, v158, v162
  v_mov_b32 v171, v169
  v_add_f32 v159, v159, v163
  v_permlane16_swap_b32 v168, v170
  v_add_f32 v160, v160, v164
  v_permlane16_swap_b32 v169, v171
  v_add_f32 v161, v161, v165
  v_add_f32 v168, v168, v170
  v_bfe_u32 v175, v1, 4, 1
  v_add_f32 v169, v169, v171
  v_lshl_add_u32 v174, v175, 3, v174
  v_mul_f32 v168, 986500301, v168
  v_permlane16_swap_b32 v158, v160
  v_mul_f32 v169, 986500301, v169
  v_permlane16_swap_b32 v159, v161
  v_fma_f32 v169, -v168, v168, v169
  v_add_f32 v158, v158, v160
  v_max_f32 v169, 0, v169
  v_add_f32 v159, v159, v161
  v_bfe_u32 v175, v1, 3, 1
  v_lshl_add_u32 v174, v175, 30, v174
  v_add_f32_dpp v158, v158, v158 row_ror:8 row_mask:0xf bank_mask:0xf
  v_add_f32_dpp v159, v159, v159 row_ror:8 row_mask:0xf bank_mask:0xf
  s_lshl_b32 s78, s71, 4
  s_add_u32 s78, s78, s69
  s_lshl_b32 s78, s78, 2
  s_add_u32 s78, s78, s68
  s_lshl_b32 s78, s78, 8
  s_add_u32 s78, s78, 65536
  v_add_u32 v174, s78, v174
  s_waitcnt lgkmcnt(6)
  v_mfma_f32_32x32x16_bf16 v[80:95], a[168:171], a[8:11], v[80:95]
  ds_read_b64_tr_b16 a[188:189], v213 offset:14336
  ds_read_b64_tr_b16 a[190:191], v213 offset:14848
  buffer_load_dwordx4 v47, s[36:39], s101 offen offset:1152 lds
  buffer_load_dword v45, v45, s[64:67], 0 offen sc1
  buffer_store_dwordx2 v[168:169], v172, s[48:51], 0 offen sc1
  buffer_store_dwordx2 v[158:159], v174, s[48:51], 0 offen sc1
  v_mul_u32_u24 v252, 176, v252
  v_and_b32 v253, 16, v29
  v_add_u32 v252, v252, v253
  v_add_u32 v20, 81920, v252
  s_waitcnt vmcnt(11)
  s_barrier
  v_mfma_f32_32x32x16_bf16 v[80:95], a[172:175], a[12:15], v[80:95]
  ds_read_b64_tr_b16 a[160:161], v212 offset:16384
  ds_read_b64_tr_b16 a[162:163], v212 offset:16896
  ds_read_b128 a[16:19], v6 offset:4096
  s_add_u32 s100, s76, 384
  s_add_u32 m0, s86, 0
  s_waitcnt lgkmcnt(7)
  v_mfma_f32_32x32x16_bf16 v[96:111], a[176:179], a[0:3], 0
  ds_read_b64_tr_b16 a[164:165], v212 offset:18432
  ds_read_b64_tr_b16 a[166:167], v212 offset:18944
  ds_read_b128 a[20:23], v7 offset:4096
  buffer_load_dwordx4 v2, s[28:31], s100 offen offset:0 lds
  v_mfma_f32_32x32x16_bf16 v[96:111], a[180:183], a[4:7], v[96:111]
  ds_read_b64_tr_b16 a[168:169], v212 offset:20480
  ds_read_b64_tr_b16 a[170:171], v212 offset:20992
  ds_read_b128 a[24:27], v8 offset:4096
  buffer_load_dwordx4 v3, s[28:31], s100 offen offset:1024 lds
  s_waitcnt lgkmcnt(9)
  v_mfma_f32_32x32x16_bf16 v[96:111], a[184:187], a[8:11], v[96:111]
  ds_read_b64_tr_b16 a[172:173], v212 offset:22528
  ds_read_b64_tr_b16 a[174:175], v212 offset:23040
  ds_read_b128 a[28:31], v9 offset:4096
  v_mfma_f32_32x32x16_bf16 v[96:111], a[188:191], a[12:15], v[96:111]
  ds_read_b64_tr_b16 a[176:177], v213 offset:16384
  ds_read_b64_tr_b16 a[178:179], v213 offset:16896
  buffer_load_dwordx4 v4, s[28:31], s100 offen offset:2048 lds
  s_waitcnt lgkmcnt(9)
  v_mfma_f32_32x32x16_bf16 v[48:63], a[160:163], a[16:19], v[48:63]
  ds_read_b64_tr_b16 a[180:181], v213 offset:18432
  ds_read_b64_tr_b16 a[182:183], v213 offset:18944
  s_waitcnt lgkmcnt(10)
  v_mfma_f32_32x32x16_bf16 v[48:63], a[164:167], a[20:23], v[48:63]
  ds_read_b64_tr_b16 a[184:185], v213 offset:20480
  ds_read_b64_tr_b16 a[186:187], v213 offset:20992
  buffer_load_dwordx4 v5, s[28:31], s100 offen offset:3072 lds
  s_waitcnt lgkmcnt(7)
  v_mfma_f32_32x32x16_bf16 v[48:63], a[168:171], a[24:27], v[48:63]
  ds_read_b64_tr_b16 a[188:189], v213 offset:22528
  ds_read_b64_tr_b16 a[190:191], v213 offset:23040
  s_add_u32 s101, s3, 663552
  s_add_u32 m0, s91, 49152
  s_waitcnt lgkmcnt(8)
  v_mfma_f32_32x32x16_bf16 v[48:63], a[172:175], a[28:31], v[48:63]
  ds_read_b64_tr_b16 a[160:161], v212 offset:24576
  ds_read_b64_tr_b16 a[162:163], v212 offset:25088
  buffer_load_dwordx4 v46, s[36:39], s101 offen offset:0 lds
  s_waitcnt lgkmcnt(6)
  v_mfma_f32_32x32x16_bf16 v[64:79], a[176:179], a[16:19], v[64:79]
  ds_read_b64_tr_b16 a[164:165], v212 offset:26624
  ds_read_b64_tr_b16 a[166:167], v212 offset:27136
  v_mfma_f32_32x32x16_bf16 v[64:79], a[180:183], a[20:23], v[64:79]
  ds_read_b64_tr_b16 a[168:169], v212 offset:28672
  ds_read_b64_tr_b16 a[170:171], v212 offset:29184
  buffer_load_dwordx4 v47, s[36:39], s101 offen offset:1024 lds
  s_waitcnt lgkmcnt(6)
  v_mfma_f32_32x32x16_bf16 v[64:79], a[184:187], a[24:27], v[64:79]
  ds_read_b64_tr_b16 a[172:173], v212 offset:30720
  ds_read_b64_tr_b16 a[174:175], v212 offset:31232
  s_add_u32 m0, s91, 57216
  v_mfma_f32_32x32x16_bf16 v[64:79], a[188:191], a[28:31], v[64:79]
  ds_read_b64_tr_b16 a[176:177], v213 offset:24576
  ds_read_b64_tr_b16 a[178:179], v213 offset:25088
  buffer_load_dwordx4 v46, s[36:39], s101 offen offset:128 lds
  s_waitcnt lgkmcnt(6)
  v_mfma_f32_32x32x16_bf16 v[80:95], a[160:163], a[16:19], v[80:95]
  ds_read_b64_tr_b16 a[180:181], v213 offset:26624
  ds_read_b64_tr_b16 a[182:183], v213 offset:27136
  v_mfma_f32_32x32x16_bf16 v[80:95], a[164:167], a[20:23], v[80:95]
  ds_read_b64_tr_b16 a[184:185], v213 offset:28672
  ds_read_b64_tr_b16 a[186:187], v213 offset:29184
  buffer_load_dwordx4 v47, s[36:39], s101 offen offset:1152 lds
  s_waitcnt vmcnt(10)
  v_readfirstlane_b32 s74, v45
  s_nop 0
  s_cmp_eq_u32 s74, 0
  s_cbranch_scc1 L_nslow35
L_nback36:
  s_waitcnt vmcnt(8)
  s_mov_b64 exec, 1
  ds_add_rtn_u32 v26, v200, v201 offset:4
  s_mov_b64 exec, -1
  s_waitcnt lgkmcnt(0)
  v_readfirstlane_b32 s82, v26
  s_nop 0
  s_cmp_lg_u32 s82, 3
  s_cbranch_scc1 L_sig38
  s_add_u32 s82, s74, 1
  v_mov_b32 v26, s82
  s_mov_b32 s82, 5275648
  buffer_store_dword v26, v206, s[48:51], s82 offen sc1
L_sig38:
  v_mfma_f32_32x32x16_bf16 v[80:95], a[168:171], a[24:27], v[80:95]
  ds_read_b64_tr_b16 a[188:189], v213 offset:30720
  ds_read_b64_tr_b16 a[190:191], v213 offset:31232
  s_barrier
  v_mfma_f32_32x32x16_bf16 v[80:95], a[172:175], a[28:31], v[80:95]
  ds_read_b64_tr_b16 a[160:161], v212 offset:32768
  ds_read_b64_tr_b16 a[162:163], v212 offset:33280
  ds_read_b128 a[32:35], v6 offset:8192
  s_add_u32 s100, s76, 512
  s_add_u32 m0, s86, 4096
  v_mfma_f32_32x32x16_bf16 v[96:111], a[176:179], a[16:19], v[96:111]
  ds_read_b64_tr_b16 a[164:165], v212 offset:34816
  ds_read_b64_tr_b16 a[166:167], v212 offset:35328
  ds_read_b128 a[36:39], v7 offset:8192
  buffer_load_dwordx4 v2, s[28:31], s100 offen offset:0 lds
  v_mfma_f32_32x32x16_bf16 v[96:111], a[180:183], a[20:23], v[96:111]
  ds_read_b64_tr_b16 a[168:169], v212 offset:36864
  ds_read_b64_tr_b16 a[170:171], v212 offset:37376
  ds_read_b128 a[40:43], v8 offset:8192
  buffer_load_dwordx4 v3, s[28:31], s100 offen offset:1024 lds
  s_waitcnt lgkmcnt(9)
  v_mfma_f32_32x32x16_bf16 v[96:111], a[184:187], a[24:27], v[96:111]
  ds_read_b64_tr_b16 a[172:173], v212 offset:38912
  ds_read_b64_tr_b16 a[174:175], v212 offset:39424
  ds_read_b128 a[44:47], v9 offset:8192
  v_mfma_f32_32x32x16_bf16 v[96:111], a[188:191], a[28:31], v[96:111]
  ds_read_b64_tr_b16 a[176:177], v213 offset:32768
  ds_read_b64_tr_b16 a[178:179], v213 offset:33280
  buffer_load_dwordx4 v4, s[28:31], s100 offen offset:2048 lds
  s_waitcnt lgkmcnt(9)
  v_mfma_f32_32x32x16_bf16 v[48:63], a[160:163], a[32:35], v[48:63]
  ds_read_b64_tr_b16 a[180:181], v213 offset:34816
  ds_read_b64_tr_b16 a[182:183], v213 offset:35328
  buffer_load_dwordx4 v5, s[28:31], s100 offen offset:3072 lds
  s_waitcnt lgkmcnt(10)
  v_mfma_f32_32x32x16_bf16 v[48:63], a[164:167], a[36:39], v[48:63]
  ds_read_b64_tr_b16 a[184:185], v213 offset:36864
  ds_read_b64_tr_b16 a[186:187], v213 offset:37376
  s_add_u32 s101, s3, 884736
  s_add_u32 m0, s91, 0
  s_waitcnt lgkmcnt(7)
  v_mfma_f32_32x32x16_bf16 v[48:63], a[168:171], a[40:43], v[48:63]
  ds_read_b64_tr_b16 a[188:189], v213 offset:38912
  ds_read_b64_tr_b16 a[190:191], v213 offset:39424
  buffer_load_dwordx4 v46, s[36:39], s101 offen offset:0 lds
  s_waitcnt lgkmcnt(8)
  v_mfma_f32_32x32x16_bf16 v[48:63], a[172:175], a[44:47], v[48:63]
  ds_read_b64_tr_b16 a[160:161], v212 offset:40960
  ds_read_b64_tr_b16 a[162:163], v212 offset:41472
  buffer_load_dwordx4 v47, s[36:39], s101 offen offset:1024 lds
  s_waitcnt lgkmcnt(6)
  v_mfma_f32_32x32x16_bf16 v[64:79], a[176:179], a[32:35], v[64:79]
  ds_read_b64_tr_b16 a[164:165], v212 offset:43008
  ds_read_b64_tr_b16 a[166:167], v212 offset:43520
  s_add_u32 m0, s91, 8064
  v_mfma_f32_32x32x16_bf16 v[64:79], a[180:183], a[36:39], v[64:79]
  ds_read_b64_tr_b16 a[168:169], v212 offset:45056
  ds_read_b64_tr_b16 a[170:171], v212 offset:45568
  buffer_load_dwordx4 v46, s[36:39], s101 offen offset:128 lds
  s_waitcnt lgkmcnt(6)
  v_mfma_f32_32x32x16_bf16 v[64:79], a[184:187], a[40:43], v[64:79]
  ds_read_b64_tr_b16 a[172:173], v212 offset:47104
  ds_read_b64_tr_b16 a[174:175], v212 offset:47616
  buffer_load_dwordx4 v47, s[36:39], s101 offen offset:1152 lds
  v_mfma_f32_32x32x16_bf16 v[64:79], a[188:191], a[44:47], v[64:79]
  ds_read_b64_tr_b16 a[176:177], v213 offset:40960
  ds_read_b64_tr_b16 a[178:179], v213 offset:41472
  s_waitcnt lgkmcnt(6)
  v_mfma_f32_32x32x16_bf16 v[80:95], a[160:163], a[32:35], v[80:95]
  ds_read_b64_tr_b16 a[180:181], v213 offset:43008
  ds_read_b64_tr_b16 a[182:183], v213 offset:43520
  s_mov_b32 exec_hi, 0
  s_mov_b32 exec_lo, 131071
  buffer_load_dword v39, v179, s[44:47], s96 offen
  s_mov_b64 exec, -1
  v_mfma_f32_32x32x16_bf16 v[80:95], a[164:167], a[36:39], v[80:95]
  ds_read_b64_tr_b16 a[184:185], v213 offset:45056
  ds_read_b64_tr_b16 a[186:187], v213 offset:45568
  s_mov_b32 exec_hi, 0
  s_mov_b32 exec_lo, 127
  buffer_load_dword v39, v179, s[40:43], s97 offen
  s_mov_b64 exec, -1
  s_waitcnt lgkmcnt(6)
  v_mfma_f32_32x32x16_bf16 v[80:95], a[168:171], a[40:43], v[80:95]
  ds_read_b64_tr_b16 a[188:189], v213 offset:47104
  ds_read_b64_tr_b16 a[190:191], v213 offset:47616
  buffer_load_ushort v178, v221, s[56:59], 0 offen
  s_waitcnt vmcnt(11)
  s_barrier
  v_mfma_f32_32x32x16_bf16 v[80:95], a[172:175], a[44:47], v[80:95]
  ds_read_b64_tr_b16 a[160:161], v212 offset:49152
  ds_read_b64_tr_b16 a[162:163], v212 offset:49664
  ds_read_b128 a[48:51], v6 offset:0
  buffer_load_dwordx2 v[226:227], v199, s[60:63], 0 offen offset:0
  s_add_u32 s100, s76, 640
  s_add_u32 m0, s86, 8192
  s_waitcnt lgkmcnt(7)
  v_mfma_f32_32x32x16_bf16 v[96:111], a[176:179], a[32:35], v[96:111]
  ds_read_b64_tr_b16 a[164:165], v212 offset:51200
  ds_read_b64_tr_b16 a[166:167], v212 offset:51712
  ds_read_b128 a[52:55], v7 offset:0
  buffer_load_dwordx4 v2, s[28:31], s100 offen offset:0 lds
  buffer_load_dwordx2 v[230:231], v199, s[60:63], 0 offen offset:32
  v_mfma_f32_32x32x16_bf16 v[96:111], a[180:183], a[36:39], v[96:111]
  ds_read_b64_tr_b16 a[168:169], v212 offset:53248
  ds_read_b64_tr_b16 a[170:171], v212 offset:53760
  ds_read_b128 a[56:59], v8 offset:0
  buffer_load_dwordx4 v3, s[28:31], s100 offen offset:1024 lds
  buffer_load_dwordx2 v[234:235], v199, s[60:63], 0 offen offset:64
  s_waitcnt lgkmcnt(9)
  v_mfma_f32_32x32x16_bf16 v[96:111], a[184:187], a[40:43], v[96:111]
  ds_read_b64_tr_b16 a[172:173], v212 offset:55296
  ds_read_b64_tr_b16 a[174:175], v212 offset:55808
  ds_read_b128 a[60:63], v9 offset:0
  buffer_load_dwordx2 v[238:239], v199, s[60:63], 0 offen offset:96
  v_mfma_f32_32x32x16_bf16 v[96:111], a[188:191], a[44:47], v[96:111]
  ds_read_b64_tr_b16 a[176:177], v213 offset:49152
  ds_read_b64_tr_b16 a[178:179], v213 offset:49664
  buffer_load_dwordx4 v4, s[28:31], s100 offen offset:2048 lds
  buffer_load_dwordx2 v[242:243], v199, s[60:63], 0 offen offset:128
  s_waitcnt lgkmcnt(9)
  v_mfma_f32_32x32x16_bf16 v[48:63], a[160:163], a[48:51], v[48:63]
  ds_read_b64_tr_b16 a[180:181], v213 offset:51200
  ds_read_b64_tr_b16 a[182:183], v213 offset:51712
  s_waitcnt lgkmcnt(10)
  v_mfma_f32_32x32x16_bf16 v[48:63], a[164:167], a[52:55], v[48:63]
  ds_read_b64_tr_b16 a[184:185], v213 offset:53248
  ds_read_b64_tr_b16 a[186:187], v213 offset:53760
  buffer_load_dwordx4 v5, s[28:31], s100 offen offset:3072 lds
  s_waitcnt lgkmcnt(7)
  v_mfma_f32_32x32x16_bf16 v[48:63], a[168:171], a[56:59], v[48:63]
  ds_read_b64_tr_b16 a[188:189], v213 offset:55296
  ds_read_b64_tr_b16 a[190:191], v213 offset:55808
  s_add_u32 s101, s3, 1105920
  s_add_u32 m0, s91, 16384
  s_waitcnt lgkmcnt(8)
  v_mfma_f32_32x32x16_bf16 v[48:63], a[172:175], a[60:63], v[48:63]
  ds_read_b64_tr_b16 a[160:161], v212 offset:57344
  ds_read_b64_tr_b16 a[162:163], v212 offset:57856
  buffer_load_dwordx4 v46, s[36:39], s101 offen offset:0 lds
  s_waitcnt lgkmcnt(6)
  v_mfma_f32_32x32x16_bf16 v[64:79], a[176:179], a[48:51], v[64:79]
  ds_read_b64_tr_b16 a[164:165], v212 offset:59392
  ds_read_b64_tr_b16 a[166:167], v212 offset:59904
  v_mfma_f32_32x32x16_bf16 v[64:79], a[180:183], a[52:55], v[64:79]
  ds_read_b64_tr_b16 a[168:169], v212 offset:61440
  ds_read_b64_tr_b16 a[170:171], v212 offset:61952
  buffer_load_dwordx4 v47, s[36:39], s101 offen offset:1024 lds
  s_waitcnt lgkmcnt(6)
  v_mfma_f32_32x32x16_bf16 v[64:79], a[184:187], a[56:59], v[64:79]
  ds_read_b64_tr_b16 a[172:173], v212 offset:63488
  ds_read_b64_tr_b16 a[174:175], v212 offset:64000
  s_add_u32 m0, s91, 24448
  v_mfma_f32_32x32x16_bf16 v[64:79], a[188:191], a[60:63], v[64:79]
  ds_read_b64_tr_b16 a[176:177], v213 offset:57344
  ds_read_b64_tr_b16 a[178:179], v213 offset:57856
  buffer_load_dwordx4 v46, s[36:39], s101 offen offset:128 lds
  s_waitcnt lgkmcnt(6)
  v_mfma_f32_32x32x16_bf16 v[80:95], a[160:163], a[48:51], v[80:95]
  ds_read_b64_tr_b16 a[180:181], v213 offset:59392
  ds_read_b64_tr_b16 a[182:183], v213 offset:59904
  v_mfma_f32_32x32x16_bf16 v[80:95], a[164:167], a[52:55], v[80:95]
  ds_read_b64_tr_b16 a[184:185], v213 offset:61440
  ds_read_b64_tr_b16 a[186:187], v213 offset:61952
  buffer_load_dwordx4 v47, s[36:39], s101 offen offset:1152 lds
  s_waitcnt lgkmcnt(6)
  v_mfma_f32_32x32x16_bf16 v[80:95], a[168:171], a[56:59], v[80:95]
  ds_read_b64_tr_b16 a[188:189], v213 offset:63488
  ds_read_b64_tr_b16 a[190:191], v213 offset:64000
  s_waitcnt vmcnt(16)
  s_barrier
  v_mfma_f32_32x32x16_bf16 v[80:95], a[172:175], a[60:63], v[80:95]
  ds_read_b64_tr_b16 a[160:161], v212 offset:0
  ds_read_b64_tr_b16 a[162:163], v212 offset:512
  ds_read_b128 a[64:67], v6 offset:4096
  s_add_u32 s100, s76, 768
  s_add_u32 m0, s86, 0
  s_waitcnt lgkmcnt(7)
  v_mfma_f32_32x32x16_bf16 v[96:111], a[176:179], a[48:51], v[96:111]
  ds_read_b64_tr_b16 a[164:165], v212 offset:2048
  ds_read_b64_tr_b16 a[166:167], v212 offset:2560
  ds_read_b128 a[68:71], v7 offset:4096
  buffer_load_dwordx4 v2, s[28:31], s100 offen offset:0 lds
  v_mfma_f32_32x32x16_bf16 v[96:111], a[180:183], a[52:55], v[96:111]
  ds_read_b64_tr_b16 a[168:169], v212 offset:4096
  ds_read_b64_tr_b16 a[170:171], v212 offset:4608
  ds_read_b128 a[72:75], v8 offset:4096
  buffer_load_dwordx4 v3, s[28:31], s100 offen offset:1024 lds
  s_waitcnt lgkmcnt(9)
  v_mfma_f32_32x32x16_bf16 v[96:111], a[184:187], a[56:59], v[96:111]
  ds_read_b64_tr_b16 a[172:173], v212 offset:6144
  ds_read_b64_tr_b16 a[174:175], v212 offset:6656
  ds_read_b128 a[76:79], v9 offset:4096
  v_mfma_f32_32x32x16_bf16 v[96:111], a[188:191], a[60:63], v[96:111]
  ds_read_b64_tr_b16 a[176:177], v213 offset:0
  ds_read_b64_tr_b16 a[178:179], v213 offset:512
  buffer_load_dwordx4 v4, s[28:31], s100 offen offset:2048 lds
  s_waitcnt lgkmcnt(9)
  v_mfma_f32_32x32x16_bf16 v[48:63], a[160:163], a[64:67], v[48:63]
  ds_read_b64_tr_b16 a[180:181], v213 offset:2048
  ds_read_b64_tr_b16 a[182:183], v213 offset:2560
  s_waitcnt lgkmcnt(10)
  v_mfma_f32_32x32x16_bf16 v[48:63], a[164:167], a[68:71], v[48:63]
  ds_read_b64_tr_b16 a[184:185], v213 offset:4096
  ds_read_b64_tr_b16 a[186:187], v213 offset:4608
  buffer_load_dwordx4 v5, s[28:31], s100 offen offset:3072 lds
  s_waitcnt lgkmcnt(7)
  v_mfma_f32_32x32x16_bf16 v[48:63], a[168:171], a[72:75], v[48:63]
  ds_read_b64_tr_b16 a[188:189], v213 offset:6144
  ds_read_b64_tr_b16 a[190:191], v213 offset:6656
  s_add_u32 s101, s3, 1327104
  s_add_u32 m0, s91, 32768
  s_waitcnt lgkmcnt(8)
  v_mfma_f32_32x32x16_bf16 v[48:63], a[172:175], a[76:79], v[48:63]
  ds_read_b64_tr_b16 a[160:161], v212 offset:8192
  ds_read_b64_tr_b16 a[162:163], v212 offset:8704
  buffer_load_dwordx4 v46, s[36:39], s101 offen offset:0 lds
  s_waitcnt lgkmcnt(6)
  v_mfma_f32_32x32x16_bf16 v[64:79], a[176:179], a[64:67], v[64:79]
  ds_read_b64_tr_b16 a[164:165], v212 offset:10240
  ds_read_b64_tr_b16 a[166:167], v212 offset:10752
  v_mfma_f32_32x32x16_bf16 v[64:79], a[180:183], a[68:71], v[64:79]
  ds_read_b64_tr_b16 a[168:169], v212 offset:12288
  ds_read_b64_tr_b16 a[170:171], v212 offset:12800
  buffer_load_dwordx4 v47, s[36:39], s101 offen offset:1024 lds
  s_waitcnt lgkmcnt(6)
  v_mfma_f32_32x32x16_bf16 v[64:79], a[184:187], a[72:75], v[64:79]
  ds_read_b64_tr_b16 a[172:173], v212 offset:14336
  ds_read_b64_tr_b16 a[174:175], v212 offset:14848
  s_add_u32 m0, s91, 40832
  v_mfma_f32_32x32x16_bf16 v[64:79], a[188:191], a[76:79], v[64:79]
  ds_read_b64_tr_b16 a[176:177], v213 offset:8192
  ds_read_b64_tr_b16 a[178:179], v213 offset:8704
  buffer_load_dwordx4 v46, s[36:39], s101 offen offset:128 lds
  s_waitcnt lgkmcnt(6)
  v_mfma_f32_32x32x16_bf16 v[80:95], a[160:163], a[64:67], v[80:95]
  ds_read_b64_tr_b16 a[180:181], v213 offset:10240
  ds_read_b64_tr_b16 a[182:183], v213 offset:10752
  v_mfma_f32_32x32x16_bf16 v[80:95], a[164:167], a[68:71], v[80:95]
  ds_read_b64_tr_b16 a[184:185], v213 offset:12288
  ds_read_b64_tr_b16 a[186:187], v213 offset:12800
  buffer_load_dwordx4 v47, s[36:39], s101 offen offset:1152 lds
  s_waitcnt lgkmcnt(6)
  v_mfma_f32_32x32x16_bf16 v[80:95], a[168:171], a[72:75], v[80:95]
  ds_read_b64_tr_b16 a[188:189], v213 offset:14336
  ds_read_b64_tr_b16 a[190:191], v213 offset:14848
  s_waitcnt vmcnt(8)
  s_barrier
  v_mfma_f32_32x32x16_bf16 v[80:95], a[172:175], a[76:79], v[80:95]
  ds_read_b64_tr_b16 a[160:161], v212 offset:16384
  ds_read_b64_tr_b16 a[162:163], v212 offset:16896
  ds_read_b128 a[80:83], v6 offset:8192
  s_add_u32 s100, s76, 896
  s_add_u32 m0, s86, 4096
  s_waitcnt lgkmcnt(7)
  v_mfma_f32_32x32x16_bf16 v[96:111], a[176:179], a[64:67], v[96:111]
  ds_read_b64_tr_b16 a[164:165], v212 offset:18432
  ds_read_b64_tr_b16 a[166:167], v212 offset:18944
  ds_read_b128 a[84:87], v7 offset:8192
  buffer_load_dwordx4 v2, s[28:31], s100 offen offset:0 lds
  v_mfma_f32_32x32x16_bf16 v[96:111], a[180:183], a[68:71], v[96:111]
  ds_read_b64_tr_b16 a[168:169], v212 offset:20480
  ds_read_b64_tr_b16 a[170:171], v212 offset:20992
  ds_read_b128 a[88:91], v8 offset:8192
  buffer_load_dwordx4 v3, s[28:31], s100 offen offset:1024 lds
  s_waitcnt lgkmcnt(9)
  v_mfma_f32_32x32x16_bf16 v[96:111], a[184:187], a[72:75], v[96:111]
  ds_read_b64_tr_b16 a[172:173], v212 offset:22528
  ds_read_b64_tr_b16 a[174:175], v212 offset:23040
  ds_read_b128 a[92:95], v9 offset:8192
  v_mfma_f32_32x32x16_bf16 v[96:111], a[188:191], a[76:79], v[96:111]
  ds_read_b64_tr_b16 a[176:177], v213 offset:16384
  ds_read_b64_tr_b16 a[178:179], v213 offset:16896
  buffer_load_dwordx4 v4, s[28:31], s100 offen offset:2048 lds
  s_waitcnt lgkmcnt(9)
  v_mfma_f32_32x32x16_bf16 v[48:63], a[160:163], a[80:83], v[48:63]
  ds_read_b64_tr_b16 a[180:181], v213 offset:18432
  ds_read_b64_tr_b16 a[182:183], v213 offset:18944
  s_waitcnt lgkmcnt(10)
  v_mfma_f32_32x32x16_bf16 v[48:63], a[164:167], a[84:87], v[48:63]
  ds_read_b64_tr_b16 a[184:185], v213 offset:20480
  ds_read_b64_tr_b16 a[186:187], v213 offset:20992
  buffer_load_dwordx4 v5, s[28:31], s100 offen offset:3072 lds
  s_waitcnt lgkmcnt(7)
  v_mfma_f32_32x32x16_bf16 v[48:63], a[168:171], a[88:91], v[48:63]
  ds_read_b64_tr_b16 a[188:189], v213 offset:22528
  ds_read_b64_tr_b16 a[190:191], v213 offset:23040
  s_add_u32 s101, s3, 1548288
  s_add_u32 m0, s91, 49152
  s_waitcnt lgkmcnt(8)
  v_mfma_f32_32x32x16_bf16 v[48:63], a[172:175], a[92:95], v[48:63]
  ds_read_b64_tr_b16 a[160:161], v212 offset:24576
  ds_read_b64_tr_b16 a[162:163], v212 offset:25088
  buffer_load_dwordx4 v46, s[36:39], s101 offen offset:0 lds
  s_waitcnt lgkmcnt(6)
  v_mfma_f32_32x32x16_bf16 v[64:79], a[176:179], a[80:83], v[64:79]
  ds_read_b64_tr_b16 a[164:165], v212 offset:26624
  ds_read_b64_tr_b16 a[166:167], v212 offset:27136
  v_mfma_f32_32x32x16_bf16 v[64:79], a[180:183], a[84:87], v[64:79]
  ds_read_b64_tr_b16 a[168:169], v212 offset:28672
  ds_read_b64_tr_b16 a[170:171], v212 offset:29184
  buffer_load_dwordx4 v47, s[36:39], s101 offen offset:1024 lds
  s_waitcnt lgkmcnt(6)
  v_mfma_f32_32x32x16_bf16 v[64:79], a[184:187], a[88:91], v[64:79]
  ds_read_b64_tr_b16 a[172:173], v212 offset:30720
  ds_read_b64_tr_b16 a[174:175], v212 offset:31232
  s_add_u32 m0, s91, 57216
  v_mfma_f32_32x32x16_bf16 v[64:79], a[188:191], a[92:95], v[64:79]
  ds_read_b64_tr_b16 a[176:177], v213 offset:24576
  ds_read_b64_tr_b16 a[178:179], v213 offset:25088
  buffer_load_dwordx4 v46, s[36:39], s101 offen offset:128 lds
  s_waitcnt lgkmcnt(6)
  v_mfma_f32_32x32x16_bf16 v[80:95], a[160:163], a[80:83], v[80:95]
  ds_read_b64_tr_b16 a[180:181], v213 offset:26624
  ds_read_b64_tr_b16 a[182:183], v213 offset:27136
  v_mfma_f32_32x32x16_bf16 v[80:95], a[164:167], a[84:87], v[80:95]
  ds_read_b64_tr_b16 a[184:185], v213 offset:28672
  ds_read_b64_tr_b16 a[186:187], v213 offset:29184
  buffer_load_dwordx4 v47, s[36:39], s101 offen offset:1152 lds
  s_waitcnt lgkmcnt(6)
  v_mfma_f32_32x32x16_bf16 v[80:95], a[168:171], a[88:91], v[80:95]
  ds_read_b64_tr_b16 a[188:189], v213 offset:30720
  ds_read_b64_tr_b16 a[190:191], v213 offset:31232
  s_waitcnt vmcnt(8)
  s_barrier
  v_mfma_f32_32x32x16_bf16 v[80:95], a[172:175], a[92:95], v[80:95]
  ds_read_b64_tr_b16 a[160:161], v212 offset:32768
  ds_read_b64_tr_b16 a[162:163], v212 offset:33280
  ds_read_b128 a[96:99], v6 offset:0
  s_add_u32 s100, s76, 1024
  s_add_u32 m0, s86, 8192
  s_waitcnt lgkmcnt(7)
  v_mfma_f32_32x32x16_bf16 v[96:111], a[176:179], a[80:83], v[96:111]
  ds_read_b64_tr_b16 a[164:165], v212 offset:34816
  ds_read_b64_tr_b16 a[166:167], v212 offset:35328
  ds_read_b128 a[100:103], v7 offset:0
  buffer_load_dwordx4 v2, s[28:31], s100 offen offset:0 lds
  v_mfma_f32_32x32x16_bf16 v[96:111], a[180:183], a[84:87], v[96:111]
  ds_read_b64_tr_b16 a[168:169], v212 offset:36864
  ds_read_b64_tr_b16 a[170:171], v212 offset:37376
  ds_read_b128 a[104:107], v8 offset:0
  buffer_load_dwordx4 v3, s[28:31], s100 offen offset:1024 lds
  s_waitcnt lgkmcnt(9)
  v_mfma_f32_32x32x16_bf16 v[96:111], a[184:187], a[88:91], v[96:111]
  ds_read_b64_tr_b16 a[172:173], v212 offset:38912
  ds_read_b64_tr_b16 a[174:175], v212 offset:39424
  ds_read_b128 a[108:111], v9 offset:0
  v_mfma_f32_32x32x16_bf16 v[96:111], a[188:191], a[92:95], v[96:111]
  ds_read_b64_tr_b16 a[176:177], v213 offset:32768
  ds_read_b64_tr_b16 a[178:179], v213 offset:33280
  buffer_load_dwordx4 v4, s[28:31], s100 offen offset:2048 lds
  s_waitcnt lgkmcnt(9)
  v_mfma_f32_32x32x16_bf16 v[48:63], a[160:163], a[96:99], v[48:63]
  ds_read_b64_tr_b16 a[180:181], v213 offset:34816
  ds_read_b64_tr_b16 a[182:183], v213 offset:35328
  s_waitcnt lgkmcnt(10)
  v_mfma_f32_32x32x16_bf16 v[48:63], a[164:167], a[100:103], v[48:63]
  ds_read_b64_tr_b16 a[184:185], v213 offset:36864
  ds_read_b64_tr_b16 a[186:187], v213 offset:37376
  buffer_load_dwordx4 v5, s[28:31], s100 offen offset:3072 lds
  s_waitcnt lgkmcnt(7)
  v_mfma_f32_32x32x16_bf16 v[48:63], a[168:171], a[104:107], v[48:63]
  ds_read_b64_tr_b16 a[188:189], v213 offset:38912
  ds_read_b64_tr_b16 a[190:191], v213 offset:39424
  s_add_u32 s101, s3, 1769472
  s_add_u32 m0, s91, 0
  s_waitcnt lgkmcnt(8)
  v_mfma_f32_32x32x16_bf16 v[48:63], a[172:175], a[108:111], v[48:63]
  ds_read_b64_tr_b16 a[160:161], v212 offset:40960
  ds_read_b64_tr_b16 a[162:163], v212 offset:41472
  buffer_load_dwordx4 v46, s[36:39], s101 offen offset:0 lds
  s_waitcnt lgkmcnt(6)
  v_mfma_f32_32x32x16_bf16 v[64:79], a[176:179], a[96:99], v[64:79]
  ds_read_b64_tr_b16 a[164:165], v212 offset:43008
  ds_read_b64_tr_b16 a[166:167], v212 offset:43520
  v_mfma_f32_32x32x16_bf16 v[64:79], a[180:183], a[100:103], v[64:79]
  ds_read_b64_tr_b16 a[168:169], v212 offset:45056
  ds_read_b64_tr_b16 a[170:171], v212 offset:45568
  buffer_load_dwordx4 v47, s[36:39], s101 offen offset:1024 lds
  s_waitcnt lgkmcnt(6)
  v_mfma_f32_32x32x16_bf16 v[64:79], a[184:187], a[104:107], v[64:79]
  ds_read_b64_tr_b16 a[172:173], v212 offset:47104
  ds_read_b64_tr_b16 a[174:175], v212 offset:47616
  s_add_u32 m0, s91, 8064
  v_mfma_f32_32x32x16_bf16 v[64:79], a[188:191], a[108:111], v[64:79]
  ds_read_b64_tr_b16 a[176:177], v213 offset:40960
  ds_read_b64_tr_b16 a[178:179], v213 offset:41472
  buffer_load_dwordx4 v46, s[36:39], s101 offen offset:128 lds
  s_waitcnt lgkmcnt(6)
  v_mfma_f32_32x32x16_bf16 v[80:95], a[160:163], a[96:99], v[80:95]
  ds_read_b64_tr_b16 a[180:181], v213 offset:43008
  ds_read_b64_tr_b16 a[182:183], v213 offset:43520
  v_mfma_f32_32x32x16_bf16 v[80:95], a[164:167], a[100:103], v[80:95]
  ds_read_b64_tr_b16 a[184:185], v213 offset:45056
  ds_read_b64_tr_b16 a[186:187], v213 offset:45568
  buffer_load_dwordx4 v47, s[36:39], s101 offen offset:1152 lds
  s_mov_b32 s82, 5275648
  buffer_load_dword v27, v17, s[48:51], s82 offen sc1
  s_mov_b32 s82, 5275648
  buffer_load_dword v45, v18, s[48:51], s82 offen sc1
  s_waitcnt lgkmcnt(6)
  v_mfma_f32_32x32x16_bf16 v[80:95], a[168:171], a[104:107], v[80:95]
  ds_read_b64_tr_b16 a[188:189], v213 offset:47104
  ds_read_b64_tr_b16 a[190:191], v213 offset:47616
  s_waitcnt vmcnt(10)
  s_barrier
  v_mfma_f32_32x32x16_bf16 v[80:95], a[172:175], a[108:111], v[80:95]
  ds_read_b64_tr_b16 a[160:161], v212 offset:49152
  ds_read_b64_tr_b16 a[162:163], v212 offset:49664
  ds_read_b128 a[112:115], v6 offset:4096
  s_add_u32 s100, s76, 1152
  s_add_u32 m0, s86, 0
  s_waitcnt lgkmcnt(7)
  v_mfma_f32_32x32x16_bf16 v[96:111], a[176:179], a[96:99], v[96:111]
  ds_read_b64_tr_b16 a[164:165], v212 offset:51200
  ds_read_b64_tr_b16 a[166:167], v212 offset:51712
  ds_read_b128 a[116:119], v7 offset:4096
  buffer_load_dwordx4 v2, s[28:31], s100 offen offset:0 lds
  v_mfma_f32_32x32x16_bf16 v[96:111], a[180:183], a[100:103], v[96:111]
  ds_read_b64_tr_b16 a[168:169], v212 offset:53248
  ds_read_b64_tr_b16 a[170:171], v212 offset:53760
  ds_read_b128 a[120:123], v8 offset:4096
  buffer_load_dwordx4 v3, s[28:31], s100 offen offset:1024 lds
  s_waitcnt lgkmcnt(9)
  v_mfma_f32_32x32x16_bf16 v[96:111], a[184:187], a[104:107], v[96:111]
  ds_read_b64_tr_b16 a[172:173], v212 offset:55296
  ds_read_b64_tr_b16 a[174:175], v212 offset:55808
  ds_read_b128 a[124:127], v9 offset:4096
  v_mfma_f32_32x32x16_bf16 v[96:111], a[188:191], a[108:111], v[96:111]
  ds_read_b64_tr_b16 a[176:177], v213 offset:49152
  ds_read_b64_tr_b16 a[178:179], v213 offset:49664
  buffer_load_dwordx4 v4, s[28:31], s100 offen offset:2048 lds
  s_waitcnt lgkmcnt(9)
  v_mfma_f32_32x32x16_bf16 v[48:63], a[160:163], a[112:115], v[48:63]
  ds_read_b64_tr_b16 a[180:181], v213 offset:51200
  ds_read_b64_tr_b16 a[182:183], v213 offset:51712
  s_waitcnt lgkmcnt(10)
  v_mfma_f32_32x32x16_bf16 v[48:63], a[164:167], a[116:119], v[48:63]
  ds_read_b64_tr_b16 a[184:185], v213 offset:53248
  ds_read_b64_tr_b16 a[186:187], v213 offset:53760
  buffer_load_dwordx4 v5, s[28:31], s100 offen offset:3072 lds
  s_waitcnt lgkmcnt(7)
  v_mfma_f32_32x32x16_bf16 v[48:63], a[168:171], a[120:123], v[48:63]
  ds_read_b64_tr_b16 a[188:189], v213 offset:55296
  ds_read_b64_tr_b16 a[190:191], v213 offset:55808
  s_add_u32 s101, s3, 1990656
  s_add_u32 m0, s91, 16384
  s_waitcnt lgkmcnt(8)
  v_mfma_f32_32x32x16_bf16 v[48:63], a[172:175], a[124:127], v[48:63]
  ds_read_b64_tr_b16 a[160:161], v212 offset:57344
  ds_read_b64_tr_b16 a[162:163], v212 offset:57856
  buffer_load_dwordx4 v46, s[36:39], s101 offen offset:0 lds
  s_waitcnt lgkmcnt(6)
  v_mfma_f32_32x32x16_bf16 v[64:79], a[176:179], a[112:115], v[64:79]
  ds_read_b64_tr_b16 a[164:165], v212 offset:59392
  ds_read_b64_tr_b16 a[166:167], v212 offset:59904
  v_mfma_f32_32x32x16_bf16 v[64:79], a[180:183], a[116:119], v[64:79]
  ds_read_b64_tr_b16 a[168:169], v212 offset:61440
  ds_read_b64_tr_b16 a[170:171], v212 offset:61952
  buffer_load_dwordx4 v47, s[36:39], s101 offen offset:1024 lds
  s_waitcnt lgkmcnt(6)
  v_mfma_f32_32x32x16_bf16 v[64:79], a[184:187], a[120:123], v[64:79]
  ds_read_b64_tr_b16 a[172:173], v212 offset:63488
  ds_read_b64_tr_b16 a[174:175], v212 offset:64000
  s_add_u32 m0, s91, 24448
  v_mfma_f32_32x32x16_bf16 v[64:79], a[188:191], a[124:127], v[64:79]
  ds_read_b64_tr_b16 a[176:177], v213 offset:57344
  ds_read_b64_tr_b16 a[178:179], v213 offset:57856
  buffer_load_dwordx4 v46, s[36:39], s101 offen offset:128 lds
  s_waitcnt lgkmcnt(6)
  v_mfma_f32_32x32x16_bf16 v[80:95], a[160:163], a[112:115], v[80:95]
  ds_read_b64_tr_b16 a[180:181], v213 offset:59392
  ds_read_b64_tr_b16 a[182:183], v213 offset:59904
  v_mfma_f32_32x32x16_bf16 v[80:95], a[164:167], a[116:119], v[80:95]
  ds_read_b64_tr_b16 a[184:185], v213 offset:61440
  ds_read_b64_tr_b16 a[186:187], v213 offset:61952
  buffer_load_dwordx4 v47, s[36:39], s101 offen offset:1152 lds
  s_add_u32 s82, s74, 1
  s_waitcnt vmcnt(9)
  v_cmp_ne_u32 vcc, s82, v27
  s_nop 0
  s_cbranch_vccnz L_slow39
L_back40:
  s_add_u32 s82, s74, 1
  s_waitcnt vmcnt(8)
  v_cmp_ne_u32 vcc, s82, v45
  s_nop 0
  s_cbranch_vccnz L_slow42
L_back43:
  buffer_load_dwordx2 v[128:129], v216, s[48:51], 0 offen sc1
  s_waitcnt lgkmcnt(6)
  v_mfma_f32_32x32x16_bf16 v[80:95], a[168:171], a[120:123], v[80:95]
  ds_read_b64_tr_b16 a[188:189], v213 offset:63488
  ds_read_b64_tr_b16 a[190:191], v213 offset:64000
  buffer_load_dwordx4 v[132:135], v217, s[48:51], 0 offen sc1
  s_barrier
  v_mfma_f32_32x32x16_bf16 v[80:95], a[172:175], a[124:127], v[80:95]
  ds_read_b64_tr_b16 a[160:161], v212 offset:0
  ds_read_b64_tr_b16 a[162:163], v212 offset:512
  ds_read_b128 a[128:131], v6 offset:8192
  buffer_load_dwordx4 v[136:139], v218, s[48:51], 0 offen sc1
  s_add_u32 s101, s73, 0
  s_or_b32 s101, s101, s83
  s_add_u32 m0, s75, 32768
  s_waitcnt lgkmcnt(7)
  v_mfma_f32_32x32x16_bf16 v[96:111], a[176:179], a[112:115], v[96:111]
  ds_read_b64_tr_b16 a[164:165], v212 offset:2048
  ds_read_b64_tr_b16 a[166:167], v212 offset:2560
  ds_read_b128 a[132:135], v7 offset:8192
  buffer_load_dwordx4 v214, s[36:39], s101 offen offset:0 lds
  buffer_load_dwordx4 v[140:143], v219, s[48:51], 0 offen sc1
  v_mfma_f32_32x32x16_bf16 v[96:111], a[180:183], a[116:119], v[96:111]
  ds_read_b64_tr_b16 a[168:169], v212 offset:4096
  ds_read_b64_tr_b16 a[170:171], v212 offset:4608
  ds_read_b128 a[136:139], v8 offset:8192
  buffer_load_dwordx4 v[144:147], v220, s[48:51], 0 offen sc1
  s_waitcnt lgkmcnt(9)
  v_mfma_f32_32x32x16_bf16 v[96:111], a[184:187], a[120:123], v[96:111]
  ds_read_b64_tr_b16 a[172:173], v212 offset:6144
  ds_read_b64_tr_b16 a[174:175], v212 offset:6656
  ds_read_b128 a[140:143], v9 offset:8192
  s_add_u32 s101, s73, 221184
  s_or_b32 s101, s101, s83
  s_add_u32 m0, s75, 36864
  v_mfma_f32_32x32x16_bf16 v[96:111], a[188:191], a[124:127], v[96:111]
  ds_read_b64_tr_b16 a[176:177], v213 offset:0
  ds_read_b64_tr_b16 a[178:179], v213 offset:512
  buffer_load_dwordx4 v214, s[36:39], s101 offen offset:0 lds
  s_waitcnt lgkmcnt(9)
  v_mfma_f32_32x32x16_bf16 v[48:63], a[160:163], a[128:131], v[48:63]
  ds_read_b64_tr_b16 a[180:181], v213 offset:2048
  ds_read_b64_tr_b16 a[182:183], v213 offset:2560
  s_waitcnt lgkmcnt(10)
  v_mfma_f32_32x32x16_bf16 v[48:63], a[164:167], a[132:135], v[48:63]
  ds_read_b64_tr_b16 a[184:185], v213 offset:4096
  ds_read_b64_tr_b16 a[186:187], v213 offset:4608
  s_waitcnt lgkmcnt(7)
  v_mfma_f32_32x32x16_bf16 v[48:63], a[168:171], a[136:139], v[48:63]
  ds_read_b64_tr_b16 a[188:189], v213 offset:6144
  ds_read_b64_tr_b16 a[190:191], v213 offset:6656
  s_add_u32 s101, s73, 442368
  s_or_b32 s101, s101, s83
  s_add_u32 m0, s75, 40960
  s_waitcnt lgkmcnt(8)
  v_mfma_f32_32x32x16_bf16 v[48:63], a[172:175], a[140:143], v[48:63]
  ds_read_b64_tr_b16 a[160:161], v212 offset:8192
  ds_read_b64_tr_b16 a[162:163], v212 offset:8704
  buffer_load_dwordx4 v214, s[36:39], s101 offen offset:0 lds
  s_waitcnt lgkmcnt(6)
  v_mfma_f32_32x32x16_bf16 v[64:79], a[176:179], a[128:131], v[64:79]
  ds_read_b64_tr_b16 a[164:165], v212 offset:10240
  ds_read_b64_tr_b16 a[166:167], v212 offset:10752
  v_mfma_f32_32x32x16_bf16 v[64:79], a[180:183], a[132:135], v[64:79]
  ds_read_b64_tr_b16 a[168:169], v212 offset:12288
  ds_read_b64_tr_b16 a[170:171], v212 offset:12800
  s_waitcnt lgkmcnt(6)
  v_mfma_f32_32x32x16_bf16 v[64:79], a[184:187], a[136:139], v[64:79]
  ds_read_b64_tr_b16 a[172:173], v212 offset:14336
  ds_read_b64_tr_b16 a[174:175], v212 offset:14848
  s_add_u32 s101, s73, 663552
  s_or_b32 s101, s101, s83
  s_add_u32 m0, s75, 45056
  v_mfma_f32_32x32x16_bf16 v[64:79], a[188:191], a[140:143], v[64:79]
  ds_read_b64_tr_b16 a[176:177], v213 offset:8192
  ds_read_b64_tr_b16 a[178:179], v213 offset:8704
  buffer_load_dwordx4 v214, s[36:39], s101 offen offset:0 lds
  s_waitcnt lgkmcnt(6)
  v_mfma_f32_32x32x16_bf16 v[80:95], a[160:163], a[128:131], v[80:95]
  ds_read_b64_tr_b16 a[180:181], v213 offset:10240
  ds_read_b64_tr_b16 a[182:183], v213 offset:10752
  s_waitcnt vmcnt(6)
  v_add_f32 v132, v132, v136
  v_add_f32 v156, 925353388, v129
  v_add_f32 v133, v133, v137
  v_rsq_f32 v32, v156
  v_mfma_f32_32x32x16_bf16 v[80:95], a[164:167], a[132:135], v[80:95]
  ds_read_b64_tr_b16 a[184:185], v213 offset:12288
  ds_read_b64_tr_b16 a[186:187], v213 offset:12800
  v_add_f32 v134, v134, v138
  v_mul_f32 v157, v129, v32
  v_add_f32 v135, v135, v139
  v_mul_f32 v157, v157, v32
  s_waitcnt lgkmcnt(6)
  v_mfma_f32_32x32x16_bf16 v[80:95], a[168:171], a[136:139], v[80:95]
  ds_read_b64_tr_b16 a[188:189], v213 offset:14336
  ds_read_b64_tr_b16 a[190:191], v213 offset:14848
  s_waitcnt vmcnt(4)
  v_add_f32 v132, v132, v140
  v_add_f32 v157, 925353388, v157
  v_add_f32 v133, v133, v141
  v_rsq_f32 v157, v157
  s_barrier
  v_mfma_f32_32x32x16_bf16 v[80:95], a[172:175], a[140:143], v[80:95]
  ds_read_b64_tr_b16 a[160:161], v212 offset:16384
  ds_read_b64_tr_b16 a[162:163], v212 offset:16896
  ds_read_b128 a[144:147], v6 offset:0
  v_add_f32 v134, v134, v142
  v_mul_f32 v34, 1069066811, v32
  v_add_f32 v135, v135, v143
  s_add_u32 s101, s73, 884736
  s_or_b32 s101, s101, s83
  s_add_u32 m0, s75, 49152
  s_waitcnt lgkmcnt(7)
  v_mfma_f32_32x32x16_bf16 v[96:111], a[176:179], a[128:131], v[96:111]
  ds_read_b64_tr_b16 a[164:165], v212 offset:18432
  ds_read_b64_tr_b16 a[166:167], v212 offset:18944
  ds_read_b128 a[148:151], v7 offset:0
  buffer_load_dwordx4 v214, s[36:39], s101 offen offset:0 lds
  v_mfma_f32_32x32x16_bf16 v[96:111], a[180:183], a[132:135], v[96:111]
  ds_read_b64_tr_b16 a[168:169], v212 offset:20480
  ds_read_b64_tr_b16 a[170:171], v212 offset:20992
  ds_read_b128 a[152:155], v8 offset:0
  v_mul_f32 v157, v157, v32
  s_waitcnt vmcnt(4)
  v_add_f32 v132, v132, v144
  v_rcp_f32 v44, v157
  s_waitcnt lgkmcnt(9)
  v_mfma_f32_32x32x16_bf16 v[96:111], a[184:187], a[136:139], v[96:111]
  ds_read_b64_tr_b16 a[172:173], v212 offset:22528
  ds_read_b64_tr_b16 a[174:175], v212 offset:23040
  ds_read_b128 a[156:159], v9 offset:0
  v_add_f32 v133, v133, v145
  v_mul_f32 v36, 3222493025, v157
  v_add_f32 v134, v134, v146
  s_add_u32 s101, s73, 1105920
  s_or_b32 s101, s101, s83
  s_add_u32 m0, s75, 53248
  v_mfma_f32_32x32x16_bf16 v[96:111], a[188:191], a[140:143], v[96:111]
  ds_read_b64_tr_b16 a[176:177], v213 offset:16384
  ds_read_b64_tr_b16 a[178:179], v213 offset:16896
  buffer_load_dwordx4 v214, s[36:39], s101 offen offset:0 lds
  s_waitcnt lgkmcnt(9)
  v_mfma_f32_32x32x16_bf16 v[48:63], a[160:163], a[144:147], v[48:63]
  ds_read_b64_tr_b16 a[180:181], v213 offset:18432
  ds_read_b64_tr_b16 a[182:183], v213 offset:18944
  v_mul_f32 v158, v157, v157
  v_add_f32 v135, v135, v147
  v_mul_f32 v158, v158, v157
  v_permlane32_swap_b32 v132, v134
  v_mul_f32 v38, 3184710632, v158
  s_waitcnt lgkmcnt(10)
  v_mfma_f32_32x32x16_bf16 v[48:63], a[164:167], a[148:151], v[48:63]
  ds_read_b64_tr_b16 a[184:185], v213 offset:20480
  ds_read_b64_tr_b16 a[186:187], v213 offset:20992
  v_permlane32_swap_b32 v133, v135
  v_sub_f32 v128, 0, v128
  v_add_f32 v132, v132, v134
  v_cvt_pk_bf16_f32 v156, v128, v128
  s_add_u32 s101, s73, 1327104
  s_or_b32 s101, s101, s83
  s_add_u32 m0, s75, 57344
  s_waitcnt lgkmcnt(7)
  v_mfma_f32_32x32x16_bf16 v[48:63], a[168:171], a[152:155], v[48:63]
  ds_read_b64_tr_b16 a[188:189], v213 offset:22528
  ds_read_b64_tr_b16 a[190:191], v213 offset:23040
  buffer_load_dwordx4 v214, s[36:39], s101 offen offset:0 lds
  v_add_f32 v133, v133, v135
  s_waitcnt lgkmcnt(8)
  v_mfma_f32_32x32x16_bf16 v[48:63], a[172:175], a[156:159], v[48:63]
  ds_read_b64_tr_b16 a[160:161], v212 offset:24576
  ds_read_b64_tr_b16 a[162:163], v212 offset:25088
  v_and_b32 v156, 0xffff0000, v156
  v_permlane16_swap_b32 v132, v133
  v_sub_f32 v158, v128, v156
  v_add_f32 v132, v132, v133
  s_waitcnt lgkmcnt(6)
  v_mfma_f32_32x32x16_bf16 v[64:79], a[176:179], a[144:147], v[64:79]
  ds_read_b64_tr_b16 a[164:165], v212 offset:26624
  ds_read_b64_tr_b16 a[166:167], v212 offset:27136
  v_cvt_pk_bf16_f32 v40, v156, v158
  v_cvt_pk_bf16_f32 v152, v132, v132
  v_cvt_pk_bf16_f32 v156, v44, v44
  v_and_b32 v160, 0xffff0000, v152
  v_and_b32 v156, 0xffff0000, v156
  s_add_u32 s101, s73, 1548288
  s_or_b32 s101, s101, s83
  s_add_u32 m0, s75, 61440
  v_mfma_f32_32x32x16_bf16 v[64:79], a[180:183], a[148:151], v[64:79]
  ds_read_b64_tr_b16 a[168:169], v212 offset:28672
  ds_read_b64_tr_b16 a[170:171], v212 offset:29184
  buffer_load_dwordx4 v214, s[36:39], s101 offen offset:0 lds
  s_waitcnt lgkmcnt(6)
  v_mfma_f32_32x32x16_bf16 v[64:79], a[184:187], a[152:155], v[64:79]
  ds_read_b64_tr_b16 a[172:173], v212 offset:30720
  ds_read_b64_tr_b16 a[174:175], v212 offset:31232
  v_sub_f32 v160, v132, v160
  v_sub_f32 v158, v44, v156
  v_cvt_pk_bf16_f32 v153, v160, v160
  v_cvt_pk_bf16_f32 v42, v156, v158
  v_lshl_or_b32 v154, v178, 16, v178
  v_mfma_f32_32x32x16_bf16 v[64:79], a[188:191], a[156:159], v[64:79]
  ds_read_b64_tr_b16 a[176:177], v213 offset:24576
  ds_read_b64_tr_b16 a[178:179], v213 offset:25088
  v_and_b32 v156, 0xffff0000, v42
  v_mov_b32 v155, v178
  v_sub_f32 v158, v158, v156
  ds_write_b128 v222, v[152:155]
  s_add_u32 s101, s73, 1769472
  s_or_b32 s101, s101, s83
  s_add_u32 m0, s75, 65536
  s_waitcnt lgkmcnt(7)
  v_mfma_f32_32x32x16_bf16 v[80:95], a[160:163], a[144:147], v[80:95]
  ds_read_b64_tr_b16 a[180:181], v213 offset:26624
  ds_read_b64_tr_b16 a[182:183], v213 offset:27136
  buffer_load_dwordx4 v214, s[36:39], s101 offen offset:0 lds
  v_cvt_pk_bf16_f32 v43, v158, 0
  v_not_b32 v159, v29
  v_and_b32 v40, v40, v159
  v_and_b32 v42, v42, v159
  v_and_b32 v43, v43, v159
  v_mov_b32 v41, v40
  v_mfma_f32_32x32x16_bf16 v[80:95], a[164:167], a[148:151], v[80:95]
  ds_read_b64_tr_b16 a[184:185], v213 offset:28672
  ds_read_b64_tr_b16 a[186:187], v213 offset:29184
  s_waitcnt lgkmcnt(4)
  s_barrier
  v_mfma_f32_32x32x16_bf16 v[80:95], a[168:171], a[152:155], v[80:95]
  ds_read_b64_tr_b16 a[188:189], v213 offset:30720
  ds_read_b64_tr_b16 a[190:191], v213 offset:31232
  s_add_u32 s101, s73, 1990656
  s_or_b32 s101, s101, s83
  s_add_u32 m0, s75, 69632
  v_mfma_f32_32x32x16_bf16 v[80:95], a[172:175], a[156:159], v[80:95]
  ds_read_b128 a[160:163], v19 offset:0
  buffer_load_dwordx4 v214, s[36:39], s101 offen offset:0 lds
  v_lshlrev_b32 v224, 16, v226
  s_waitcnt lgkmcnt(5)
  v_mfma_f32_32x32x16_bf16 v[96:111], a[176:179], a[144:147], v[96:111]
  ds_read_b128 a[164:167], v19 offset:512
  v_and_b32 v225, 0xffff0000, v226
  v_lshlrev_b32 v226, 16, v227
  v_and_b32 v227, 0xffff0000, v227
  v_lshlrev_b32 v228, 16, v230
  v_mfma_f32_32x32x16_bf16 v[96:111], a[180:183], a[148:151], v[96:111]
  ds_read_b128 a[168:171], v19 offset:1024
  v_and_b32 v229, 0xffff0000, v230
  v_lshlrev_b32 v230, 16, v231
  v_and_b32 v231, 0xffff0000, v231
  v_lshlrev_b32 v232, 16, v234
  v_and_b32 v233, 0xffff0000, v234
  s_waitcnt lgkmcnt(3)
  v_mfma_f32_32x32x16_bf16 v[96:111], a[184:187], a[152:155], v[96:111]
  ds_read_b128 a[172:175], v19 offset:1536
  v_lshlrev_b32 v234, 16, v235
  v_and_b32 v235, 0xffff0000, v235
  v_lshlrev_b32 v236, 16, v238
  v_and_b32 v237, 0xffff0000, v238
  s_waitcnt vmcnt(8)
  s_barrier
  v_mfma_f32_32x32x16_bf16 v[96:111], a[188:191], a[156:159], v[96:111]
  ds_read_b64_tr_b16 a[176:177], v215 offset:0
  ds_read_b64_tr_b16 a[178:179], v215 offset:256
  v_lshlrev_b32 v238, 16, v239
  v_and_b32 v239, 0xffff0000, v239
  v_lshlrev_b32 v240, 16, v242
  v_and_b32 v241, 0xffff0000, v242
  v_lshlrev_b32 v242, 16, v243
  s_waitcnt lgkmcnt(4)
  v_mfma_f32_32x32x16_bf16 v[48:63], a[160:163], v[40:43], v[48:63]
  ds_read_b64_tr_b16 a[180:181], v215 offset:1024
  ds_read_b64_tr_b16 a[182:183], v215 offset:1280
  v_and_b32 v243, 0xffff0000, v243
  s_sub_u32 s79, s9, s10
  v_add_u32 v2, s79, v185
  v_add_u32 v3, s79, v186
  v_add_u32 v4, s79, v187
  v_add_u32 v5, s79, v188
  v_mfma_f32_32x32x16_bf16 v[64:79], a[164:167], v[40:43], v[64:79]
  ds_read_b64_tr_b16 a[184:185], v215 offset:2048
  ds_read_b64_tr_b16 a[186:187], v215 offset:2304
  s_waitcnt lgkmcnt(6)
  v_mfma_f32_32x32x16_bf16 v[80:95], a[168:171], v[40:43], v[80:95]
  ds_read_b64_tr_b16 a[188:189], v215 offset:3072
  ds_read_b64_tr_b16 a[190:191], v215 offset:3328
  v_mfma_f32_32x32x16_bf16 v[96:111], a[172:175], v[40:43], v[96:111]
  ds_read_b64_tr_b16 a[160:161], v215 offset:4096
  ds_read_b64_tr_b16 a[162:163], v215 offset:4352
  s_add_u32 m0, s94, 143360
  s_nop 0
  buffer_load_dwordx4 v180, s[44:47], s21 offen offset:0 lds
  v_pk_mul_f32 v[244:245], v[48:49], v[48:49]
  v_pk_mul_f32 v[246:247], v[50:51], v[50:51]
  v_pk_fma_f32 v[244:245], v[244:245], v[38:39], v[36:37] op_sel_hi:[1,0,0]
  v_pk_fma_f32 v[246:247], v[246:247], v[38:39], v[36:37] op_sel_hi:[1,0,0]
  v_pk_mul_f32 v[244:245], v[244:245], v[48:49]
  v_pk_mul_f32 v[246:247], v[246:247], v[50:51]
  v_exp_f32 v244, v244
  v_exp_f32 v245, v245
  v_exp_f32 v246, v246
  v_exp_f32 v247, v247
  v_pk_fma_f32 v[244:245], v[244:245], v[44:45], v[44:45] op_sel_hi:[1,0,0]
  v_pk_fma_f32 v[246:247], v[246:247], v[44:45], v[44:45] op_sel_hi:[1,0,0]
  v_rcp_f32 v244, v244
  v_rcp_f32 v245, v245
  v_rcp_f32 v246, v246
  v_rcp_f32 v247, v247
  v_pk_mul_f32 v[244:245], v[244:245], v[48:49]
  v_pk_mul_f32 v[246:247], v[246:247], v[50:51]
  v_cvt_pk_bf16_f32 v48, v244, v245
  v_cvt_pk_bf16_f32 v49, v246, v247
  v_pk_mul_f32 v[248:249], v[52:53], v[52:53]
  v_pk_mul_f32 v[250:251], v[54:55], v[54:55]
  v_pk_fma_f32 v[248:249], v[248:249], v[38:39], v[36:37] op_sel_hi:[1,0,0]
  v_pk_fma_f32 v[250:251], v[250:251], v[38:39], v[36:37] op_sel_hi:[1,0,0]
  v_pk_mul_f32 v[248:249], v[248:249], v[52:53]
  v_pk_mul_f32 v[250:251], v[250:251], v[54:55]
  buffer_load_dwordx4 v181, s[44:47], s21 offen offset:1024 lds
  v_exp_f32 v248, v248
  v_exp_f32 v249, v249
  v_exp_f32 v250, v250
  v_exp_f32 v251, v251
  v_pk_fma_f32 v[248:249], v[248:249], v[44:45], v[44:45] op_sel_hi:[1,0,0]
  v_pk_fma_f32 v[250:251], v[250:251], v[44:45], v[44:45] op_sel_hi:[1,0,0]
  v_rcp_f32 v248, v248
  v_rcp_f32 v249, v249
  v_rcp_f32 v250, v250
  v_rcp_f32 v251, v251
  v_pk_mul_f32 v[248:249], v[248:249], v[52:53]
  v_pk_mul_f32 v[250:251], v[250:251], v[54:55]
  v_cvt_pk_bf16_f32 v50, v248, v249
  v_cvt_pk_bf16_f32 v51, v250, v251
  buffer_store_dwordx4 v[48:51], v15, s[48:51], s85 offen offset:0 sc1
  v_pk_mul_f32 v[244:245], v[56:57], v[56:57]
  v_pk_mul_f32 v[246:247], v[58:59], v[58:59]
  v_pk_fma_f32 v[244:245], v[244:245], v[38:39], v[36:37] op_sel_hi:[1,0,0]
  v_pk_fma_f32 v[246:247], v[246:247], v[38:39], v[36:37] op_sel_hi:[1,0,0]
  v_pk_mul_f32 v[244:245], v[244:245], v[56:57]
  v_pk_mul_f32 v[246:247], v[246:247], v[58:59]
  v_exp_f32 v244, v244
  v_exp_f32 v245, v245
  v_exp_f32 v246, v246
  v_exp_f32 v247, v247
  v_pk_fma_f32 v[244:245], v[244:245], v[44:45], v[44:45] op_sel_hi:[1,0,0]
  buffer_load_dwordx4 v182, s[44:47], s21 offen offset:2048 lds
  v_pk_fma_f32 v[246:247], v[246:247], v[44:45], v[44:45] op_sel_hi:[1,0,0]
  v_rcp_f32 v244, v244
  v_rcp_f32 v245, v245
  v_rcp_f32 v246, v246
  v_rcp_f32 v247, v247
  v_pk_mul_f32 v[244:245], v[244:245], v[56:57]
  v_pk_mul_f32 v[246:247], v[246:247], v[58:59]
  v_cvt_pk_bf16_f32 v56, v244, v245
  v_cvt_pk_bf16_f32 v57, v246, v247
  v_pk_mul_f32 v[248:249], v[60:61], v[60:61]
  v_pk_mul_f32 v[250:251], v[62:63], v[62:63]
  v_pk_fma_f32 v[248:249], v[248:249], v[38:39], v[36:37] op_sel_hi:[1,0,0]
  v_pk_fma_f32 v[250:251], v[250:251], v[38:39], v[36:37] op_sel_hi:[1,0,0]
  v_pk_mul_f32 v[248:249], v[248:249], v[60:61]
  v_pk_mul_f32 v[250:251], v[250:251], v[62:63]
  v_exp_f32 v248, v248
  v_exp_f32 v249, v249
  v_exp_f32 v250, v250
  v_exp_f32 v251, v251
  v_pk_fma_f32 v[248:249], v[248:249], v[44:45], v[44:45] op_sel_hi:[1,0,0]
  v_pk_fma_f32 v[250:251], v[250:251], v[44:45], v[44:45] op_sel_hi:[1,0,0]
  v_rcp_f32 v248, v248
  v_rcp_f32 v249, v249
  v_rcp_f32 v250, v250
  v_rcp_f32 v251, v251
  v_pk_mul_f32 v[248:249], v[248:249], v[60:61]
  buffer_load_dwordx4 v183, s[44:47], s21 offen offset:3072 lds
  v_pk_mul_f32 v[250:251], v[250:251], v[62:63]
  v_cvt_pk_bf16_f32 v58, v248, v249
  v_cvt_pk_bf16_f32 v59, v250, v251
  buffer_store_dwordx4 v[56:59], v15, s[48:51], s85 offen offset:512 sc1
  v_pk_mul_f32 v[244:245], v[64:65], v[64:65]
  v_pk_mul_f32 v[246:247], v[66:67], v[66:67]
  v_pk_fma_f32 v[244:245], v[244:245], v[38:39], v[36:37] op_sel_hi:[1,0,0]
  v_pk_fma_f32 v[246:247], v[246:247], v[38:39], v[36:37] op_sel_hi:[1,0,0]
  v_pk_mul_f32 v[244:245], v[244:245], v[64:65]
  v_pk_mul_f32 v[246:247], v[246:247], v[66:67]
  v_exp_f32 v244, v244
  v_exp_f32 v245, v245
  v_exp_f32 v246, v246
  v_exp_f32 v247, v247
  v_pk_fma_f32 v[244:245], v[244:245], v[44:45], v[44:45] op_sel_hi:[1,0,0]
  v_pk_fma_f32 v[246:247], v[246:247], v[44:45], v[44:45] op_sel_hi:[1,0,0]
  v_rcp_f32 v244, v244
  v_rcp_f32 v245, v245
  v_rcp_f32 v246, v246
  v_rcp_f32 v247, v247
  v_pk_mul_f32 v[244:245], v[244:245], v[64:65]
  v_pk_mul_f32 v[246:247], v[246:247], v[66:67]
  v_cvt_pk_bf16_f32 v64, v244, v245
  v_cvt_pk_bf16_f32 v65, v246, v247
  v_pk_mul_f32 v[248:249], v[68:69], v[68:69]
  v_pk_mul_f32 v[250:251], v[70:71], v[70:71]
  s_add_u32 m0, s94, 147456
  s_nop 0
  buffer_load_dwordx4 v184, s[44:47], s21 offen offset:0 lds
  v_pk_fma_f32 v[248:249], v[248:249], v[38:39], v[36:37] op_sel_hi:[1,0,0]
  v_pk_fma_f32 v[250:251], v[250:251], v[38:39], v[36:37] op_sel_hi:[1,0,0]
  v_pk_mul_f32 v[248:249], v[248:249], v[68:69]
  v_pk_mul_f32 v[250:251], v[250:251], v[70:71]
  v_exp_f32 v248, v248
  v_exp_f32 v249, v249
  v_exp_f32 v250, v250
  v_exp_f32 v251, v251
  v_pk_fma_f32 v[248:249], v[248:249], v[44:45], v[44:45] op_sel_hi:[1,0,0]
  v_pk_fma_f32 v[250:251], v[250:251], v[44:45], v[44:45] op_sel_hi:[1,0,0]
  v_rcp_f32 v248, v248
  v_rcp_f32 v249, v249
  v_rcp_f32 v250, v250
  v_rcp_f32 v251, v251
  v_pk_mul_f32 v[248:249], v[248:249], v[68:69]
  v_pk_mul_f32 v[250:251], v[250:251], v[70:71]
  v_cvt_pk_bf16_f32 v66, v248, v249
  v_cvt_pk_bf16_f32 v67, v250, v251
  buffer_store_dwordx4 v[64:67], v15, s[48:51], s85 offen offset:1024 sc1
  v_pk_mul_f32 v[244:245], v[72:73], v[72:73]
  v_pk_mul_f32 v[246:247], v[74:75], v[74:75]
  v_pk_fma_f32 v[244:245], v[244:245], v[38:39], v[36:37] op_sel_hi:[1,0,0]
  v_pk_fma_f32 v[246:247], v[246:247], v[38:39], v[36:37] op_sel_hi:[1,0,0]
  v_pk_mul_f32 v[244:245], v[244:245], v[72:73]
  v_pk_mul_f32 v[246:247], v[246:247], v[74:75]
  v_exp_f32 v244, v244
  s_add_u32 s14, s21, 40960
  s_add_u32 m0, s94, 102400
  s_nop 0
  buffer_load_dwordx4 v180, s[44:47], s14 offen offset:0 lds
  v_exp_f32 v245, v245
  v_exp_f32 v246, v246
  v_exp_f32 v247, v247
  v_pk_fma_f32 v[244:245], v[244:245], v[44:45], v[44:45] op_sel_hi:[1,0,0]
  v_pk_fma_f32 v[246:247], v[246:247], v[44:45], v[44:45] op_sel_hi:[1,0,0]
  v_rcp_f32 v244, v244
  v_rcp_f32 v245, v245
  v_rcp_f32 v246, v246
  v_rcp_f32 v247, v247
  v_pk_mul_f32 v[244:245], v[244:245], v[72:73]
  v_pk_mul_f32 v[246:247], v[246:247], v[74:75]
  v_cvt_pk_bf16_f32 v72, v244, v245
  v_cvt_pk_bf16_f32 v73, v246, v247
  v_pk_mul_f32 v[248:249], v[76:77], v[76:77]
  v_pk_mul_f32 v[250:251], v[78:79], v[78:79]
  v_pk_fma_f32 v[248:249], v[248:249], v[38:39], v[36:37] op_sel_hi:[1,0,0]
  v_pk_fma_f32 v[250:251], v[250:251], v[38:39], v[36:37] op_sel_hi:[1,0,0]
  v_pk_mul_f32 v[248:249], v[248:249], v[76:77]
  v_pk_mul_f32 v[250:251], v[250:251], v[78:79]
  v_exp_f32 v248, v248
  v_exp_f32 v249, v249
  v_exp_f32 v250, v250
  v_exp_f32 v251, v251
  v_pk_fma_f32 v[248:249], v[248:249], v[44:45], v[44:45] op_sel_hi:[1,0,0]
  v_pk_fma_f32 v[250:251], v[250:251], v[44:45], v[44:45] op_sel_hi:[1,0,0]
  buffer_load_dwordx4 v181, s[44:47], s14 offen offset:1024 lds
  v_rcp_f32 v248, v248
  v_rcp_f32 v249, v249
  v_rcp_f32 v250, v250
  v_rcp_f32 v251, v251
  v_pk_mul_f32 v[248:249], v[248:249], v[76:77]
  v_pk_mul_f32 v[250:251], v[250:251], v[78:79]
  v_cvt_pk_bf16_f32 v74, v248, v249
  v_cvt_pk_bf16_f32 v75, v250, v251
  buffer_store_dwordx4 v[72:75], v15, s[48:51], s85 offen offset:1536 sc1
  v_pk_mul_f32 v[244:245], v[80:81], v[80:81]
  v_pk_mul_f32 v[246:247], v[82:83], v[82:83]
  v_pk_fma_f32 v[244:245], v[244:245], v[38:39], v[36:37] op_sel_hi:[1,0,0]
  v_pk_fma_f32 v[246:247], v[246:247], v[38:39], v[36:37] op_sel_hi:[1,0,0]
  v_pk_mul_f32 v[244:245], v[244:245], v[80:81]
  v_pk_mul_f32 v[246:247], v[246:247], v[82:83]
  v_exp_f32 v244, v244
  v_exp_f32 v245, v245
  v_exp_f32 v246, v246
  v_exp_f32 v247, v247
  v_pk_fma_f32 v[244:245], v[244:245], v[44:45], v[44:45] op_sel_hi:[1,0,0]
  v_pk_fma_f32 v[246:247], v[246:247], v[44:45], v[44:45] op_sel_hi:[1,0,0]
  v_rcp_f32 v244, v244
  v_rcp_f32 v245, v245
  v_rcp_f32 v246, v246
  v_rcp_f32 v247, v247
  v_pk_mul_f32 v[244:245], v[244:245], v[80:81]
  buffer_load_dwordx4 v182, s[44:47], s14 offen offset:2048 lds
  v_pk_mul_f32 v[246:247], v[246:247], v[82:83]
  v_cvt_pk_bf16_f32 v80, v244, v245
  v_cvt_pk_bf16_f32 v81, v246, v247
  v_pk_mul_f32 v[248:249], v[84:85], v[84:85]
  v_pk_mul_f32 v[250:251], v[86:87], v[86:87]
  v_pk_fma_f32 v[248:249], v[248:249], v[38:39], v[36:37] op_sel_hi:[1,0,0]
  v_pk_fma_f32 v[250:251], v[250:251], v[38:39], v[36:37] op_sel_hi:[1,0,0]
  v_pk_mul_f32 v[248:249], v[248:249], v[84:85]
  v_pk_mul_f32 v[250:251], v[250:251], v[86:87]
  v_exp_f32 v248, v248
  v_exp_f32 v249, v249
  v_exp_f32 v250, v250
  v_exp_f32 v251, v251
  v_pk_fma_f32 v[248:249], v[248:249], v[44:45], v[44:45] op_sel_hi:[1,0,0]
  v_pk_fma_f32 v[250:251], v[250:251], v[44:45], v[44:45] op_sel_hi:[1,0,0]
  v_rcp_f32 v248, v248
  v_rcp_f32 v249, v249
  v_rcp_f32 v250, v250
  v_rcp_f32 v251, v251
  v_pk_mul_f32 v[248:249], v[248:249], v[84:85]
  v_pk_mul_f32 v[250:251], v[250:251], v[86:87]
  v_cvt_pk_bf16_f32 v82, v248, v249
  v_cvt_pk_bf16_f32 v83, v250, v251
  buffer_store_dwordx4 v[80:83], v15, s[48:51], s85 offen offset:2048 sc1
  v_pk_mul_f32 v[244:245], v[88:89], v[88:89]
  v_pk_mul_f32 v[246:247], v[90:91], v[90:91]
  buffer_load_dwordx4 v183, s[44:47], s14 offen offset:3072 lds
  v_pk_fma_f32 v[244:245], v[244:245], v[38:39], v[36:37] op_sel_hi:[1,0,0]
  v_pk_fma_f32 v[246:247], v[246:247], v[38:39], v[36:37] op_sel_hi:[1,0,0]
  v_pk_mul_f32 v[244:245], v[244:245], v[88:89]
  v_pk_mul_f32 v[246:247], v[246:247], v[90:91]
  v_exp_f32 v244, v244
  v_exp_f32 v245, v245
  v_exp_f32 v246, v246
  v_exp_f32 v247, v247
  v_pk_fma_f32 v[244:245], v[244:245], v[44:45], v[44:45] op_sel_hi:[1,0,0]
  v_pk_fma_f32 v[246:247], v[246:247], v[44:45], v[44:45] op_sel_hi:[1,0,0]
  v_rcp_f32 v244, v244
  v_rcp_f32 v245, v245
  v_rcp_f32 v246, v246
  v_rcp_f32 v247, v247
  v_pk_mul_f32 v[244:245], v[244:245], v[88:89]
  v_pk_mul_f32 v[246:247], v[246:247], v[90:91]
  v_cvt_pk_bf16_f32 v88, v244, v245
  v_cvt_pk_bf16_f32 v89, v246, v247
  v_pk_mul_f32 v[248:249], v[92:93], v[92:93]
  v_pk_mul_f32 v[250:251], v[94:95], v[94:95]
  v_pk_fma_f32 v[248:249], v[248:249], v[38:39], v[36:37] op_sel_hi:[1,0,0]
  v_pk_fma_f32 v[250:251], v[250:251], v[38:39], v[36:37] op_sel_hi:[1,0,0]
  v_pk_mul_f32 v[248:249], v[248:249], v[92:93]
  v_pk_mul_f32 v[250:251], v[250:251], v[94:95]
  v_exp_f32 v248, v248
  v_exp_f32 v249, v249
  s_add_u32 m0, s94, 106496
  s_nop 0
  buffer_load_dwordx4 v184, s[44:47], s14 offen offset:0 lds
  v_exp_f32 v250, v250
  v_exp_f32 v251, v251
  v_pk_fma_f32 v[248:249], v[248:249], v[44:45], v[44:45] op_sel_hi:[1,0,0]
  v_pk_fma_f32 v[250:251], v[250:251], v[44:45], v[44:45] op_sel_hi:[1,0,0]
  v_rcp_f32 v248, v248
  v_rcp_f32 v249, v249
  v_rcp_f32 v250, v250
  v_rcp_f32 v251, v251
  v_pk_mul_f32 v[248:249], v[248:249], v[92:93]
  v_pk_mul_f32 v[250:251], v[250:251], v[94:95]
  v_cvt_pk_bf16_f32 v90, v248, v249
  v_cvt_pk_bf16_f32 v91, v250, v251
  buffer_store_dwordx4 v[88:91], v15, s[48:51], s85 offen offset:2560 sc1
  v_pk_mul_f32 v[244:245], v[96:97], v[96:97]
  v_pk_mul_f32 v[246:247], v[98:99], v[98:99]
  v_pk_fma_f32 v[244:245], v[244:245], v[38:39], v[36:37] op_sel_hi:[1,0,0]
  v_pk_fma_f32 v[246:247], v[246:247], v[38:39], v[36:37] op_sel_hi:[1,0,0]
  v_pk_mul_f32 v[244:245], v[244:245], v[96:97]
  v_pk_mul_f32 v[246:247], v[246:247], v[98:99]
  v_exp_f32 v244, v244
  v_exp_f32 v245, v245
  v_exp_f32 v246, v246
  v_exp_f32 v247, v247
  v_pk_fma_f32 v[244:245], v[244:245], v[44:45], v[44:45] op_sel_hi:[1,0,0]
  v_pk_fma_f32 v[246:247], v[246:247], v[44:45], v[44:45] op_sel_hi:[1,0,0]
  v_rcp_f32 v244, v244
  v_rcp_f32 v245, v245
  v_rcp_f32 v246, v246
  v_rcp_f32 v247, v247
  v_pk_mul_f32 v[244:245], v[244:245], v[96:97]
  v_pk_mul_f32 v[246:247], v[246:247], v[98:99]
  v_cvt_pk_bf16_f32 v96, v244, v245
  v_cvt_pk_bf16_f32 v97, v246, v247
  v_pk_mul_f32 v[248:249], v[100:101], v[100:101]
  v_pk_mul_f32 v[250:251], v[102:103], v[102:103]
  v_pk_fma_f32 v[248:249], v[248:249], v[38:39], v[36:37] op_sel_hi:[1,0,0]
  v_pk_fma_f32 v[250:251], v[250:251], v[38:39], v[36:37] op_sel_hi:[1,0,0]
  v_pk_mul_f32 v[248:249], v[248:249], v[100:101]
  v_pk_mul_f32 v[250:251], v[250:251], v[102:103]
  v_exp_f32 v248, v248
  v_exp_f32 v249, v249
  v_exp_f32 v250, v250
  v_exp_f32 v251, v251
  v_pk_fma_f32 v[248:249], v[248:249], v[44:45], v[44:45] op_sel_hi:[1,0,0]
  v_pk_fma_f32 v[250:251], v[250:251], v[44:45], v[44:45] op_sel_hi:[1,0,0]
  v_rcp_f32 v248, v248
  v_rcp_f32 v249, v249
  v_rcp_f32 v250, v250
  v_rcp_f32 v251, v251
  v_pk_mul_f32 v[248:249], v[248:249], v[100:101]
  v_pk_mul_f32 v[250:251], v[250:251], v[102:103]
  v_cvt_pk_bf16_f32 v98, v248, v249
  v_cvt_pk_bf16_f32 v99, v250, v251
  buffer_store_dwordx4 v[96:99], v15, s[48:51], s85 offen offset:3072 sc1
  s_waitcnt lgkmcnt(6)
  v_mfma_f32_32x32x16_bf16 v[112:127], a[176:179], a[0:3], 0
  ds_read_b64_tr_b16 a[164:165], v215 offset:5120
  ds_read_b64_tr_b16 a[166:167], v215 offset:5376
  v_mul_f32 v244, v104, v104
  v_mul_f32 v245, v105, v105
  v_mul_f32 v246, v106, v106
  v_mfma_f32_32x32x16_bf16 v[112:127], a[180:183], a[4:7], v[112:127]
  ds_read_b64_tr_b16 a[168:169], v215 offset:6144
  ds_read_b64_tr_b16 a[170:171], v215 offset:6400
  v_mul_f32 v247, v107, v107
  v_fma_f32 v244, v244, v38, v36
  v_fma_f32 v245, v245, v38, v36
  s_waitcnt lgkmcnt(6)
  v_mfma_f32_32x32x16_bf16 v[112:127], a[184:187], a[8:11], v[112:127]
  ds_read_b64_tr_b16 a[172:173], v215 offset:7168
  ds_read_b64_tr_b16 a[174:175], v215 offset:7424
  v_fma_f32 v246, v246, v38, v36
  v_fma_f32 v247, v247, v38, v36
  v_mul_f32 v244, v244, v104
  s_waitcnt vmcnt(23)
  s_barrier
  v_mfma_f32_32x32x16_bf16 v[112:127], a[188:191], a[12:15], v[112:127]
  ds_read_b64_tr_b16 a[176:177], v215 offset:8192
  ds_read_b64_tr_b16 a[178:179], v215 offset:8448
  v_mul_f32 v245, v245, v105
  v_mul_f32 v246, v246, v106
  v_mul_f32 v247, v247, v107
  s_add_u32 s101, s90, 0
  s_add_u32 m0, s94, 0
  s_waitcnt lgkmcnt(6)
  v_mfma_f32_32x32x16_bf16 v[112:127], a[160:163], a[16:19], v[112:127]
  ds_read_b64_tr_b16 a[180:181], v215 offset:9216
  ds_read_b64_tr_b16 a[182:183], v215 offset:9472
  buffer_load_dwordx4 v10, s[32:35], s101 offen offset:0 lds
  buffer_load_dwordx4 v11, s[32:35], s101 offen offset:1024 lds
  buffer_load_dwordx4 v12, s[32:35], s101 offen offset:2048 lds
  v_mfma_f32_32x32x16_bf16 v[112:127], a[164:167], a[20:23], v[112:127]
  ds_read_b64_tr_b16 a[184:185], v215 offset:10240
  ds_read_b64_tr_b16 a[186:187], v215 offset:10496
  buffer_load_dwordx4 v13, s[32:35], s101 offen offset:3072 lds
  s_add_u32 m0, s94, 4096
  s_nop 0
  buffer_load_dwordx4 v14, s[32:35], s101 offen offset:0 lds
  s_waitcnt lgkmcnt(6)
  v_mfma_f32_32x32x16_bf16 v[112:127], a[168:171], a[24:27], v[112:127]
  ds_read_b64_tr_b16 a[188:189], v215 offset:11264
  ds_read_b64_tr_b16 a[190:191], v215 offset:11520
  v_mfma_f32_32x32x16_bf16 v[112:127], a[172:175], a[28:31], v[112:127]
  ds_read_b64_tr_b16 a[160:161], v215 offset:12288
  ds_read_b64_tr_b16 a[162:163], v215 offset:12544
  v_exp_f32 v244, v244
  v_exp_f32 v245, v245
  s_waitcnt lgkmcnt(6)
  v_mfma_f32_32x32x16_bf16 v[112:127], a[176:179], a[32:35], v[112:127]
  ds_read_b64_tr_b16 a[164:165], v215 offset:13312
  ds_read_b64_tr_b16 a[166:167], v215 offset:13568
  v_exp_f32 v246, v246
  v_mfma_f32_32x32x16_bf16 v[112:127], a[180:183], a[36:39], v[112:127]
  ds_read_b64_tr_b16 a[168:169], v215 offset:14336
  ds_read_b64_tr_b16 a[170:171], v215 offset:14592
  v_exp_f32 v247, v247
  v_fma_f32 v244, v244, v44, v44
  s_waitcnt lgkmcnt(6)
  v_mfma_f32_32x32x16_bf16 v[112:127], a[184:187], a[40:43], v[112:127]
  ds_read_b64_tr_b16 a[172:173], v215 offset:15360
  ds_read_b64_tr_b16 a[174:175], v215 offset:15616
  v_fma_f32 v245, v245, v44, v44
  v_fma_f32 v246, v246, v44, v44
  v_fma_f32 v247, v247, v44, v44
  s_waitcnt vmcnt(26)
  s_barrier
  v_mfma_f32_32x32x16_bf16 v[112:127], a[188:191], a[44:47], v[112:127]
  ds_read_b64_tr_b16 a[176:177], v215 offset:16384
  ds_read_b64_tr_b16 a[178:179], v215 offset:16640
  v_rcp_f32 v244, v244
  v_rcp_f32 v245, v245
  s_add_u32 s101, s90, 491520
  s_add_u32 m0, s94, 20480
  s_waitcnt lgkmcnt(6)
  v_mfma_f32_32x32x16_bf16 v[112:127], a[160:163], a[48:51], v[112:127]
  ds_read_b64_tr_b16 a[180:181], v215 offset:17408
  ds_read_b64_tr_b16 a[182:183], v215 offset:17664
  buffer_load_dwordx4 v10, s[32:35], s101 offen offset:0 lds
  buffer_load_dwordx4 v11, s[32:35], s101 offen offset:1024 lds
  buffer_load_dwordx4 v12, s[32:35], s101 offen offset:2048 lds
  v_mfma_f32_32x32x16_bf16 v[112:127], a[164:167], a[52:55], v[112:127]
  ds_read_b64_tr_b16 a[184:185], v215 offset:18432
  ds_read_b64_tr_b16 a[186:187], v215 offset:18688
  buffer_load_dwordx4 v13, s[32:35], s101 offen offset:3072 lds
  s_add_u32 m0, s94, 24576
  s_nop 0
  buffer_load_dwordx4 v14, s[32:35], s101 offen offset:0 lds
  s_waitcnt lgkmcnt(6)
  v_mfma_f32_32x32x16_bf16 v[112:127], a[168:171], a[56:59], v[112:127]
  ds_read_b64_tr_b16 a[188:189], v215 offset:19456
  ds_read_b64_tr_b16 a[190:191], v215 offset:19712
  v_mfma_f32_32x32x16_bf16 v[112:127], a[172:175], a[60:63], v[112:127]
  ds_read_b64_tr_b16 a[160:161], v215 offset:20480
  ds_read_b64_tr_b16 a[162:163], v215 offset:20736
  v_rcp_f32 v246, v246
  v_rcp_f32 v247, v247
  s_waitcnt lgkmcnt(6)
  v_mfma_f32_32x32x16_bf16 v[112:127], a[176:179], a[64:67], v[112:127]
  ds_read_b64_tr_b16 a[164:165], v215 offset:21504
  ds_read_b64_tr_b16 a[166:167], v215 offset:21760
  v_mul_f32 v244, v244, v104
  v_mul_f32 v245, v245, v105
  v_mfma_f32_32x32x16_bf16 v[112:127], a[180:183], a[68:71], v[112:127]
  ds_read_b64_tr_b16 a[168:169], v215 offset:22528
  ds_read_b64_tr_b16 a[170:171], v215 offset:22784
  v_mul_f32 v246, v246, v106
  v_mul_f32 v247, v247, v107
  v_cvt_pk_bf16_f32 v104, v244, v245
  s_waitcnt lgkmcnt(6)
  v_mfma_f32_32x32x16_bf16 v[112:127], a[184:187], a[72:75], v[112:127]
  ds_read_b64_tr_b16 a[172:173], v215 offset:23552
  ds_read_b64_tr_b16 a[174:175], v215 offset:23808
  v_cvt_pk_bf16_f32 v105, v246, v247
  v_mul_f32 v248, v108, v108
  v_mul_f32 v249, v109, v109
  s_waitcnt vmcnt(29)
  s_barrier
  v_mfma_f32_32x32x16_bf16 v[112:127], a[188:191], a[76:79], v[112:127]
  ds_read_b64_tr_b16 a[176:177], v215 offset:24576
  ds_read_b64_tr_b16 a[178:179], v215 offset:24832
  v_mul_f32 v250, v110, v110
  v_mul_f32 v251, v111, v111
  v_fma_f32 v248, v248, v38, v36
  s_waitcnt lgkmcnt(6)
  v_mfma_f32_32x32x16_bf16 v[112:127], a[160:163], a[80:83], v[112:127]
  ds_read_b64_tr_b16 a[180:181], v215 offset:25600
  ds_read_b64_tr_b16 a[182:183], v215 offset:25856
  v_fma_f32 v249, v249, v38, v36
  v_fma_f32 v250, v250, v38, v36
  v_fma_f32 v251, v251, v38, v36
  v_mfma_f32_32x32x16_bf16 v[112:127], a[164:167], a[84:87], v[112:127]
  ds_read_b64_tr_b16 a[184:185], v215 offset:26624
  ds_read_b64_tr_b16 a[186:187], v215 offset:26880
  v_mul_f32 v248, v248, v108
  v_mul_f32 v249, v249, v109
  v_mul_f32 v250, v250, v110
  s_waitcnt lgkmcnt(6)
  v_mfma_f32_32x32x16_bf16 v[112:127], a[168:171], a[88:91], v[112:127]
  ds_read_b64_tr_b16 a[188:189], v215 offset:27648
  ds_read_b64_tr_b16 a[190:191], v215 offset:27904
  v_mul_f32 v251, v251, v111
  v_exp_f32 v248, v248
  v_mfma_f32_32x32x16_bf16 v[112:127], a[172:175], a[92:95], v[112:127]
  ds_read_b64_tr_b16 a[160:161], v215 offset:28672
  ds_read_b64_tr_b16 a[162:163], v215 offset:28928
  v_exp_f32 v249, v249
  v_exp_f32 v250, v250
  s_add_u32 s14, s21, 81920
  s_add_u32 m0, s94, 81920
  s_waitcnt lgkmcnt(6)
  v_mfma_f32_32x32x16_bf16 v[112:127], a[176:179], a[96:99], v[112:127]
  ds_read_b64_tr_b16 a[164:165], v215 offset:29696
  ds_read_b64_tr_b16 a[166:167], v215 offset:29952
  buffer_load_dwordx4 v180, s[44:47], s14 offen offset:0 lds
  v_mfma_f32_32x32x16_bf16 v[112:127], a[180:183], a[100:103], v[112:127]
  ds_read_b64_tr_b16 a[168:169], v215 offset:30720
  ds_read_b64_tr_b16 a[170:171], v215 offset:30976
  v_exp_f32 v251, v251
  s_waitcnt lgkmcnt(6)
  v_mfma_f32_32x32x16_bf16 v[112:127], a[184:187], a[104:107], v[112:127]
  ds_read_b64_tr_b16 a[172:173], v215 offset:31744
  ds_read_b64_tr_b16 a[174:175], v215 offset:32000
  buffer_load_dwordx4 v181, s[44:47], s14 offen offset:1024 lds
  v_fma_f32 v248, v248, v44, v44
  s_waitcnt vmcnt(29)
  s_barrier
  v_mfma_f32_32x32x16_bf16 v[112:127], a[188:191], a[108:111], v[112:127]
  ds_read_b64_tr_b16 a[176:177], v215 offset:32768
  ds_read_b64_tr_b16 a[178:179], v215 offset:33024
  v_fma_f32 v249, v249, v44, v44
  v_fma_f32 v250, v250, v44, v44
  v_fma_f32 v251, v251, v44, v44
  s_waitcnt lgkmcnt(6)
  v_mfma_f32_32x32x16_bf16 v[112:127], a[160:163], a[112:115], v[112:127]
  ds_read_b64_tr_b16 a[180:181], v215 offset:33792
  ds_read_b64_tr_b16 a[182:183], v215 offset:34048
  buffer_load_dwordx4 v182, s[44:47], s14 offen offset:2048 lds
  v_rcp_f32 v248, v248
  v_mfma_f32_32x32x16_bf16 v[112:127], a[164:167], a[116:119], v[112:127]
  ds_read_b64_tr_b16 a[184:185], v215 offset:34816
  ds_read_b64_tr_b16 a[186:187], v215 offset:35072
  v_rcp_f32 v249, v249
  s_waitcnt lgkmcnt(6)
  v_mfma_f32_32x32x16_bf16 v[112:127], a[168:171], a[120:123], v[112:127]
  ds_read_b64_tr_b16 a[188:189], v215 offset:35840
  ds_read_b64_tr_b16 a[190:191], v215 offset:36096
  v_rcp_f32 v250, v250
  v_rcp_f32 v251, v251
  v_mfma_f32_32x32x16_bf16 v[112:127], a[172:175], a[124:127], v[112:127]
  ds_read_b64_tr_b16 a[160:161], v215 offset:36864
  ds_read_b64_tr_b16 a[162:163], v215 offset:37120
  buffer_load_dwordx4 v183, s[44:47], s14 offen offset:3072 lds
  s_waitcnt lgkmcnt(6)
  v_mfma_f32_32x32x16_bf16 v[112:127], a[176:179], a[128:131], v[112:127]
  ds_read_b64_tr_b16 a[164:165], v215 offset:37888
  ds_read_b64_tr_b16 a[166:167], v215 offset:38144
  v_mul_f32 v248, v248, v108
  v_mul_f32 v249, v249, v109
  v_mul_f32 v250, v250, v110
  s_add_u32 m0, s94, 86016
  v_mfma_f32_32x32x16_bf16 v[112:127], a[180:183], a[132:135], v[112:127]
  ds_read_b64_tr_b16 a[168:169], v215 offset:38912
  ds_read_b64_tr_b16 a[170:171], v215 offset:39168
  buffer_load_dwordx4 v184, s[44:47], s14 offen offset:0 lds
  v_mul_f32 v251, v251, v111
  s_waitcnt lgkmcnt(6)
  v_mfma_f32_32x32x16_bf16 v[112:127], a[184:187], a[136:139], v[112:127]
  ds_read_b64_tr_b16 a[172:173], v215 offset:39936
  ds_read_b64_tr_b16 a[174:175], v215 offset:40192
  v_cvt_pk_bf16_f32 v106, v248, v249
  v_cvt_pk_bf16_f32 v107, v250, v251
  buffer_store_dwordx4 v[104:107], v15, s[48:51], s85 offen offset:3584 sc1
  v_mfma_f32_32x32x16_bf16 v[112:127], a[188:191], a[140:143], v[112:127]
  ds_read_b128 a[176:179], v19 offset:2048
  s_waitcnt vmcnt(11)
  s_barrier
  s_waitcnt lgkmcnt(5)
  v_mfma_f32_32x32x16_bf16 v[112:127], a[160:163], a[144:147], v[112:127]
  ds_read_b64_tr_b16 a[180:181], v208 offset:0
  ds_read_b64_tr_b16 a[182:183], v208 offset:640
  s_add_u32 s101, s90, 983040
  s_add_u32 m0, s94, 40960
  v_mfma_f32_32x32x16_bf16 v[112:127], a[164:167], a[148:151], v[112:127]
  ds_read_b64_tr_b16 a[184:185], v208 offset:2560
  ds_read_b64_tr_b16 a[186:187], v208 offset:3200
  buffer_load_dwordx4 v10, s[32:35], s101 offen offset:0 lds
  s_waitcnt lgkmcnt(5)
  v_mfma_f32_32x32x16_bf16 v[112:127], a[168:171], a[152:155], v[112:127]
  ds_read_b64_tr_b16 a[188:189], v208 offset:5120
  ds_read_b64_tr_b16 a[190:191], v208 offset:5760
  buffer_load_dwordx4 v11, s[32:35], s101 offen offset:1024 lds
  v_mfma_f32_32x32x16_bf16 v[112:127], a[172:175], a[156:159], v[112:127]
  ds_read_b64_tr_b16 a[160:161], v208 offset:7680
  ds_read_b64_tr_b16 a[162:163], v208 offset:8320
  s_waitcnt lgkmcnt(6)
  v_mfma_f32_32x32x16_bf16 v[112:127], a[176:179], v[40:43], v[112:127]
  ds_read_b64_tr_b16 a[164:165], v208 offset:64
  ds_read_b64_tr_b16 a[166:167], v208 offset:704
  buffer_load_dwordx4 v12, s[32:35], s101 offen offset:2048 lds
  v_mfma_f32_32x32x16_bf16 v[128:143], a[180:183], a[0:3], 0
  ds_read_b64_tr_b16 a[168:169], v208 offset:2624
  ds_read_b64_tr_b16 a[170:171], v208 offset:3264
  s_waitcnt lgkmcnt(6)
  v_mfma_f32_32x32x16_bf16 v[128:143], a[184:187], a[4:7], v[128:143]
  ds_read_b64_tr_b16 a[172:173], v208 offset:5184
  ds_read_b64_tr_b16 a[174:175], v208 offset:5824
  buffer_load_dwordx4 v13, s[32:35], s101 offen offset:3072 lds
  s_nop 0
  v_mul_f32 v244, v112, v112
  v_mfma_f32_32x32x16_bf16 v[128:143], a[188:191], a[8:11], v[128:143]
  ds_read_b64_tr_b16 a[176:177], v208 offset:7744
  ds_read_b64_tr_b16 a[178:179], v208 offset:8384
  v_mul_f32 v245, v113, v113
  v_mul_f32 v246, v114, v114
  v_mul_f32 v247, v115, v115
  s_add_u32 m0, s94, 45056
  s_waitcnt lgkmcnt(6)
  v_mfma_f32_32x32x16_bf16 v[128:143], a[160:163], a[12:15], v[128:143]
  ds_read_b64_tr_b16 a[180:181], v210 offset:0
  ds_read_b64_tr_b16 a[182:183], v210 offset:640
  buffer_load_dwordx4 v14, s[32:35], s101 offen offset:0 lds
  v_fma_f32 v244, v244, v38, v36
  v_mfma_f32_32x32x16_bf16 v[144:159], a[164:167], a[0:3], 0
  ds_read_b64_tr_b16 a[184:185], v210 offset:2560
  ds_read_b64_tr_b16 a[186:187], v210 offset:3200
  v_fma_f32 v245, v245, v38, v36
  v_fma_f32 v246, v246, v38, v36
  v_fma_f32 v247, v247, v38, v36
  s_waitcnt lgkmcnt(6)
  v_mfma_f32_32x32x16_bf16 v[144:159], a[168:171], a[4:7], v[144:159]
  ds_read_b64_tr_b16 a[188:189], v210 offset:5120
  ds_read_b64_tr_b16 a[190:191], v210 offset:5760
  v_mul_f32 v244, v244, v112
  v_mul_f32 v245, v245, v113
  v_mul_f32 v246, v246, v114
  v_mfma_f32_32x32x16_bf16 v[144:159], a[172:175], a[8:11], v[144:159]
  ds_read_b64_tr_b16 a[160:161], v210 offset:7680
  ds_read_b64_tr_b16 a[162:163], v210 offset:8320
  v_mul_f32 v247, v247, v115
  v_exp_f32 v244, v244
  s_waitcnt lgkmcnt(6)
  v_mfma_f32_32x32x16_bf16 v[144:159], a[176:179], a[12:15], v[144:159]
  ds_read_b64_tr_b16 a[164:165], v208 offset:10240
  ds_read_b64_tr_b16 a[166:167], v208 offset:10880
  v_exp_f32 v245, v245
  v_exp_f32 v246, v246
  v_mfma_f32_32x32x16_bf16 v[160:175], a[180:183], a[0:3], 0
  ds_read_b64_tr_b16 a[168:169], v208 offset:12800
  ds_read_b64_tr_b16 a[170:171], v208 offset:13440
  v_exp_f32 v247, v247
  s_waitcnt lgkmcnt(6)
  v_mfma_f32_32x32x16_bf16 v[160:175], a[184:187], a[4:7], v[160:175]
  ds_read_b64_tr_b16 a[172:173], v208 offset:15360
  ds_read_b64_tr_b16 a[174:175], v208 offset:16000
  v_fma_f32 v244, v244, v44, v44
  v_fma_f32 v245, v245, v44, v44
  v_fma_f32 v246, v246, v44, v44
  v_mfma_f32_32x32x16_bf16 v[160:175], a[188:191], a[8:11], v[160:175]
  ds_read_b64_tr_b16 a[176:177], v208 offset:17920
  ds_read_b64_tr_b16 a[178:179], v208 offset:18560
  v_fma_f32 v247, v247, v44, v44
  v_rcp_f32 v244, v244
  s_waitcnt lgkmcnt(6)
  v_mfma_f32_32x32x16_bf16 v[160:175], a[160:163], a[12:15], v[160:175]
  ds_read_b64_tr_b16 a[180:181], v208 offset:10304
  ds_read_b64_tr_b16 a[182:183], v208 offset:10944
  v_rcp_f32 v245, v245
  v_rcp_f32 v246, v246
  v_mfma_f32_32x32x16_bf16 v[128:143], a[164:167], a[16:19], v[128:143]
  ds_read_b64_tr_b16 a[184:185], v208 offset:12864
  ds_read_b64_tr_b16 a[186:187], v208 offset:13504
  v_rcp_f32 v247, v247
  s_waitcnt lgkmcnt(6)
  v_mfma_f32_32x32x16_bf16 v[128:143], a[168:171], a[20:23], v[128:143]
  ds_read_b64_tr_b16 a[188:189], v208 offset:15424
  ds_read_b64_tr_b16 a[190:191], v208 offset:16064
  v_mul_f32 v244, v244, v112
  v_mul_f32 v245, v245, v113
  v_mul_f32 v246, v246, v114
  v_mfma_f32_32x32x16_bf16 v[128:143], a[172:175], a[24:27], v[128:143]
  ds_read_b64_tr_b16 a[160:161], v208 offset:17984
  ds_read_b64_tr_b16 a[162:163], v208 offset:18624
  v_mul_f32 v247, v247, v115
  v_cvt_pk_bf16_f32 v112, v244, v245
  v_cvt_pk_bf16_f32 v113, v246, v247
  s_waitcnt lgkmcnt(6)
  v_mfma_f32_32x32x16_bf16 v[128:143], a[176:179], a[28:31], v[128:143]
  ds_read_b64_tr_b16 a[164:165], v210 offset:10240
  ds_read_b64_tr_b16 a[166:167], v210 offset:10880
  v_mul_f32 v248, v116, v116
  v_mul_f32 v249, v117, v117
  v_mul_f32 v250, v118, v118
  v_mfma_f32_32x32x16_bf16 v[144:159], a[180:183], a[16:19], v[144:159]
  ds_read_b64_tr_b16 a[168:169], v210 offset:12800
  ds_read_b64_tr_b16 a[170:171], v210 offset:13440
  v_mul_f32 v251, v119, v119
  v_fma_f32 v248, v248, v38, v36
  v_fma_f32 v249, v249, v38, v36
  s_waitcnt lgkmcnt(6)
  v_mfma_f32_32x32x16_bf16 v[144:159], a[184:187], a[20:23], v[144:159]
  ds_read_b64_tr_b16 a[172:173], v210 offset:15360
  ds_read_b64_tr_b16 a[174:175], v210 offset:16000
  v_fma_f32 v250, v250, v38, v36
  v_fma_f32 v251, v251, v38, v36
  v_mul_f32 v248, v248, v116
  v_mfma_f32_32x32x16_bf16 v[144:159], a[188:191], a[24:27], v[144:159]
  ds_read_b64_tr_b16 a[176:177], v210 offset:17920
  ds_read_b64_tr_b16 a[178:179], v210 offset:18560
  v_mul_f32 v249, v249, v117
  v_mul_f32 v250, v250, v118
  v_mul_f32 v251, v251, v119
  s_waitcnt vmcnt(11)
  s_barrier
  s_waitcnt lgkmcnt(6)
  v_mfma_f32_32x32x16_bf16 v[144:159], a[160:163], a[28:31], v[144:159]
  ds_read_b64_tr_b16 a[180:181], v208 offset:20480
  ds_read_b64_tr_b16 a[182:183], v208 offset:21120
  v_exp_f32 v248, v248
  v_exp_f32 v249, v249
  s_add_u32 s101, s90, 1474560
  s_add_u32 m0, s94, 61440
  v_mfma_f32_32x32x16_bf16 v[160:175], a[164:167], a[16:19], v[160:175]
  ds_read_b64_tr_b16 a[184:185], v208 offset:23040
  ds_read_b64_tr_b16 a[186:187], v208 offset:23680
  buffer_load_dwordx4 v10, s[32:35], s101 offen offset:0 lds
  s_waitcnt lgkmcnt(6)
  v_mfma_f32_32x32x16_bf16 v[160:175], a[168:171], a[20:23], v[160:175]
  ds_read_b64_tr_b16 a[188:189], v208 offset:25600
  ds_read_b64_tr_b16 a[190:191], v208 offset:26240
  buffer_load_dwordx4 v11, s[32:35], s101 offen offset:1024 lds
  v_mfma_f32_32x32x16_bf16 v[160:175], a[172:175], a[24:27], v[160:175]
  ds_read_b64_tr_b16 a[160:161], v208 offset:28160
  ds_read_b64_tr_b16 a[162:163], v208 offset:28800
  v_exp_f32 v250, v250
  v_exp_f32 v251, v251
  s_waitcnt lgkmcnt(6)
  v_mfma_f32_32x32x16_bf16 v[160:175], a[176:179], a[28:31], v[160:175]
  ds_read_b64_tr_b16 a[164:165], v208 offset:20544
  ds_read_b64_tr_b16 a[166:167], v208 offset:21184
  buffer_load_dwordx4 v12, s[32:35], s101 offen offset:2048 lds
  v_mfma_f32_32x32x16_bf16 v[128:143], a[180:183], a[32:35], v[128:143]
  ds_read_b64_tr_b16 a[168:169], v208 offset:23104
  ds_read_b64_tr_b16 a[170:171], v208 offset:23744
  ds_read_b64_tr_b16 a[0:1], v191 offset:12288
  v_fma_f32 v248, v248, v44, v44
  v_fma_f32 v249, v249, v44, v44
  s_waitcnt lgkmcnt(7)
  v_mfma_f32_32x32x16_bf16 v[128:143], a[184:187], a[36:39], v[128:143]
  ds_read_b64_tr_b16 a[172:173], v208 offset:25664
  ds_read_b64_tr_b16 a[174:175], v208 offset:26304
  buffer_load_dwordx4 v13, s[32:35], s101 offen offset:3072 lds
  ds_read_b64_tr_b16 a[2:3], v191 offset:13568
  v_mfma_f32_32x32x16_bf16 v[128:143], a[188:191], a[40:43], v[128:143]
  ds_read_b64_tr_b16 a[176:177], v208 offset:28224
  ds_read_b64_tr_b16 a[178:179], v208 offset:28864
  ds_read_b64_tr_b16 a[4:5], v191 offset:12320
  v_fma_f32 v250, v250, v44, v44
  v_fma_f32 v251, v251, v44, v44
  s_add_u32 m0, s94, 65536
  s_waitcnt lgkmcnt(9)
  v_mfma_f32_32x32x16_bf16 v[128:143], a[160:163], a[44:47], v[128:143]
  ds_read_b64_tr_b16 a[180:181], v210 offset:20480
  ds_read_b64_tr_b16 a[182:183], v210 offset:21120
  buffer_load_dwordx4 v14, s[32:35], s101 offen offset:0 lds
  ds_read_b64_tr_b16 a[6:7], v191 offset:13600
  v_mfma_f32_32x32x16_bf16 v[144:159], a[164:167], a[32:35], v[144:159]
  ds_read_b64_tr_b16 a[184:185], v210 offset:23040
  ds_read_b64_tr_b16 a[186:187], v210 offset:23680
  ds_read_b64_tr_b16 a[8:9], v191 offset:12352
  v_rcp_f32 v248, v248
  s_waitcnt lgkmcnt(10)
  v_mfma_f32_32x32x16_bf16 v[144:159], a[168:171], a[36:39], v[144:159]
  ds_read_b64_tr_b16 a[188:189], v210 offset:25600
  ds_read_b64_tr_b16 a[190:191], v210 offset:26240
  ds_read_b64_tr_b16 a[10:11], v191 offset:13632
  v_rcp_f32 v249, v249
  v_mfma_f32_32x32x16_bf16 v[144:159], a[172:175], a[40:43], v[144:159]
  ds_read_b64_tr_b16 a[160:161], v210 offset:28160
  ds_read_b64_tr_b16 a[162:163], v210 offset:28800
  s_waitcnt lgkmcnt(8)
  ds_read_b64_tr_b16 a[12:13], v191 offset:12384
  v_rcp_f32 v250, v250
  v_mfma_f32_32x32x16_bf16 v[144:159], a[176:179], a[44:47], v[144:159]
  ds_read_b64_tr_b16 a[164:165], v208 offset:30720
  ds_read_b64_tr_b16 a[166:167], v208 offset:31360
  ds_read_b64_tr_b16 a[14:15], v191 offset:13664
  v_rcp_f32 v251, v251
  v_mfma_f32_32x32x16_bf16 v[160:175], a[180:183], a[32:35], v[160:175]
  ds_read_b64_tr_b16 a[168:169], v209 offset:512
  ds_read_b64_tr_b16 a[170:171], v209 offset:1152
  ds_read_b64_tr_b16 a[16:17], v191 offset:12416
  v_mul_f32 v248, v248, v116
  v_mul_f32 v249, v249, v117
  s_waitcnt lgkmcnt(10)
  v_mfma_f32_32x32x16_bf16 v[160:175], a[184:187], a[36:39], v[160:175]
  ds_read_b64_tr_b16 a[172:173], v209 offset:3072
  ds_read_b64_tr_b16 a[174:175], v209 offset:3712
  ds_read_b64_tr_b16 a[18:19], v191 offset:13696
  v_mul_f32 v250, v250, v118
  v_mul_f32 v251, v251, v119
  v_mfma_f32_32x32x16_bf16 v[160:175], a[188:191], a[40:43], v[160:175]
  ds_read_b64_tr_b16 a[176:177], v209 offset:5632
  ds_read_b64_tr_b16 a[178:179], v209 offset:6272
  v_cvt_pk_bf16_f32 v114, v248, v249
  v_cvt_pk_bf16_f32 v115, v250, v251
  buffer_store_dwordx4 v[112:115], v15, s[48:51], s95 offen offset:0 sc1
  s_add_u32 s14, s21, 122880
  s_add_u32 m0, s94, 143360
  s_waitcnt lgkmcnt(9)
  v_mfma_f32_32x32x16_bf16 v[160:175], a[160:163], a[44:47], v[160:175]
  ds_read_b64_tr_b16 a[180:181], v208 offset:30784
  ds_read_b64_tr_b16 a[182:183], v208 offset:31424
  s_waitcnt lgkmcnt(4)
  buffer_load_dwordx4 v180, s[44:47], s14 offen offset:0 lds
  v_mfma_f32_32x32x16_bf16 v[128:143], a[164:167], a[48:51], v[128:143]
  ds_read_b64_tr_b16 a[184:185], v209 offset:576
  ds_read_b64_tr_b16 a[186:187], v209 offset:1216
  buffer_load_dwordx4 v181, s[44:47], s14 offen offset:1024 lds
  v_mul_f32 v244, v120, v120
  v_mfma_f32_32x32x16_bf16 v[128:143], a[168:171], a[52:55], v[128:143]
  ds_read_b64_tr_b16 a[188:189], v209 offset:3136
  ds_read_b64_tr_b16 a[190:191], v209 offset:3776
  ds_read_b64_tr_b16 a[20:21], v190 offset:36864
  v_mul_f32 v245, v121, v121
  v_mul_f32 v246, v122, v122
  v_mfma_f32_32x32x16_bf16 v[128:143], a[172:175], a[56:59], v[128:143]
  ds_read_b64_tr_b16 a[160:161], v209 offset:5696
  ds_read_b64_tr_b16 a[162:163], v209 offset:6336
  buffer_load_dwordx4 v182, s[44:47], s14 offen offset:2048 lds
  ds_read_b64_tr_b16 a[22:23], v190 offset:38144
  s_waitcnt lgkmcnt(8)
  v_mfma_f32_32x32x16_bf16 v[128:143], a[176:179], a[60:63], v[128:143]
  ds_read_b64_tr_b16 a[164:165], v210 offset:30720
  ds_read_b64_tr_b16 a[166:167], v210 offset:31360
  buffer_load_dwordx4 v183, s[44:47], s14 offen offset:3072 lds
  ds_read_b64_tr_b16 a[24:25], v190 offset:36896
  v_mfma_f32_32x32x16_bf16 v[144:159], a[180:183], a[48:51], v[144:159]
  ds_read_b64_tr_b16 a[168:169], v211 offset:512
  ds_read_b64_tr_b16 a[170:171], v211 offset:1152
  ds_read_b64_tr_b16 a[26:27], v190 offset:38176
  v_mul_f32 v247, v123, v123
  v_fma_f32 v244, v244, v38, v36
  s_add_u32 m0, s94, 147456
  s_waitcnt lgkmcnt(10)
  v_mfma_f32_32x32x16_bf16 v[144:159], a[184:187], a[52:55], v[144:159]
  ds_read_b64_tr_b16 a[172:173], v211 offset:3072
  ds_read_b64_tr_b16 a[174:175], v211 offset:3712
  buffer_load_dwordx4 v184, s[44:47], s14 offen offset:0 lds
  ds_read_b64_tr_b16 a[28:29], v190 offset:36928
  v_mfma_f32_32x32x16_bf16 v[144:159], a[188:191], a[56:59], v[144:159]
  ds_read_b64_tr_b16 a[176:177], v211 offset:5632
  ds_read_b64_tr_b16 a[178:179], v211 offset:6272
  s_waitcnt lgkmcnt(8)
  ds_read_b64_tr_b16 a[30:31], v190 offset:38208
  v_fma_f32 v245, v245, v38, v36
  v_fma_f32 v246, v246, v38, v36
  s_waitcnt vmcnt(11)
  s_barrier
  v_mfma_f32_32x32x16_bf16 v[144:159], a[160:163], a[60:63], v[144:159]
  ds_read_b64_tr_b16 a[180:181], v209 offset:8192
  ds_read_b64_tr_b16 a[182:183], v209 offset:8832
  ds_read_b64_tr_b16 a[32:33], v190 offset:36960
  v_fma_f32 v247, v247, v38, v36
  v_mul_f32 v244, v244, v120
  s_add_u32 s101, s90, 1966080
  s_add_u32 m0, s94, 0
  v_mfma_f32_32x32x16_bf16 v[160:175], a[164:167], a[48:51], v[160:175]
  ds_read_b64_tr_b16 a[184:185], v209 offset:10752
  ds_read_b64_tr_b16 a[186:187], v209 offset:11392
  buffer_load_dwordx4 v10, s[32:35], s101 offen offset:0 lds
  ds_read_b64_tr_b16 a[34:35], v190 offset:38240
  s_waitcnt lgkmcnt(10)
  v_mfma_f32_32x32x16_bf16 v[160:175], a[168:171], a[52:55], v[160:175]
  ds_read_b64_tr_b16 a[188:189], v209 offset:13312
  ds_read_b64_tr_b16 a[190:191], v209 offset:13952
  buffer_load_dwordx4 v11, s[32:35], s101 offen offset:1024 lds
  ds_read_b64_tr_b16 a[36:37], v190 offset:36992
  v_mfma_f32_32x32x16_bf16 v[160:175], a[172:175], a[56:59], v[160:175]
  ds_read_b64_tr_b16 a[160:161], v209 offset:15872
  ds_read_b64_tr_b16 a[162:163], v209 offset:16512
  s_waitcnt lgkmcnt(8)
  ds_read_b64_tr_b16 a[38:39], v190 offset:38272
  v_mul_f32 v245, v245, v121
  v_mfma_f32_32x32x16_bf16 v[160:175], a[176:179], a[60:63], v[160:175]
  ds_read_b64_tr_b16 a[164:165], v209 offset:8256
  ds_read_b64_tr_b16 a[166:167], v209 offset:8896
  buffer_load_dwordx4 v12, s[32:35], s101 offen offset:2048 lds
  v_mul_f32 v246, v246, v122
  v_mfma_f32_32x32x16_bf16 v[128:143], a[180:183], a[64:67], v[128:143]
  ds_read_b64_tr_b16 a[168:169], v209 offset:10816
  ds_read_b64_tr_b16 a[170:171], v209 offset:11456
  v_mul_f32 v247, v247, v123
  v_exp_f32 v244, v244
  s_waitcnt lgkmcnt(8)
  v_mfma_f32_32x32x16_bf16 v[128:143], a[184:187], a[68:71], v[128:143]
  ds_read_b64_tr_b16 a[172:173], v209 offset:13376
  ds_read_b64_tr_b16 a[174:175], v209 offset:14016
  buffer_load_dwordx4 v13, s[32:35], s101 offen offset:3072 lds
  v_exp_f32 v245, v245
  v_mfma_f32_32x32x16_bf16 v[128:143], a[188:191], a[72:75], v[128:143]
  ds_read_b64_tr_b16 a[176:177], v209 offset:15936
  ds_read_b64_tr_b16 a[178:179], v209 offset:16576
  v_exp_f32 v246, v246
  s_add_u32 m0, s94, 4096
  s_waitcnt lgkmcnt(6)
  v_mfma_f32_32x32x16_bf16 v[128:143], a[160:163], a[76:79], v[128:143]
  ds_read_b64_tr_b16 a[180:181], v211 offset:8192
  ds_read_b64_tr_b16 a[182:183], v211 offset:8832
  buffer_load_dwordx4 v14, s[32:35], s101 offen offset:0 lds
  v_exp_f32 v247, v247
  v_mfma_f32_32x32x16_bf16 v[144:159], a[164:167], a[64:67], v[144:159]
  ds_read_b64_tr_b16 a[184:185], v211 offset:10752
  ds_read_b64_tr_b16 a[186:187], v211 offset:11392
  ds_read_b64_tr_b16 a[40:41], v190 offset:16384
  v_fma_f32 v244, v244, v44, v44
  v_fma_f32 v245, v245, v44, v44
  v_fma_f32 v246, v246, v44, v44
  v_fma_f32 v247, v247, v44, v44
  v_rcp_f32 v244, v244
  v_rcp_f32 v245, v245
  v_rcp_f32 v246, v246
  v_rcp_f32 v247, v247
  v_mul_f32 v244, v244, v120
  v_mul_f32 v245, v245, v121
  v_mul_f32 v246, v246, v122
  v_mul_f32 v247, v247, v123
  v_cvt_pk_bf16_f32 v120, v244, v245
  v_cvt_pk_bf16_f32 v121, v246, v247
  v_mul_f32 v248, v124, v124
  v_mul_f32 v249, v125, v125
  v_mul_f32 v250, v126, v126
  v_mul_f32 v251, v127, v127
  v_fma_f32 v248, v248, v38, v36
  v_fma_f32 v249, v249, v38, v36
  v_fma_f32 v250, v250, v38, v36
  v_fma_f32 v251, v251, v38, v36
  v_mul_f32 v248, v248, v124
  v_mul_f32 v249, v249, v125
  v_mul_f32 v250, v250, v126
  v_mul_f32 v251, v251, v127
  v_exp_f32 v248, v248
  v_exp_f32 v249, v249
  v_exp_f32 v250, v250
  v_exp_f32 v251, v251
  v_fma_f32 v248, v248, v44, v44
  v_fma_f32 v249, v249, v44, v44
  v_fma_f32 v250, v250, v44, v44
  v_fma_f32 v251, v251, v44, v44
  v_rcp_f32 v248, v248
  v_rcp_f32 v249, v249
  v_rcp_f32 v250, v250
  v_rcp_f32 v251, v251
  v_mul_f32 v248, v248, v124
  v_mul_f32 v249, v249, v125
  v_mul_f32 v250, v250, v126
  v_mul_f32 v251, v251, v127
  v_cvt_pk_bf16_f32 v122, v248, v249
  v_cvt_pk_bf16_f32 v123, v250, v251
  buffer_store_dwordx4 v[120:123], v15, s[48:51], s95 offen offset:512 sc1
  s_waitcnt lgkmcnt(7)
  v_mfma_f32_32x32x16_bf16 v[144:159], a[168:171], a[68:71], v[144:159]
  ds_read_b64_tr_b16 a[188:189], v211 offset:13312
  ds_read_b64_tr_b16 a[190:191], v211 offset:13952
  ds_read_b64_tr_b16 a[42:43], v190 offset:17664
  s_add_u32 m0, s94, 102400
  v_mfma_f32_32x32x16_bf16 v[144:159], a[172:175], a[72:75], v[144:159]
  ds_read_b64_tr_b16 a[160:161], v211 offset:15872
  ds_read_b64_tr_b16 a[162:163], v211 offset:16512
  buffer_load_dwordx4 v180, s[44:47], s23 offen offset:0 lds
  ds_read_b64_tr_b16 a[44:45], v190 offset:16416
  s_waitcnt lgkmcnt(9)
  v_mfma_f32_32x32x16_bf16 v[144:159], a[176:179], a[76:79], v[144:159]
  ds_read_b64_tr_b16 a[164:165], v209 offset:18432
  ds_read_b64_tr_b16 a[166:167], v209 offset:19072
  ds_read_b64_tr_b16 a[46:47], v190 offset:17696
  v_mfma_f32_32x32x16_bf16 v[160:175], a[180:183], a[64:67], v[160:175]
  ds_read_b64_tr_b16 a[168:169], v209 offset:20992
  ds_read_b64_tr_b16 a[170:171], v209 offset:21632
  buffer_load_dwordx4 v181, s[44:47], s23 offen offset:1024 lds
  ds_read_b64_tr_b16 a[48:49], v190 offset:16448
  s_waitcnt lgkmcnt(10)
  v_mfma_f32_32x32x16_bf16 v[160:175], a[184:187], a[68:71], v[160:175]
  ds_read_b64_tr_b16 a[172:173], v209 offset:23552
  ds_read_b64_tr_b16 a[174:175], v209 offset:24192
  ds_read_b64_tr_b16 a[50:51], v190 offset:17728
  v_mfma_f32_32x32x16_bf16 v[160:175], a[188:191], a[72:75], v[160:175]
  ds_read_b64_tr_b16 a[176:177], v209 offset:26112
  ds_read_b64_tr_b16 a[178:179], v209 offset:26752
  buffer_load_dwordx4 v182, s[44:47], s23 offen offset:2048 lds
  s_waitcnt lgkmcnt(8)
  ds_read_b64_tr_b16 a[52:53], v190 offset:16480
  v_mfma_f32_32x32x16_bf16 v[160:175], a[160:163], a[76:79], v[160:175]
  ds_read_b64_tr_b16 a[180:181], v209 offset:18496
  ds_read_b64_tr_b16 a[182:183], v209 offset:19136
  ds_read_b64_tr_b16 a[54:55], v190 offset:17760
  v_mfma_f32_32x32x16_bf16 v[128:143], a[164:167], a[80:83], v[128:143]
  ds_read_b64_tr_b16 a[184:185], v209 offset:21056
  ds_read_b64_tr_b16 a[186:187], v209 offset:21696
  buffer_load_dwordx4 v183, s[44:47], s23 offen offset:3072 lds
  ds_read_b64_tr_b16 a[56:57], v190 offset:16512
  s_waitcnt lgkmcnt(10)
  v_mfma_f32_32x32x16_bf16 v[128:143], a[168:171], a[84:87], v[128:143]
  ds_read_b64_tr_b16 a[188:189], v209 offset:23616
  ds_read_b64_tr_b16 a[190:191], v209 offset:24256
  ds_read_b64_tr_b16 a[58:59], v190 offset:17792
  s_add_u32 m0, s94, 106496
  v_mfma_f32_32x32x16_bf16 v[128:143], a[172:175], a[88:91], v[128:143]
  ds_read_b64_tr_b16 a[160:161], v209 offset:26176
  ds_read_b64_tr_b16 a[162:163], v209 offset:26816
  buffer_load_dwordx4 v184, s[44:47], s23 offen offset:0 lds
  s_waitcnt lgkmcnt(9)
  v_mfma_f32_32x32x16_bf16 v[128:143], a[176:179], a[92:95], v[128:143]
  ds_read_b64_tr_b16 a[164:165], v211 offset:18432
  ds_read_b64_tr_b16 a[166:167], v211 offset:19072
  s_mov_b32 s82, 5308416
  buffer_load_dword v45, v176, s[48:51], s82 offen sc1
  v_mfma_f32_32x32x16_bf16 v[144:159], a[180:183], a[80:83], v[144:159]
  ds_read_b64_tr_b16 a[168:169], v211 offset:20992
  ds_read_b64_tr_b16 a[170:171], v211 offset:21632
  s_waitcnt lgkmcnt(7)
  v_mfma_f32_32x32x16_bf16 v[144:159], a[184:187], a[84:87], v[144:159]
  ds_read_b64_tr_b16 a[172:173], v211 offset:23552
  ds_read_b64_tr_b16 a[174:175], v211 offset:24192
  v_mfma_f32_32x32x16_bf16 v[144:159], a[188:191], a[88:91], v[144:159]
  ds_read_b64_tr_b16 a[176:177], v211 offset:26112
  ds_read_b64_tr_b16 a[178:179], v211 offset:26752
  s_waitcnt vmcnt(18) lgkmcnt(10)
  s_barrier
  s_waitcnt lgkmcnt(6)
  v_mfma_f32_32x32x16_bf16 v[144:159], a[160:163], a[92:95], v[144:159]
  ds_read_b64_tr_b16 a[180:181], v209 offset:28672
  ds_read_b64_tr_b16 a[182:183], v209 offset:29312
  v_mfma_f32_32x32x16_bf16 v[160:175], a[164:167], a[80:83], v[160:175]
  ds_read_b64_tr_b16 a[184:185], v209 offset:31232
  ds_read_b64_tr_b16 a[186:187], v209 offset:31872
  v_mov_b32 v244, 0
  v_mov_b32 v245, 0
  v_mov_b32 v246, 0
  s_waitcnt lgkmcnt(6)
  v_mfma_f32_32x32x16_bf16 v[160:175], a[168:171], a[84:87], v[160:175]
  ds_read_b64_tr_b16 a[188:189], v209 offset:33792
  ds_read_b64_tr_b16 a[190:191], v209 offset:34432
  v_mov_b32 v247, 0
  v_lshlrev_b32 v248, 4, v0
  v_add_u32 v248, 81920, v248
  v_mfma_f32_32x32x16_bf16 v[160:175], a[172:175], a[88:91], v[160:175]
  ds_read_b64_tr_b16 a[160:161], v209 offset:36352
  ds_read_b64_tr_b16 a[162:163], v209 offset:36992
  ds_write_b128 v248, v[244:247] offset:0
  ds_write_b128 v248, v[244:247] offset:4096
  ds_write_b128 v248, v[244:247] offset:8192
  s_waitcnt lgkmcnt(9)
  v_mfma_f32_32x32x16_bf16 v[160:175], a[176:179], a[92:95], v[160:175]
  ds_read_b64_tr_b16 a[164:165], v209 offset:28736
  ds_read_b64_tr_b16 a[166:167], v209 offset:29376
  ds_write_b128 v248, v[244:247] offset:12288
  ds_write_b128 v248, v[244:247] offset:16384
  s_add_u32 m0, s94, 20480
  v_mfma_f32_32x32x16_bf16 v[128:143], a[180:183], a[96:99], v[128:143]
  ds_read_b64_tr_b16 a[168:169], v209 offset:31296
  ds_read_b64_tr_b16 a[170:171], v209 offset:31936
  buffer_load_dwordx4 v180, s[44:47], s22 offen offset:0 lds
  s_waitcnt lgkmcnt(11)
  v_mfma_f32_32x32x16_bf16 v[128:143], a[184:187], a[100:103], v[128:143]
  ds_read_b64_tr_b16 a[172:173], v209 offset:33856
  ds_read_b64_tr_b16 a[174:175], v209 offset:34496
  v_mfma_f32_32x32x16_bf16 v[128:143], a[188:191], a[104:107], v[128:143]
  ds_read_b64_tr_b16 a[176:177], v209 offset:36416
  ds_read_b64_tr_b16 a[178:179], v209 offset:37056
  buffer_load_dwordx4 v181, s[44:47], s22 offen offset:1024 lds
  s_waitcnt lgkmcnt(8)
  v_mfma_f32_32x32x16_bf16 v[128:143], a[160:163], a[108:111], v[128:143]
  ds_read_b64_tr_b16 a[180:181], v211 offset:28672
  ds_read_b64_tr_b16 a[182:183], v211 offset:29312
  v_mfma_f32_32x32x16_bf16 v[144:159], a[164:167], a[96:99], v[144:159]
  ds_read_b64_tr_b16 a[184:185], v211 offset:31232
  ds_read_b64_tr_b16 a[186:187], v211 offset:31872
  buffer_load_dwordx4 v182, s[44:47], s22 offen offset:2048 lds
  s_waitcnt vmcnt(15)
  ds_read_b64_tr_b16 a[60:61], v191 offset:12288
  s_waitcnt lgkmcnt(7)
  v_mfma_f32_32x32x16_bf16 v[144:159], a[168:171], a[100:103], v[144:159]
  ds_read_b64_tr_b16 a[188:189], v211 offset:33792
  ds_read_b64_tr_b16 a[190:191], v211 offset:34432
  ds_read_b64_tr_b16 a[62:63], v191 offset:13568
  v_mfma_f32_32x32x16_bf16 v[144:159], a[172:175], a[104:107], v[144:159]
  ds_read_b64_tr_b16 a[160:161], v211 offset:36352
  ds_read_b64_tr_b16 a[162:163], v211 offset:36992
  buffer_load_dwordx4 v183, s[44:47], s22 offen offset:3072 lds
  ds_read_b64_tr_b16 a[64:65], v191 offset:12320
  s_waitcnt lgkmcnt(9)
  v_mfma_f32_32x32x16_bf16 v[144:159], a[176:179], a[108:111], v[144:159]
  ds_read_b64_tr_b16 a[164:165], v209 offset:38912
  ds_read_b64_tr_b16 a[166:167], v209 offset:39552
  ds_read_b64_tr_b16 a[66:67], v191 offset:13600
  s_add_u32 m0, s94, 24576
  v_mfma_f32_32x32x16_bf16 v[160:175], a[180:183], a[96:99], v[160:175]
  ds_read_b64_tr_b16 a[168:169], v209 offset:41472
  ds_read_b64_tr_b16 a[170:171], v209 offset:42112
  buffer_load_dwordx4 v184, s[44:47], s22 offen offset:0 lds
  ds_read_b64_tr_b16 a[68:69], v191 offset:12352
  s_waitcnt lgkmcnt(10)
  v_mfma_f32_32x32x16_bf16 v[160:175], a[184:187], a[100:103], v[160:175]
  ds_read_b64_tr_b16 a[172:173], v209 offset:44032
  ds_read_b64_tr_b16 a[174:175], v209 offset:44672
  ds_read_b64_tr_b16 a[70:71], v191 offset:13632
  s_waitcnt vmcnt(11)
  s_mov_b64 exec, 1
  ds_add_rtn_u32 v26, v200, v201 offset:8
  s_mov_b64 exec, -1
  v_mfma_f32_32x32x16_bf16 v[160:175], a[188:191], a[104:107], v[160:175]
  ds_read_b64_tr_b16 a[176:177], v209 offset:46592
  s_waitcnt lgkmcnt(8)
  ds_read_b64_tr_b16 a[178:179], v209 offset:47232
  ds_read_b64_tr_b16 a[72:73], v191 offset:12384
  v_mfma_f32_32x32x16_bf16 v[160:175], a[160:163], a[108:111], v[160:175]
  ds_read_b64_tr_b16 a[180:181], v209 offset:38976
  ds_read_b64_tr_b16 a[182:183], v209 offset:39616
  ds_read_b64_tr_b16 a[74:75], v191 offset:13664
  v_mfma_f32_32x32x16_bf16 v[128:143], a[164:167], a[112:115], v[128:143]
  ds_read_b64_tr_b16 a[184:185], v209 offset:41536
  ds_read_b64_tr_b16 a[186:187], v209 offset:42176
  s_waitcnt lgkmcnt(8)
  ds_read_b64_tr_b16 a[76:77], v191 offset:12416
  v_readfirstlane_b32 s82, v26
  s_nop 0
  s_cmp_lg_u32 s82, 3
  s_cbranch_scc1 L_sig60
  s_add_u32 s82, s74, 2
  v_mov_b32 v26, s82
  s_mov_b32 s82, 5308416
  buffer_store_dword v26, v206, s[48:51], s82 offen sc1
L_sig60:
  v_mfma_f32_32x32x16_bf16 v[128:143], a[168:171], a[116:119], v[128:143]
  ds_read_b64_tr_b16 a[188:189], v209 offset:44096
  ds_read_b64_tr_b16 a[190:191], v209 offset:44736
  ds_read_b64_tr_b16 a[78:79], v191 offset:13696
  v_mfma_f32_32x32x16_bf16 v[128:143], a[172:175], a[120:123], v[128:143]
  ds_read_b64_tr_b16 a[160:161], v209 offset:46656
  ds_read_b64_tr_b16 a[162:163], v209 offset:47296
  s_waitcnt lgkmcnt(9)
  v_mfma_f32_32x32x16_bf16 v[128:143], a[176:179], a[124:127], v[128:143]
  ds_read_b64_tr_b16 a[164:165], v211 offset:38912
  ds_read_b64_tr_b16 a[166:167], v211 offset:39552
  v_mfma_f32_32x32x16_bf16 v[144:159], a[180:183], a[112:115], v[144:159]
  ds_read_b64_tr_b16 a[168:169], v211 offset:41472
  ds_read_b64_tr_b16 a[170:171], v211 offset:42112
  s_waitcnt lgkmcnt(7)
  v_mfma_f32_32x32x16_bf16 v[144:159], a[184:187], a[116:119], v[144:159]
  ds_read_b64_tr_b16 a[172:173], v211 offset:44032
  ds_read_b64_tr_b16 a[174:175], v211 offset:44672
  v_mfma_f32_32x32x16_bf16 v[144:159], a[188:191], a[120:123], v[144:159]
  ds_read_b64_tr_b16 a[176:177], v211 offset:46592
  ds_read_b64_tr_b16 a[178:179], v211 offset:47232
  s_barrier
  s_waitcnt lgkmcnt(6)
  v_mfma_f32_32x32x16_bf16 v[144:159], a[160:163], a[124:127], v[144:159]
  ds_read_b64_tr_b16 a[180:181], v208 offset:0
  ds_read_b64_tr_b16 a[182:183], v208 offset:640
  v_mfma_f32_32x32x16_bf16 v[160:175], a[164:167], a[112:115], v[160:175]
  ds_read_b64_tr_b16 a[184:185], v208 offset:2560
  ds_read_b64_tr_b16 a[186:187], v208 offset:3200
  s_waitcnt lgkmcnt(6)
  v_mfma_f32_32x32x16_bf16 v[160:175], a[168:171], a[116:119], v[160:175]
  ds_read_b64_tr_b16 a[188:189], v208 offset:5120
  ds_read_b64_tr_b16 a[190:191], v208 offset:5760
  s_add_u32 s82, s74, 2
  s_waitcnt vmcnt(5)
  v_cmp_ne_u32 vcc, s82, v45
  s_nop 0
  s_cbranch_vccnz L_slow45
L_back46:
  s_add_u32 s78, s99, 0
  v_mfma_f32_32x32x16_bf16 v[160:175], a[172:175], a[120:123], v[160:175]
  ds_read_b64_tr_b16 a[160:161], v208 offset:7680
  ds_read_b64_tr_b16 a[162:163], v208 offset:8320
  buffer_load_dwordx4 v[48:51], v21, s[48:51], s78 offen offset:0 sc1
  s_waitcnt lgkmcnt(6)
  v_mfma_f32_32x32x16_bf16 v[160:175], a[176:179], a[124:127], v[160:175]
  ds_read_b64_tr_b16 a[164:165], v208 offset:64
  ds_read_b64_tr_b16 a[166:167], v208 offset:704
  buffer_load_dwordx4 v[52:55], v21, s[48:51], s78 offen offset:1280 sc1
  v_mfma_f32_32x32x16_bf16 v[128:143], a[180:183], a[128:131], v[128:143]
  ds_read_b64_tr_b16 a[168:169], v208 offset:2624
  ds_read_b64_tr_b16 a[170:171], v208 offset:3264
  s_waitcnt lgkmcnt(6)
  v_mfma_f32_32x32x16_bf16 v[128:143], a[184:187], a[132:135], v[128:143]
  ds_read_b64_tr_b16 a[172:173], v208 offset:5184
  ds_read_b64_tr_b16 a[174:175], v208 offset:5824
  buffer_load_dwordx4 v[56:59], v21, s[48:51], s78 offen offset:2560 sc1
  v_mfma_f32_32x32x16_bf16 v[128:143], a[188:191], a[136:139], v[128:143]
  ds_read_b64_tr_b16 a[176:177], v208 offset:7744
  ds_read_b64_tr_b16 a[178:179], v208 offset:8384
  ds_read_b64_tr_b16 a[80:81], v190 offset:36864
  s_waitcnt lgkmcnt(7)
  v_mfma_f32_32x32x16_bf16 v[128:143], a[160:163], a[140:143], v[128:143]
  ds_read_b64_tr_b16 a[180:181], v210 offset:0
  ds_read_b64_tr_b16 a[182:183], v210 offset:640
  ds_read_b64_tr_b16 a[82:83], v190 offset:38144
  buffer_load_dwordx4 v[60:63], v21, s[48:51], s78 offen offset:3840 sc1
  v_mfma_f32_32x32x16_bf16 v[144:159], a[164:167], a[128:131], v[144:159]
  ds_read_b64_tr_b16 a[184:185], v210 offset:2560
  ds_read_b64_tr_b16 a[186:187], v210 offset:3200
  ds_read_b64_tr_b16 a[84:85], v190 offset:36896
  s_add_u32 s78, s99, 5120
  s_waitcnt lgkmcnt(9)
  v_mfma_f32_32x32x16_bf16 v[144:159], a[168:171], a[132:135], v[144:159]
  ds_read_b64_tr_b16 a[188:189], v210 offset:5120
  ds_read_b64_tr_b16 a[190:191], v210 offset:5760
  ds_read_b64_tr_b16 a[86:87], v190 offset:38176
  buffer_load_dwordx4 v[64:67], v21, s[48:51], s78 offen offset:0 sc1
  v_mfma_f32_32x32x16_bf16 v[144:159], a[172:175], a[136:139], v[144:159]
  ds_read_b64_tr_b16 a[160:161], v210 offset:7680
  ds_read_b64_tr_b16 a[162:163], v210 offset:8320
  ds_read_b64_tr_b16 a[88:89], v190 offset:36928
  buffer_load_dwordx4 v[68:71], v21, s[48:51], s78 offen offset:1280 sc1
  s_waitcnt lgkmcnt(10)
  v_mfma_f32_32x32x16_bf16 v[144:159], a[176:179], a[140:143], v[144:159]
  ds_read_b64_tr_b16 a[164:165], v208 offset:10240
  ds_read_b64_tr_b16 a[166:167], v208 offset:10880
  ds_read_b64_tr_b16 a[90:91], v190 offset:38208
  v_mfma_f32_32x32x16_bf16 v[160:175], a[180:183], a[128:131], v[160:175]
  ds_read_b64_tr_b16 a[168:169], v208 offset:12800
  ds_read_b64_tr_b16 a[170:171], v208 offset:13440
  s_waitcnt lgkmcnt(8)
  ds_read_b64_tr_b16 a[92:93], v190 offset:36960
  buffer_load_dwordx4 v[72:75], v21, s[48:51], s78 offen offset:2560 sc1
  v_mfma_f32_32x32x16_bf16 v[160:175], a[184:187], a[132:135], v[160:175]
  ds_read_b64_tr_b16 a[172:173], v208 offset:15360
  ds_read_b64_tr_b16 a[174:175], v208 offset:16000
  ds_read_b64_tr_b16 a[94:95], v190 offset:38240
  v_mfma_f32_32x32x16_bf16 v[160:175], a[188:191], a[136:139], v[160:175]
  ds_read_b64_tr_b16 a[176:177], v208 offset:17920
  ds_read_b64_tr_b16 a[178:179], v208 offset:18560
  ds_read_b64_tr_b16 a[96:97], v190 offset:36992
  buffer_load_dwordx4 v[76:79], v21, s[48:51], s78 offen offset:3840 sc1
  s_waitcnt lgkmcnt(10)
  v_mfma_f32_32x32x16_bf16 v[160:175], a[160:163], a[140:143], v[160:175]
  ds_read_b128 a[180:183], v19 offset:2560
  ds_read_b64_tr_b16 a[98:99], v190 offset:38272
  s_add_u32 s78, s99, 10240
  v_mfma_f32_32x32x16_bf16 v[128:143], a[164:167], a[144:147], v[128:143]
  ds_read_b64_tr_b16 a[184:185], v208 offset:10304
  ds_read_b64_tr_b16 a[186:187], v208 offset:10944
  buffer_load_dwordx4 v[80:83], v21, s[48:51], s78 offen offset:0 sc1
  s_waitcnt lgkmcnt(8)
  v_mfma_f32_32x32x16_bf16 v[128:143], a[168:171], a[148:151], v[128:143]
  ds_read_b64_tr_b16 a[188:189], v208 offset:12864
  ds_read_b64_tr_b16 a[190:191], v208 offset:13504
  buffer_load_dwordx4 v[84:87], v21, s[48:51], s78 offen offset:1280 sc1
  v_mfma_f32_32x32x16_bf16 v[128:143], a[172:175], a[152:155], v[128:143]
  ds_read_b64_tr_b16 a[160:161], v208 offset:15424
  ds_read_b64_tr_b16 a[162:163], v208 offset:16064
  s_waitcnt lgkmcnt(7)
  v_mfma_f32_32x32x16_bf16 v[128:143], a[176:179], a[156:159], v[128:143]
  ds_read_b64_tr_b16 a[164:165], v208 offset:17984
  ds_read_b64_tr_b16 a[166:167], v208 offset:18624
  buffer_load_dwordx4 v[88:91], v21, s[48:51], s78 offen offset:2560 sc1
  v_mfma_f32_32x32x16_bf16 v[128:143], a[180:183], v[40:43], v[128:143]
  ds_read_b128 a[168:171], v19 offset:3072
  s_waitcnt lgkmcnt(5)
  v_mfma_f32_32x32x16_bf16 v[144:159], a[184:187], a[144:147], v[144:159]
  ds_read_b64_tr_b16 a[172:173], v210 offset:10240
  ds_read_b64_tr_b16 a[174:175], v210 offset:10880
  buffer_load_dwordx4 v[92:95], v21, s[48:51], s78 offen offset:3840 sc1
  v_mfma_f32_32x32x16_bf16 v[144:159], a[188:191], a[148:151], v[144:159]
  ds_read_b64_tr_b16 a[176:177], v210 offset:12800
  ds_read_b64_tr_b16 a[178:179], v210 offset:13440
  s_add_u32 s78, s99, 15360
  s_waitcnt lgkmcnt(5)
  v_mfma_f32_32x32x16_bf16 v[144:159], a[160:163], a[152:155], v[144:159]
  ds_read_b64_tr_b16 a[180:181], v210 offset:15360
  ds_read_b64_tr_b16 a[182:183], v210 offset:16000
  buffer_load_dwordx4 v[96:99], v21, s[48:51], s78 offen offset:0 sc1
  v_mfma_f32_32x32x16_bf16 v[144:159], a[164:167], a[156:159], v[144:159]
  ds_read_b64_tr_b16 a[184:185], v210 offset:17920
  ds_read_b64_tr_b16 a[186:187], v210 offset:18560
  buffer_load_dwordx4 v[100:103], v21, s[48:51], s78 offen offset:1280 sc1
  s_waitcnt lgkmcnt(6)
  v_mfma_f32_32x32x16_bf16 v[144:159], a[168:171], v[40:43], v[144:159]
  ds_read_b128 a[188:191], v19 offset:3584
  v_mfma_f32_32x32x16_bf16 v[160:175], a[172:175], a[144:147], v[160:175]
  buffer_load_dwordx4 v[104:107], v21, s[48:51], s78 offen offset:2560 sc1
  s_waitcnt lgkmcnt(3)
  v_mfma_f32_32x32x16_bf16 v[160:175], a[176:179], a[148:151], v[160:175]
  v_mfma_f32_32x32x16_bf16 v[160:175], a[180:183], a[152:155], v[160:175]
  buffer_load_dwordx4 v[108:111], v21, s[48:51], s78 offen offset:3840 sc1
  s_waitcnt lgkmcnt(0)
  v_mfma_f32_32x32x16_bf16 v[160:175], a[184:187], a[156:159], v[160:175]
  v_mfma_f32_32x32x16_bf16 v[160:175], a[188:191], v[40:43], v[160:175]
  s_mov_b32 s82, 5308416
  buffer_load_dword v27, v205, s[48:51], s82 offen sc1
  s_barrier
  v_pk_mul_f32 v[244:245], v[128:129], v[34:35] op_sel_hi:[1,0]
  v_pk_mul_f32 v[246:247], v[130:131], v[34:35] op_sel_hi:[1,0]
  v_pk_fma_f32 v[128:129], v[128:129], v[32:33], 1.0 op_sel_hi:[1,0,0]
  v_pk_fma_f32 v[130:131], v[130:131], v[32:33], 1.0 op_sel_hi:[1,0,0]
  v_exp_f32_e64 v244, v244 clamp
  v_exp_f32_e64 v245, v245 clamp
  v_exp_f32_e64 v246, v246 clamp
  v_exp_f32_e64 v247, v247 clamp
  v_max_f32 v244, v244, v128
  v_max_f32 v245, v245, v129
  v_max_f32 v246, v246, v130
  v_max_f32 v247, v247, v131
  v_pk_add_f32 v[244:245], v[244:245], s[84:85] op_sel_hi:[1,0]
  v_pk_add_f32 v[246:247], v[246:247], s[84:85] op_sel_hi:[1,0]
  v_cvt_pk_bf16_f32 v128, v244, v245
  v_cvt_pk_bf16_f32 v129, v246, v247
  v_pk_mul_f32 v[248:249], v[132:133], v[34:35] op_sel_hi:[1,0]
  v_pk_mul_f32 v[250:251], v[134:135], v[34:35] op_sel_hi:[1,0]
  v_pk_fma_f32 v[132:133], v[132:133], v[32:33], 1.0 op_sel_hi:[1,0,0]
  v_pk_fma_f32 v[134:135], v[134:135], v[32:33], 1.0 op_sel_hi:[1,0,0]
  v_exp_f32_e64 v248, v248 clamp
  v_exp_f32_e64 v249, v249 clamp
  v_exp_f32_e64 v250, v250 clamp
  v_exp_f32_e64 v251, v251 clamp
  v_max_f32 v248, v248, v132
  v_max_f32 v249, v249, v133
  v_max_f32 v250, v250, v134
  v_max_f32 v251, v251, v135
  v_pk_add_f32 v[248:249], v[248:249], s[84:85] op_sel_hi:[1,0]
  v_pk_add_f32 v[250:251], v[250:251], s[84:85] op_sel_hi:[1,0]
  v_cvt_pk_bf16_f32 v130, v248, v249
  v_cvt_pk_bf16_f32 v131, v250, v251
  v_pk_mul_f32 v[244:245], v[136:137], v[34:35] op_sel_hi:[1,0]
  v_pk_mul_f32 v[246:247], v[138:139], v[34:35] op_sel_hi:[1,0]
  v_pk_fma_f32 v[136:137], v[136:137], v[32:33], 1.0 op_sel_hi:[1,0,0]
  v_pk_fma_f32 v[138:139], v[138:139], v[32:33], 1.0 op_sel_hi:[1,0,0]
  v_exp_f32_e64 v244, v244 clamp
  v_exp_f32_e64 v245, v245 clamp
  v_exp_f32_e64 v246, v246 clamp
  v_exp_f32_e64 v247, v247 clamp
  v_max_f32 v244, v244, v136
  v_max_f32 v245, v245, v137
  v_max_f32 v246, v246, v138
  v_max_f32 v247, v247, v139
  v_pk_add_f32 v[244:245], v[244:245], s[84:85] op_sel_hi:[1,0]
  v_pk_add_f32 v[246:247], v[246:247], s[84:85] op_sel_hi:[1,0]
  v_cvt_pk_bf16_f32 v132, v244, v245
  v_cvt_pk_bf16_f32 v133, v246, v247
  s_waitcnt vmcnt(16)
  v_dot2_f32_bf16 v112, v48, s88, 0
  v_dot2_f32_bf16 v113, v48, s89, 0
  v_dot2_f32_bf16 v114, v49, s88, 0
  v_dot2_f32_bf16 v115, v49, s89, 0
  v_dot2_f32_bf16 v116, v50, s88, 0
  v_dot2_f32_bf16 v117, v50, s89, 0
  v_dot2_f32_bf16 v118, v51, s88, 0
  v_dot2_f32_bf16 v119, v51, s89, 0
  s_add_u32 s14, s22, 40960
  s_add_u32 m0, s94, 40960
  s_nop 0
  buffer_load_dwordx4 v180, s[44:47], s14 offen offset:0 lds
  s_waitcnt vmcnt(16)
  v_dot2_f32_bf16 v112, v52, s88, v112
  v_dot2_f32_bf16 v113, v52, s89, v113
  v_dot2_f32_bf16 v114, v53, s88, v114
  v_dot2_f32_bf16 v115, v53, s89, v115
  v_dot2_f32_bf16 v116, v54, s88, v116
  v_dot2_f32_bf16 v117, v54, s89, v117
  v_dot2_f32_bf16 v118, v55, s88, v118
  v_dot2_f32_bf16 v119, v55, s89, v119
  s_waitcnt vmcnt(15)
  v_dot2_f32_bf16 v112, v56, s88, v112
  v_dot2_f32_bf16 v113, v56, s89, v113
  v_dot2_f32_bf16 v114, v57, s88, v114
  v_dot2_f32_bf16 v115, v57, s89, v115
  v_dot2_f32_bf16 v116, v58, s88, v116
  buffer_load_dwordx4 v181, s[44:47], s14 offen offset:1024 lds
  v_dot2_f32_bf16 v117, v58, s89, v117
  v_dot2_f32_bf16 v118, v59, s88, v118
  v_dot2_f32_bf16 v119, v59, s89, v119
  s_waitcnt vmcnt(15)
  v_dot2_f32_bf16 v112, v60, s88, v112
  v_dot2_f32_bf16 v113, v60, s89, v113
  v_dot2_f32_bf16 v114, v61, s88, v114
  v_dot2_f32_bf16 v115, v61, s89, v115
  v_dot2_f32_bf16 v116, v62, s88, v116
  v_dot2_f32_bf16 v117, v62, s89, v117
  v_dot2_f32_bf16 v118, v63, s88, v118
  v_dot2_f32_bf16 v119, v63, s89, v119
  s_waitcnt vmcnt(14)
  v_dot2_f32_bf16 v112, v64, s88, v112
  buffer_load_dwordx4 v182, s[44:47], s14 offen offset:2048 lds
  v_dot2_f32_bf16 v113, v64, s89, v113
  v_dot2_f32_bf16 v114, v65, s88, v114
  v_dot2_f32_bf16 v115, v65, s89, v115
  v_dot2_f32_bf16 v116, v66, s88, v116
  v_dot2_f32_bf16 v117, v66, s89, v117
  v_dot2_f32_bf16 v118, v67, s88, v118
  v_dot2_f32_bf16 v119, v67, s89, v119
  s_waitcnt vmcnt(14)
  v_dot2_f32_bf16 v112, v68, s88, v112
  v_dot2_f32_bf16 v113, v68, s89, v113
  v_dot2_f32_bf16 v114, v69, s88, v114
  v_dot2_f32_bf16 v115, v69, s89, v115
  v_dot2_f32_bf16 v116, v70, s88, v116
  v_dot2_f32_bf16 v117, v70, s89, v117
  buffer_load_dwordx4 v183, s[44:47], s14 offen offset:3072 lds
  v_dot2_f32_bf16 v118, v71, s88, v118
  v_dot2_f32_bf16 v119, v71, s89, v119
  s_waitcnt vmcnt(14)
  v_dot2_f32_bf16 v112, v72, s88, v112
  v_dot2_f32_bf16 v113, v72, s89, v113
  v_dot2_f32_bf16 v114, v73, s88, v114
  v_dot2_f32_bf16 v115, v73, s89, v115
  v_dot2_f32_bf16 v116, v74, s88, v116
  v_dot2_f32_bf16 v117, v74, s89, v117
  v_dot2_f32_bf16 v118, v75, s88, v118
  v_dot2_f32_bf16 v119, v75, s89, v119
  s_waitcnt vmcnt(13)
  v_dot2_f32_bf16 v112, v76, s88, v112
  v_dot2_f32_bf16 v113, v76, s89, v113
  v_dot2_f32_bf16 v114, v77, s88, v114
  s_add_u32 m0, s94, 45056
  s_nop 0
  buffer_load_dwordx4 v184, s[44:47], s14 offen offset:0 lds
  v_dot2_f32_bf16 v115, v77, s89, v115
  v_dot2_f32_bf16 v116, v78, s88, v116
  v_dot2_f32_bf16 v117, v78, s89, v117
  v_dot2_f32_bf16 v118, v79, s88, v118
  v_dot2_f32_bf16 v119, v79, s89, v119
  s_waitcnt vmcnt(13)
  v_dot2_f32_bf16 v112, v80, s88, v112
  v_dot2_f32_bf16 v113, v80, s89, v113
  v_dot2_f32_bf16 v114, v81, s88, v114
  v_dot2_f32_bf16 v115, v81, s89, v115
  v_dot2_f32_bf16 v116, v82, s88, v116
  v_dot2_f32_bf16 v117, v82, s89, v117
  v_dot2_f32_bf16 v118, v83, s88, v118
  v_dot2_f32_bf16 v119, v83, s89, v119
  s_add_u32 m0, s94, 143360
  s_nop 0
  buffer_load_dwordx4 v180, s[40:43], s24 offen offset:0 lds
  s_waitcnt vmcnt(13)
  v_dot2_f32_bf16 v112, v84, s88, v112
  v_dot2_f32_bf16 v113, v84, s89, v113
  v_dot2_f32_bf16 v114, v85, s88, v114
  v_dot2_f32_bf16 v115, v85, s89, v115
  v_dot2_f32_bf16 v116, v86, s88, v116
  v_dot2_f32_bf16 v117, v86, s89, v117
  v_dot2_f32_bf16 v118, v87, s88, v118
  v_dot2_f32_bf16 v119, v87, s89, v119
  s_waitcnt vmcnt(12)
  v_dot2_f32_bf16 v112, v88, s88, v112
  v_dot2_f32_bf16 v113, v88, s89, v113
  v_dot2_f32_bf16 v114, v89, s88, v114
  v_dot2_f32_bf16 v115, v89, s89, v115
  v_dot2_f32_bf16 v116, v90, s88, v116
  buffer_load_dwordx4 v181, s[40:43], s24 offen offset:1024 lds
  v_dot2_f32_bf16 v117, v90, s89, v117
  v_dot2_f32_bf16 v118, v91, s88, v118
  v_dot2_f32_bf16 v119, v91, s89, v119
  s_waitcnt vmcnt(12)
  v_dot2_f32_bf16 v112, v92, s88, v112
  v_dot2_f32_bf16 v113, v92, s89, v113
  v_dot2_f32_bf16 v114, v93, s88, v114
  v_dot2_f32_bf16 v115, v93, s89, v115
  v_dot2_f32_bf16 v116, v94, s88, v116
  v_dot2_f32_bf16 v117, v94, s89, v117
  v_dot2_f32_bf16 v118, v95, s88, v118
  v_dot2_f32_bf16 v119, v95, s89, v119
  s_waitcnt vmcnt(11)
  v_dot2_f32_bf16 v112, v96, s88, v112
  v_dot2_f32_bf16 v113, v96, s89, v113
  buffer_load_dwordx4 v182, s[40:43], s24 offen offset:2048 lds
  v_dot2_f32_bf16 v114, v97, s88, v114
  v_dot2_f32_bf16 v115, v97, s89, v115
  v_dot2_f32_bf16 v116, v98, s88, v116
  v_dot2_f32_bf16 v117, v98, s89, v117
  v_dot2_f32_bf16 v118, v99, s88, v118
  v_dot2_f32_bf16 v119, v99, s89, v119
  s_waitcnt vmcnt(11)
  v_dot2_f32_bf16 v112, v100, s88, v112
  v_dot2_f32_bf16 v113, v100, s89, v113
  v_dot2_f32_bf16 v114, v101, s88, v114
  v_dot2_f32_bf16 v115, v101, s89, v115
  v_dot2_f32_bf16 v116, v102, s88, v116
  v_dot2_f32_bf16 v117, v102, s89, v117
  v_dot2_f32_bf16 v118, v103, s88, v118
  buffer_load_dwordx4 v183, s[40:43], s24 offen offset:3072 lds
  v_dot2_f32_bf16 v119, v103, s89, v119
  s_waitcnt vmcnt(11)
  v_dot2_f32_bf16 v112, v104, s88, v112
  v_dot2_f32_bf16 v113, v104, s89, v113
  v_dot2_f32_bf16 v114, v105, s88, v114
  v_dot2_f32_bf16 v115, v105, s89, v115
  v_dot2_f32_bf16 v116, v106, s88, v116
  v_dot2_f32_bf16 v117, v106, s89, v117
  v_dot2_f32_bf16 v118, v107, s88, v118
  v_dot2_f32_bf16 v119, v107, s89, v119
  s_waitcnt vmcnt(10)
  v_dot2_f32_bf16 v112, v108, s88, v112
  v_dot2_f32_bf16 v113, v108, s89, v113
  v_dot2_f32_bf16 v114, v109, s88, v114
  v_dot2_f32_bf16 v115, v109, s89, v115
  s_add_u32 m0, s94, 147456
  s_nop 0
  buffer_load_dwordx4 v184, s[40:43], s24 offen offset:0 lds
  v_dot2_f32_bf16 v116, v110, s88, v116
  v_dot2_f32_bf16 v117, v110, s89, v117
  v_dot2_f32_bf16 v118, v111, s88, v118
  v_dot2_f32_bf16 v119, v111, s89, v119
  v_cvt_pk_bf16_f32 v112, v112, v113
  v_cvt_pk_bf16_f32 v113, v114, v115
  v_cvt_pk_bf16_f32 v114, v116, v117
  v_cvt_pk_bf16_f32 v115, v118, v119
  ds_write_b64 v23, v[112:113]
  ds_write_b64 v25, v[112:113]
  ds_write_b64 v24, v[114:115]
  ds_write_b64 v177, v[114:115]
  s_add_u32 s82, s74, 2
  s_waitcnt vmcnt(10)
  v_cmp_ne_u32 vcc, s82, v27
  s_nop 0
  s_cbranch_vccnz L_slow48
L_back49:
  buffer_load_dwordx4 a[196:199], v3, s[48:51], s17 offen offset:0 sc1
  v_pk_mul_f32 v[248:249], v[140:141], v[34:35] op_sel_hi:[1,0]
  v_pk_mul_f32 v[250:251], v[142:143], v[34:35] op_sel_hi:[1,0]
  v_pk_fma_f32 v[140:141], v[140:141], v[32:33], 1.0 op_sel_hi:[1,0,0]
  v_pk_fma_f32 v[142:143], v[142:143], v[32:33], 1.0 op_sel_hi:[1,0,0]
  v_exp_f32_e64 v248, v248 clamp
  v_exp_f32_e64 v249, v249 clamp
  v_exp_f32_e64 v250, v250 clamp
  v_exp_f32_e64 v251, v251 clamp
  v_max_f32 v248, v248, v140
  v_max_f32 v249, v249, v141
  buffer_load_dwordx4 a[200:203], v4, s[48:51], s17 offen offset:0 sc1
  v_max_f32 v250, v250, v142
  v_max_f32 v251, v251, v143
  v_pk_add_f32 v[248:249], v[248:249], s[84:85] op_sel_hi:[1,0]
  v_pk_add_f32 v[250:251], v[250:251], s[84:85] op_sel_hi:[1,0]
  v_cvt_pk_bf16_f32 v134, v248, v249
  v_cvt_pk_bf16_f32 v135, v250, v251
  v_pk_mul_f32 v[244:245], v[144:145], v[34:35] op_sel_hi:[1,0]
  v_pk_mul_f32 v[246:247], v[146:147], v[34:35] op_sel_hi:[1,0]
  v_pk_fma_f32 v[144:145], v[144:145], v[32:33], 1.0 op_sel_hi:[1,0,0]
  buffer_load_dwordx4 a[204:207], v5, s[48:51], s17 offen offset:0 sc1
  v_pk_fma_f32 v[146:147], v[146:147], v[32:33], 1.0 op_sel_hi:[1,0,0]
  v_exp_f32_e64 v244, v244 clamp
  v_exp_f32_e64 v245, v245 clamp
  v_exp_f32_e64 v246, v246 clamp
  v_exp_f32_e64 v247, v247 clamp
  v_max_f32 v244, v244, v144
  v_max_f32 v245, v245, v145
  v_max_f32 v246, v246, v146
  v_max_f32 v247, v247, v147
  buffer_load_dwordx4 a[192:195], v2, s[48:51], s17 offen offset:0 sc1
  v_pk_add_f32 v[244:245], v[244:245], s[84:85] op_sel_hi:[1,0]
  v_pk_add_f32 v[246:247], v[246:247], s[84:85] op_sel_hi:[1,0]
  v_cvt_pk_bf16_f32 v136, v244, v245
  v_cvt_pk_bf16_f32 v137, v246, v247
  v_pk_mul_f32 v[248:249], v[148:149], v[34:35] op_sel_hi:[1,0]
  v_pk_mul_f32 v[250:251], v[150:151], v[34:35] op_sel_hi:[1,0]
  v_pk_fma_f32 v[148:149], v[148:149], v[32:33], 1.0 op_sel_hi:[1,0,0]
  v_pk_fma_f32 v[150:151], v[150:151], v[32:33], 1.0 op_sel_hi:[1,0,0]
  v_exp_f32_e64 v248, v248 clamp
  v_exp_f32_e64 v249, v249 clamp
  buffer_load_dwordx4 a[212:215], v3, s[48:51], s17 offen offset:1024 sc1
  v_exp_f32_e64 v250, v250 clamp
  v_exp_f32_e64 v251, v251 clamp
  v_max_f32 v248, v248, v148
  v_max_f32 v249, v249, v149
  v_max_f32 v250, v250, v150
  v_max_f32 v251, v251, v151
  v_pk_add_f32 v[248:249], v[248:249], s[84:85] op_sel_hi:[1,0]
  v_pk_add_f32 v[250:251], v[250:251], s[84:85] op_sel_hi:[1,0]
  v_cvt_pk_bf16_f32 v138, v248, v249
  buffer_load_dwordx4 a[216:219], v4, s[48:51], s17 offen offset:1024 sc1
  v_cvt_pk_bf16_f32 v139, v250, v251
  v_pk_mul_f32 v[244:245], v[152:153], v[34:35] op_sel_hi:[1,0]
  v_pk_mul_f32 v[246:247], v[154:155], v[34:35] op_sel_hi:[1,0]
  v_pk_fma_f32 v[152:153], v[152:153], v[32:33], 1.0 op_sel_hi:[1,0,0]
  v_pk_fma_f32 v[154:155], v[154:155], v[32:33], 1.0 op_sel_hi:[1,0,0]
  v_exp_f32_e64 v244, v244 clamp
  v_exp_f32_e64 v245, v245 clamp
  v_exp_f32_e64 v246, v246 clamp
  v_exp_f32_e64 v247, v247 clamp
  buffer_load_dwordx4 a[220:223], v5, s[48:51], s17 offen offset:1024 sc1
  v_max_f32 v244, v244, v152
  v_max_f32 v245, v245, v153
  v_max_f32 v246, v246, v154
  v_max_f32 v247, v247, v155
  v_pk_add_f32 v[244:245], v[244:245], s[84:85] op_sel_hi:[1,0]
  v_pk_add_f32 v[246:247], v[246:247], s[84:85] op_sel_hi:[1,0]
  v_cvt_pk_bf16_f32 v140, v244, v245
  v_cvt_pk_bf16_f32 v141, v246, v247
  v_pk_mul_f32 v[248:249], v[156:157], v[34:35] op_sel_hi:[1,0]
  v_pk_mul_f32 v[250:251], v[158:159], v[34:35] op_sel_hi:[1,0]
  buffer_load_dwordx4 a[208:211], v2, s[48:51], s17 offen offset:1024 sc1
  v_pk_fma_f32 v[156:157], v[156:157], v[32:33], 1.0 op_sel_hi:[1,0,0]
  v_pk_fma_f32 v[158:159], v[158:159], v[32:33], 1.0 op_sel_hi:[1,0,0]
  v_exp_f32_e64 v248, v248 clamp
  v_exp_f32_e64 v249, v249 clamp
  v_exp_f32_e64 v250, v250 clamp
  v_exp_f32_e64 v251, v251 clamp
  v_max_f32 v248, v248, v156
  v_max_f32 v249, v249, v157
  v_max_f32 v250, v250, v158
  buffer_load_dwordx4 a[228:231], v3, s[48:51], s17 offen offset:2048 sc1
  v_max_f32 v251, v251, v159
  v_pk_add_f32 v[248:249], v[248:249], s[84:85] op_sel_hi:[1,0]
  v_pk_add_f32 v[250:251], v[250:251], s[84:85] op_sel_hi:[1,0]
  v_cvt_pk_bf16_f32 v142, v248, v249
  v_cvt_pk_bf16_f32 v143, v250, v251
  v_pk_mul_f32 v[244:245], v[160:161], v[34:35] op_sel_hi:[1,0]
  v_pk_mul_f32 v[246:247], v[162:163], v[34:35] op_sel_hi:[1,0]
  v_pk_fma_f32 v[160:161], v[160:161], v[32:33], 1.0 op_sel_hi:[1,0,0]
  v_pk_fma_f32 v[162:163], v[162:163], v[32:33], 1.0 op_sel_hi:[1,0,0]
  buffer_load_dwordx4 a[232:235], v4, s[48:51], s17 offen offset:2048 sc1
  v_exp_f32_e64 v244, v244 clamp
  v_exp_f32_e64 v245, v245 clamp
  v_exp_f32_e64 v246, v246 clamp
  v_exp_f32_e64 v247, v247 clamp
  v_max_f32 v244, v244, v160
  v_max_f32 v245, v245, v161
  v_max_f32 v246, v246, v162
  v_max_f32 v247, v247, v163
  v_pk_add_f32 v[244:245], v[244:245], s[84:85] op_sel_hi:[1,0]
  v_pk_add_f32 v[246:247], v[246:247], s[84:85] op_sel_hi:[1,0]
  buffer_load_dwordx4 a[236:239], v5, s[48:51], s17 offen offset:2048 sc1
  v_cvt_pk_bf16_f32 v144, v244, v245
  v_cvt_pk_bf16_f32 v145, v246, v247
  v_pk_mul_f32 v[248:249], v[164:165], v[34:35] op_sel_hi:[1,0]
  v_pk_mul_f32 v[250:251], v[166:167], v[34:35] op_sel_hi:[1,0]
  v_pk_fma_f32 v[164:165], v[164:165], v[32:33], 1.0 op_sel_hi:[1,0,0]
  v_pk_fma_f32 v[166:167], v[166:167], v[32:33], 1.0 op_sel_hi:[1,0,0]
  v_exp_f32_e64 v248, v248 clamp
  v_exp_f32_e64 v249, v249 clamp
  v_exp_f32_e64 v250, v250 clamp
  buffer_load_dwordx4 a[224:227], v2, s[48:51], s17 offen offset:2048 sc1
  v_exp_f32_e64 v251, v251 clamp
  v_max_f32 v248, v248, v164
  v_max_f32 v249, v249, v165
  v_max_f32 v250, v250, v166
  v_max_f32 v251, v251, v167
  v_pk_add_f32 v[248:249], v[248:249], s[84:85] op_sel_hi:[1,0]
  v_pk_add_f32 v[250:251], v[250:251], s[84:85] op_sel_hi:[1,0]
  v_cvt_pk_bf16_f32 v146, v248, v249
  v_cvt_pk_bf16_f32 v147, v250, v251
  s_waitcnt lgkmcnt(0)
  s_barrier
  ds_read_b128 v[244:247], v20 offset:11264
  ds_read_b128 v[248:251], v20 offset:11296
  s_waitcnt lgkmcnt(1)
  v_mfma_f32_32x32x16_bf16 v[164:179], v[244:247], v[128:131], 0
  ds_read_b128 v[252:255], v20 offset:11328
  buffer_load_dwordx4 a[244:247], v3, s[48:51], s17 offen offset:3072 sc1
  s_waitcnt lgkmcnt(1)
  v_mfma_f32_32x32x16_bf16 v[164:179], v[248:251], v[132:135], v[164:179]
  ds_read_b128 v[244:247], v20 offset:11360
  s_waitcnt lgkmcnt(1)
  v_mfma_f32_32x32x16_bf16 v[164:179], v[252:255], v[136:139], v[164:179]
  ds_read_b128 v[248:251], v20 offset:11392
  s_waitcnt lgkmcnt(1)
  v_mfma_f32_32x32x16_bf16 v[164:179], v[244:247], v[140:143], v[164:179]
  ds_read_b128 v[252:255], v20 offset:0
  buffer_load_dwordx4 a[248:251], v4, s[48:51], s17 offen offset:3072 sc1
  s_waitcnt lgkmcnt(1)
  v_mfma_f32_32x32x16_bf16 v[164:179], v[248:251], v[144:147], v[164:179]
  ds_read_b128 v[244:247], v20 offset:32
  s_waitcnt lgkmcnt(1)
  v_mfma_f32_32x32x16_bf16 v[112:127], v[252:255], v[128:131], 0
  ds_read_b128 v[248:251], v20 offset:64
  s_waitcnt lgkmcnt(1)
  v_mfma_f32_32x32x16_bf16 v[112:127], v[244:247], v[132:135], v[112:127]
  ds_read_b128 v[252:255], v20 offset:96
  s_waitcnt lgkmcnt(1)
  v_mfma_f32_32x32x16_bf16 v[112:127], v[248:251], v[136:139], v[112:127]
  ds_read_b128 v[244:247], v20 offset:128
  buffer_load_dwordx4 a[252:255], v5, s[48:51], s17 offen offset:3072 sc1
  s_waitcnt lgkmcnt(1)
  v_mfma_f32_32x32x16_bf16 v[112:127], v[252:255], v[140:143], v[112:127]
  ds_read_b128 v[248:251], v20 offset:5632
  s_waitcnt lgkmcnt(1)
  v_mfma_f32_32x32x16_bf16 v[112:127], v[244:247], v[144:147], v[112:127]
  ds_read_b128 v[252:255], v20 offset:5664
  s_waitcnt lgkmcnt(1)
  v_mfma_f32_32x32x16_bf16 v[148:163], v[248:251], v[128:131], 0
  ds_read_b128 v[244:247], v20 offset:5696
  s_waitcnt lgkmcnt(1)
  v_mfma_f32_32x32x16_bf16 v[148:163], v[252:255], v[132:135], v[148:163]
  ds_read_b128 v[248:251], v20 offset:5728
  buffer_load_dwordx4 a[240:243], v2, s[48:51], s17 offen offset:3072 sc1
  s_waitcnt lgkmcnt(1)
  v_mfma_f32_32x32x16_bf16 v[148:163], v[244:247], v[136:139], v[148:163]
  ds_read_b128 v[252:255], v20 offset:5760
  s_waitcnt lgkmcnt(1)
  v_mfma_f32_32x32x16_bf16 v[148:163], v[248:251], v[140:143], v[148:163]
  s_waitcnt lgkmcnt(0)
  v_mfma_f32_32x32x16_bf16 v[148:163], v[252:255], v[144:147], v[148:163]
  v_add_f32 v244, s84, v172
  v_add_f32 v245, s84, v173
  v_add_f32 v246, s84, v174
  v_add_f32 v247, s84, v175
  v_rcp_f32 v244, v244
  v_rcp_f32 v245, v245
  v_rcp_f32 v246, v246
  v_rcp_f32 v247, v247
  v_bfi_b32 v248, v29, v245, v244
  v_bfi_b32 v249, v29, v247, v246
  v_pk_mul_f32 v[164:165], v[164:165], v[246:247] op_sel:[0,1] op_sel_hi:[1,1]
  v_pk_mul_f32 v[166:167], v[166:167], v[246:247] op_sel:[0,1] op_sel_hi:[1,1]
  v_cvt_pk_bf16_f32 v164, v164, v165
  v_cvt_pk_bf16_f32 v165, v166, v167
  v_pk_mul_f32 v[168:169], v[168:169], v[246:247] op_sel:[0,1] op_sel_hi:[1,1]
  v_pk_mul_f32 v[170:171], v[170:171], v[246:247] op_sel:[0,1] op_sel_hi:[1,1]
  v_cvt_pk_bf16_f32 v166, v168, v169
  v_cvt_pk_bf16_f32 v167, v170, v171
  buffer_store_dwordx4 v[164:167], v15, s[48:51], s25 offen offset:2048 sc1
  v_pk_mul_f32 v[112:113], v[112:113], v[244:245] op_sel_hi:[1,0]
  v_pk_mul_f32 v[114:115], v[114:115], v[244:245] op_sel_hi:[1,0]
  v_cvt_pk_bf16_f32 v112, v112, v113
  v_cvt_pk_bf16_f32 v113, v114, v115
  v_pk_mul_f32 v[116:117], v[116:117], v[244:245] op_sel_hi:[1,0]
  v_pk_mul_f32 v[118:119], v[118:119], v[244:245] op_sel_hi:[1,0]
  v_cvt_pk_bf16_f32 v114, v116, v117
  v_cvt_pk_bf16_f32 v115, v118, v119
  buffer_store_dwordx4 v[112:115], v15, s[48:51], s25 offen offset:0 sc1
  v_pk_mul_f32 v[120:121], v[120:121], v[248:249] op_sel_hi:[1,0]
  v_pk_mul_f32 v[122:123], v[122:123], v[248:249] op_sel_hi:[1,0]
  v_cvt_pk_bf16_f32 v120, v120, v121
  v_cvt_pk_bf16_f32 v121, v122, v123
  v_pk_mul_f32 v[124:125], v[124:125], v[244:245] op_sel:[0,1] op_sel_hi:[1,1]
  v_pk_mul_f32 v[126:127], v[126:127], v[244:245] op_sel:[0,1] op_sel_hi:[1,1]
  v_cvt_pk_bf16_f32 v122, v124, v125
  v_cvt_pk_bf16_f32 v123, v126, v127
  buffer_store_dwordx4 v[120:123], v15, s[48:51], s25 offen offset:512 sc1
  v_pk_mul_f32 v[148:149], v[148:149], v[244:245] op_sel:[0,1] op_sel_hi:[1,1]
  v_pk_mul_f32 v[150:151], v[150:151], v[244:245] op_sel:[0,1] op_sel_hi:[1,1]
  v_cvt_pk_bf16_f32 v148, v148, v149
  v_cvt_pk_bf16_f32 v149, v150, v151
  v_pk_mul_f32 v[152:153], v[152:153], v[246:247] op_sel_hi:[1,0]
  v_pk_mul_f32 v[154:155], v[154:155], v[246:247] op_sel_hi:[1,0]
  v_cvt_pk_bf16_f32 v150, v152, v153
  v_cvt_pk_bf16_f32 v151, v154, v155
  buffer_store_dwordx4 v[148:151], v15, s[48:51], s25 offen offset:1024 sc1
  v_pk_mul_f32 v[156:157], v[156:157], v[246:247] op_sel_hi:[1,0]
  v_pk_mul_f32 v[158:159], v[158:159], v[246:247] op_sel_hi:[1,0]
  v_cvt_pk_bf16_f32 v156, v156, v157
  v_cvt_pk_bf16_f32 v157, v158, v159
  v_pk_mul_f32 v[160:161], v[160:161], v[248:249] op_sel:[0,1] op_sel_hi:[1,1]
  v_pk_mul_f32 v[162:163], v[162:163], v[248:249] op_sel:[0,1] op_sel_hi:[1,1]
  v_cvt_pk_bf16_f32 v158, v160, v161
  v_cvt_pk_bf16_f32 v159, v162, v163
  buffer_store_dwordx4 v[156:159], v15, s[48:51], s25 offen offset:1536 sc1
  s_barrier
  s_add_u32 s14, s24, 163840
  s_add_u32 m0, s94, 102400
  s_waitcnt vmcnt(20)
  v_mfma_f32_16x16x32_bf16 v[68:71], a[0:3], a[196:199], 0
  ds_read_b64_tr_b16 a[100:101], v189 offset:20480
  buffer_load_dwordx4 v180, s[40:43], s14 offen offset:0 lds
  v_mfma_f32_16x16x32_bf16 v[72:75], a[4:7], a[196:199], 0
  v_mfma_f32_16x16x32_bf16 v[76:79], a[8:11], a[196:199], 0
  ds_read_b64_tr_b16 a[102:103], v189 offset:21760
  v_mfma_f32_16x16x32_bf16 v[80:83], a[12:15], a[196:199], 0
  v_mfma_f32_16x16x32_bf16 v[84:87], a[16:19], a[196:199], 0
  ds_read_b64_tr_b16 a[104:105], v189 offset:20512
  buffer_load_dwordx4 a[196:199], v3, s[48:51], s19 offen offset:0 sc1
  s_waitcnt vmcnt(21)
  v_mfma_f32_16x16x32_bf16 v[88:91], a[0:3], a[200:203], 0
  v_mfma_f32_16x16x32_bf16 v[92:95], a[4:7], a[200:203], 0
  ds_read_b64_tr_b16 a[106:107], v189 offset:21792
  v_mfma_f32_16x16x32_bf16 v[96:99], a[8:11], a[200:203], 0
  v_mfma_f32_16x16x32_bf16 v[100:103], a[12:15], a[200:203], 0
  ds_read_b64_tr_b16 a[108:109], v189 offset:20544
  v_mfma_f32_16x16x32_bf16 v[104:107], a[16:19], a[200:203], 0
  buffer_load_dwordx4 a[200:203], v4, s[48:51], s19 offen offset:0 sc1
  s_waitcnt vmcnt(21)
  v_mfma_f32_16x16x32_bf16 v[108:111], a[0:3], a[204:207], 0
  ds_read_b64_tr_b16 a[110:111], v189 offset:21824
  v_mfma_f32_16x16x32_bf16 v[208:211], a[4:7], a[204:207], 0
  v_mfma_f32_16x16x32_bf16 v[212:215], a[8:11], a[204:207], 0
  ds_read_b64_tr_b16 a[112:113], v189 offset:20576
  buffer_load_dwordx4 v181, s[40:43], s14 offen offset:1024 lds
  v_mfma_f32_16x16x32_bf16 v[216:219], a[12:15], a[204:207], 0
  v_mfma_f32_16x16x32_bf16 v[220:223], a[16:19], a[204:207], 0
  ds_read_b64_tr_b16 a[114:115], v189 offset:21856
  buffer_load_dwordx4 a[204:207], v5, s[48:51], s19 offen offset:0 sc1
  s_waitcnt vmcnt(22)
  v_mfma_f32_16x16x32_bf16 v[48:51], a[0:3], a[192:195], 0
  v_mfma_f32_16x16x32_bf16 v[52:55], a[4:7], a[192:195], 0
  ds_read_b64_tr_b16 a[116:117], v189 offset:20608
  v_mfma_f32_16x16x32_bf16 v[56:59], a[8:11], a[192:195], 0
  v_mfma_f32_16x16x32_bf16 v[60:63], a[12:15], a[192:195], 0
  ds_read_b64_tr_b16 a[118:119], v189 offset:21888
  v_mfma_f32_16x16x32_bf16 v[64:67], a[16:19], a[192:195], 0
  buffer_load_dwordx4 a[192:195], v2, s[48:51], s19 offen offset:0 sc1
  s_waitcnt vmcnt(22)
  v_mfma_f32_16x16x32_bf16 v[68:71], a[20:23], a[212:215], v[68:71]
  v_mfma_f32_16x16x32_bf16 v[72:75], a[24:27], a[212:215], v[72:75]
  v_mfma_f32_16x16x32_bf16 v[76:79], a[28:31], a[212:215], v[76:79]
  v_mfma_f32_16x16x32_bf16 v[80:83], a[32:35], a[212:215], v[80:83]
  s_mov_b32 s82, 5373952
  buffer_load_dword v27, v33, s[48:51], s82 offen sc1
  v_mfma_f32_16x16x32_bf16 v[84:87], a[36:39], a[212:215], v[84:87]
  buffer_load_dwordx4 v182, s[40:43], s14 offen offset:2048 lds
  buffer_load_dwordx4 a[212:215], v186, s[48:51], s17 offen offset:0 sc1
  s_waitcnt vmcnt(24)
  v_mfma_f32_16x16x32_bf16 v[88:91], a[20:23], a[216:219], v[88:91]
  v_mfma_f32_16x16x32_bf16 v[92:95], a[24:27], a[216:219], v[92:95]
  v_mfma_f32_16x16x32_bf16 v[96:99], a[28:31], a[216:219], v[96:99]
  v_mfma_f32_16x16x32_bf16 v[100:103], a[32:35], a[216:219], v[100:103]
  v_mfma_f32_16x16x32_bf16 v[104:107], a[36:39], a[216:219], v[104:107]
  buffer_load_dwordx4 a[216:219], v187, s[48:51], s17 offen offset:0 sc1
  s_waitcnt vmcnt(24)
  v_mfma_f32_16x16x32_bf16 v[108:111], a[20:23], a[220:223], v[108:111]
  v_mfma_f32_16x16x32_bf16 v[208:211], a[24:27], a[220:223], v[208:211]
  v_mfma_f32_16x16x32_bf16 v[212:215], a[28:31], a[220:223], v[212:215]
  v_mfma_f32_16x16x32_bf16 v[216:219], a[32:35], a[220:223], v[216:219]
  v_mfma_f32_16x16x32_bf16 v[220:223], a[36:39], a[220:223], v[220:223]
  buffer_load_dwordx4 a[220:223], v188, s[48:51], s17 offen offset:0 sc1
  s_waitcnt vmcnt(24)
  v_mfma_f32_16x16x32_bf16 v[48:51], a[20:23], a[208:211], v[48:51]
  v_mfma_f32_16x16x32_bf16 v[52:55], a[24:27], a[208:211], v[52:55]
  buffer_load_dwordx4 v183, s[40:43], s14 offen offset:3072 lds
  v_mfma_f32_16x16x32_bf16 v[56:59], a[28:31], a[208:211], v[56:59]
  v_mfma_f32_16x16x32_bf16 v[60:63], a[32:35], a[208:211], v[60:63]
  v_mfma_f32_16x16x32_bf16 v[64:67], a[36:39], a[208:211], v[64:67]
  buffer_load_dwordx4 a[208:211], v185, s[48:51], s17 offen offset:0 sc1
  s_waitcnt vmcnt(25)
  v_mfma_f32_16x16x32_bf16 v[68:71], a[40:43], a[228:231], v[68:71]
  ds_read_b64_tr_b16 a[120:121], v189 offset:40960
  v_mfma_f32_16x16x32_bf16 v[72:75], a[44:47], a[228:231], v[72:75]
  v_mfma_f32_16x16x32_bf16 v[76:79], a[48:51], a[228:231], v[76:79]
  ds_read_b64_tr_b16 a[122:123], v189 offset:42240
  v_mfma_f32_16x16x32_bf16 v[80:83], a[52:55], a[228:231], v[80:83]
  v_mfma_f32_16x16x32_bf16 v[84:87], a[56:59], a[228:231], v[84:87]
  ds_read_b64_tr_b16 a[124:125], v189 offset:40992
  buffer_load_dwordx4 a[228:231], v186, s[48:51], s17 offen offset:1024 sc1
  s_waitcnt vmcnt(25)
  v_mfma_f32_16x16x32_bf16 v[88:91], a[40:43], a[232:235], v[88:91]
  v_mfma_f32_16x16x32_bf16 v[92:95], a[44:47], a[232:235], v[92:95]
  ds_read_b64_tr_b16 a[126:127], v189 offset:42272
  v_mfma_f32_16x16x32_bf16 v[96:99], a[48:51], a[232:235], v[96:99]
  s_add_u32 m0, s94, 106496
  v_mfma_f32_16x16x32_bf16 v[100:103], a[52:55], a[232:235], v[100:103]
  ds_read_b64_tr_b16 a[128:129], v189 offset:41024
  buffer_load_dwordx4 v184, s[40:43], s14 offen offset:0 lds
  v_mfma_f32_16x16x32_bf16 v[104:107], a[56:59], a[232:235], v[104:107]
  buffer_load_dwordx4 a[232:235], v187, s[48:51], s17 offen offset:1024 sc1
  s_waitcnt vmcnt(26)
  v_mfma_f32_16x16x32_bf16 v[108:111], a[40:43], a[236:239], v[108:111]
  s_waitcnt lgkmcnt(8)
  ds_read_b64_tr_b16 a[130:131], v189 offset:42304
  v_mfma_f32_16x16x32_bf16 v[208:211], a[44:47], a[236:239], v[208:211]
  v_mfma_f32_16x16x32_bf16 v[212:215], a[48:51], a[236:239], v[212:215]
  ds_read_b64_tr_b16 a[132:133], v189 offset:41056
  v_mfma_f32_16x16x32_bf16 v[216:219], a[52:55], a[236:239], v[216:219]
  v_mfma_f32_16x16x32_bf16 v[220:223], a[56:59], a[236:239], v[220:223]
  ds_read_b64_tr_b16 a[134:135], v189 offset:42336
  buffer_load_dwordx4 a[236:239], v188, s[48:51], s17 offen offset:1024 sc1
  s_waitcnt vmcnt(26)
  v_mfma_f32_16x16x32_bf16 v[48:51], a[40:43], a[224:227], v[48:51]
  s_waitcnt vmcnt(17)
  s_mov_b64 exec, 1
  ds_add_rtn_u32 v26, v200, v201 offset:20
  s_mov_b64 exec, -1
  v_mfma_f32_16x16x32_bf16 v[52:55], a[44:47], a[224:227], v[52:55]
  ds_read_b64_tr_b16 a[136:137], v189 offset:41088
  v_mfma_f32_16x16x32_bf16 v[56:59], a[48:51], a[224:227], v[56:59]
  v_mfma_f32_16x16x32_bf16 v[60:63], a[52:55], a[224:227], v[60:63]
  ds_read_b64_tr_b16 a[138:139], v189 offset:42368
  v_mfma_f32_16x16x32_bf16 v[64:67], a[56:59], a[224:227], v[64:67]
  buffer_load_dwordx4 a[224:227], v185, s[48:51], s17 offen offset:1024 sc1
  s_add_u32 s14, s24, 327680
  s_add_u32 m0, s94, 61440
  v_mfma_f32_16x16x32_bf16 v[68:71], a[60:63], a[244:247], v[68:71]
  buffer_load_dwordx4 v180, s[40:43], s14 offen offset:0 lds
  v_mfma_f32_16x16x32_bf16 v[72:75], a[64:67], a[244:247], v[72:75]
  s_waitcnt lgkmcnt(2)
  v_readfirstlane_b32 s82, v26
  s_nop 0
  s_cmp_lg_u32 s82, 3
  s_cbranch_scc1 L_sig61
  s_add_u32 s82, s74, 5
  v_mov_b32 v26, s82
  s_mov_b32 s82, 5406720
  buffer_store_dword v26, v206, s[48:51], s82 offen sc1
L_sig61:
  v_mfma_f32_16x16x32_bf16 v[76:79], a[68:71], a[244:247], v[76:79]
  v_mfma_f32_16x16x32_bf16 v[80:83], a[72:75], a[244:247], v[80:83]
  s_add_u32 s82, s74, 4
  s_waitcnt vmcnt(12)
  v_cmp_ne_u32 vcc, s82, v27
  s_nop 0
  s_cbranch_vccnz L_slow51
L_back52:
  v_mfma_f32_16x16x32_bf16 v[84:87], a[76:79], a[244:247], v[84:87]
  buffer_load_dwordx4 a[244:247], v3, s[48:51], s18 offen offset:0 sc1
  v_mfma_f32_16x16x32_bf16 v[88:91], a[60:63], a[248:251], v[88:91]
  v_mfma_f32_16x16x32_bf16 v[92:95], a[64:67], a[248:251], v[92:95]
  v_mfma_f32_16x16x32_bf16 v[96:99], a[68:71], a[248:251], v[96:99]
  v_mfma_f32_16x16x32_bf16 v[100:103], a[72:75], a[248:251], v[100:103]
  v_mfma_f32_16x16x32_bf16 v[104:107], a[76:79], a[248:251], v[104:107]
  buffer_load_dwordx4 a[248:251], v4, s[48:51], s18 offen offset:0 sc1
  v_mfma_f32_16x16x32_bf16 v[108:111], a[60:63], a[252:255], v[108:111]
  v_mfma_f32_16x16x32_bf16 v[208:211], a[64:67], a[252:255], v[208:211]
  v_mfma_f32_16x16x32_bf16 v[212:215], a[68:71], a[252:255], v[212:215]
  buffer_load_dwordx4 v181, s[40:43], s14 offen offset:1024 lds
  v_mfma_f32_16x16x32_bf16 v[216:219], a[72:75], a[252:255], v[216:219]
  v_mfma_f32_16x16x32_bf16 v[220:223], a[76:79], a[252:255], v[220:223]
  buffer_load_dwordx4 a[252:255], v5, s[48:51], s18 offen offset:0 sc1
  v_mfma_f32_16x16x32_bf16 v[48:51], a[60:63], a[240:243], v[48:51]
  v_mfma_f32_16x16x32_bf16 v[52:55], a[64:67], a[240:243], v[52:55]
  v_mfma_f32_16x16x32_bf16 v[56:59], a[68:71], a[240:243], v[56:59]
  v_mfma_f32_16x16x32_bf16 v[60:63], a[72:75], a[240:243], v[60:63]
  v_mfma_f32_16x16x32_bf16 v[64:67], a[76:79], a[240:243], v[64:67]
  buffer_load_dwordx4 a[240:243], v2, s[48:51], s18 offen offset:0 sc1
  v_mfma_f32_16x16x32_bf16 v[68:71], a[80:83], a[196:199], v[68:71]
  v_mfma_f32_16x16x32_bf16 v[72:75], a[84:87], a[196:199], v[72:75]
  v_mfma_f32_16x16x32_bf16 v[76:79], a[88:91], a[196:199], v[76:79]
  v_mfma_f32_16x16x32_bf16 v[80:83], a[92:95], a[196:199], v[80:83]
  v_mfma_f32_16x16x32_bf16 v[84:87], a[96:99], a[196:199], v[84:87]
  buffer_load_dwordx4 v182, s[40:43], s14 offen offset:2048 lds
  buffer_load_dwordx4 a[196:199], v3, s[48:51], s18 offen offset:1024 sc1
  v_mfma_f32_16x16x32_bf16 v[88:91], a[80:83], a[200:203], v[88:91]
  v_mfma_f32_16x16x32_bf16 v[92:95], a[84:87], a[200:203], v[92:95]
  v_mfma_f32_16x16x32_bf16 v[96:99], a[88:91], a[200:203], v[96:99]
  v_mfma_f32_16x16x32_bf16 v[100:103], a[92:95], a[200:203], v[100:103]
  v_mfma_f32_16x16x32_bf16 v[104:107], a[96:99], a[200:203], v[104:107]
  buffer_load_dwordx4 a[200:203], v4, s[48:51], s18 offen offset:1024 sc1
  v_mfma_f32_16x16x32_bf16 v[108:111], a[80:83], a[204:207], v[108:111]
  v_mfma_f32_16x16x32_bf16 v[208:211], a[84:87], a[204:207], v[208:211]
  v_mfma_f32_16x16x32_bf16 v[212:215], a[88:91], a[204:207], v[212:215]
  v_mfma_f32_16x16x32_bf16 v[216:219], a[92:95], a[204:207], v[216:219]
  v_mfma_f32_16x16x32_bf16 v[220:223], a[96:99], a[204:207], v[220:223]
  buffer_load_dwordx4 a[204:207], v5, s[48:51], s18 offen offset:1024 sc1
  v_mfma_f32_16x16x32_bf16 v[48:51], a[80:83], a[192:195], v[48:51]
  v_mfma_f32_16x16x32_bf16 v[52:55], a[84:87], a[192:195], v[52:55]
  buffer_load_dwordx4 v183, s[40:43], s14 offen offset:3072 lds
  v_mfma_f32_16x16x32_bf16 v[56:59], a[88:91], a[192:195], v[56:59]
  v_mfma_f32_16x16x32_bf16 v[60:63], a[92:95], a[192:195], v[60:63]
  v_mfma_f32_16x16x32_bf16 v[64:67], a[96:99], a[192:195], v[64:67]
  buffer_load_dwordx4 a[192:195], v2, s[48:51], s18 offen offset:1024 sc1
  s_waitcnt vmcnt(21)
  v_mfma_f32_16x16x32_bf16 a[140:143], a[0:3], a[212:215], 0
  v_mfma_f32_16x16x32_bf16 a[144:147], a[4:7], a[212:215], 0
  v_mfma_f32_16x16x32_bf16 a[148:151], a[8:11], a[212:215], 0
  v_mfma_f32_16x16x32_bf16 a[152:155], a[12:15], a[212:215], 0
  v_mfma_f32_16x16x32_bf16 a[156:159], a[16:19], a[212:215], 0
  buffer_load_dwordx4 a[212:215], v186, s[48:51], s17 offen offset:2048 sc1
  s_waitcnt vmcnt(21)
  v_mfma_f32_16x16x32_bf16 a[160:163], a[0:3], a[216:219], 0
  v_mfma_f32_16x16x32_bf16 a[164:167], a[4:7], a[216:219], 0
  v_mfma_f32_16x16x32_bf16 a[168:171], a[8:11], a[216:219], 0
  s_add_u32 m0, s94, 65536
  v_mfma_f32_16x16x32_bf16 a[172:175], a[12:15], a[216:219], 0
  buffer_load_dwordx4 v184, s[40:43], s14 offen offset:0 lds
  v_mfma_f32_16x16x32_bf16 a[176:179], a[16:19], a[216:219], 0
  buffer_load_dwordx4 a[216:219], v187, s[48:51], s17 offen offset:2048 sc1
  s_waitcnt vmcnt(22)
  v_mfma_f32_16x16x32_bf16 a[180:183], a[0:3], a[220:223], 0
  v_mfma_f32_16x16x32_bf16 a[184:187], a[4:7], a[220:223], 0
  v_mfma_f32_16x16x32_bf16 a[188:191], a[8:11], a[220:223], 0
  v_mfma_f32_16x16x32_bf16 v[6:9], a[12:15], a[220:223], 0
  v_mfma_f32_16x16x32_bf16 v[10:13], a[16:19], a[220:223], 0
  buffer_load_dwordx4 a[220:223], v188, s[48:51], s17 offen offset:2048 sc1
  s_waitcnt vmcnt(21)
  v_mfma_f32_16x16x32_bf16 v[224:227], a[0:3], a[208:211], v[224:227]
  v_mfma_f32_16x16x32_bf16 v[228:231], a[4:7], a[208:211], v[228:231]
  v_mfma_f32_16x16x32_bf16 v[232:235], a[8:11], a[208:211], v[232:235]
  v_mfma_f32_16x16x32_bf16 v[236:239], a[12:15], a[208:211], v[236:239]
  v_mfma_f32_16x16x32_bf16 v[240:243], a[16:19], a[208:211], v[240:243]
  buffer_load_dwordx4 a[208:211], v185, s[48:51], s17 offen offset:2048 sc1
  s_add_u32 s14, s24, 491520
  s_add_u32 m0, s94, 0
  s_waitcnt vmcnt(21)
  v_mfma_f32_16x16x32_bf16 a[140:143], a[20:23], a[228:231], a[140:143]
  buffer_load_dwordx4 v180, s[40:43], s14 offen offset:0 lds
  v_mfma_f32_16x16x32_bf16 a[144:147], a[24:27], a[228:231], a[144:147]
  v_mfma_f32_16x16x32_bf16 a[148:151], a[28:31], a[228:231], a[148:151]
  v_mfma_f32_16x16x32_bf16 a[152:155], a[32:35], a[228:231], a[152:155]
  v_mfma_f32_16x16x32_bf16 a[156:159], a[36:39], a[228:231], a[156:159]
  buffer_load_dwordx4 a[228:231], v186, s[48:51], s17 offen offset:3072 sc1
  s_waitcnt vmcnt(21)
  v_mfma_f32_16x16x32_bf16 a[160:163], a[20:23], a[232:235], a[160:163]
  v_mfma_f32_16x16x32_bf16 a[164:167], a[24:27], a[232:235], a[164:167]
  v_mfma_f32_16x16x32_bf16 a[168:171], a[28:31], a[232:235], a[168:171]
  v_mfma_f32_16x16x32_bf16 a[172:175], a[32:35], a[232:235], a[172:175]
  v_mfma_f32_16x16x32_bf16 a[176:179], a[36:39], a[232:235], a[176:179]
  buffer_load_dwordx4 a[232:235], v187, s[48:51], s17 offen offset:3072 sc1
  s_waitcnt vmcnt(21)
  v_mfma_f32_16x16x32_bf16 a[180:183], a[20:23], a[236:239], a[180:183]
  v_mfma_f32_16x16x32_bf16 a[184:187], a[24:27], a[236:239], a[184:187]
  v_mfma_f32_16x16x32_bf16 a[188:191], a[28:31], a[236:239], a[188:191]
  buffer_load_dwordx4 v181, s[40:43], s14 offen offset:1024 lds
  v_mfma_f32_16x16x32_bf16 v[6:9], a[32:35], a[236:239], v[6:9]
  v_mfma_f32_16x16x32_bf16 v[10:13], a[36:39], a[236:239], v[10:13]
  buffer_load_dwordx4 a[236:239], v188, s[48:51], s17 offen offset:3072 sc1
  s_waitcnt vmcnt(22)
  v_mfma_f32_16x16x32_bf16 v[224:227], a[20:23], a[224:227], v[224:227]
  v_mfma_f32_16x16x32_bf16 v[228:231], a[24:27], a[224:227], v[228:231]
  v_mfma_f32_16x16x32_bf16 v[232:235], a[28:31], a[224:227], v[232:235]
  v_mfma_f32_16x16x32_bf16 v[236:239], a[32:35], a[224:227], v[236:239]
  v_mfma_f32_16x16x32_bf16 v[240:243], a[36:39], a[224:227], v[240:243]
  buffer_load_dwordx4 a[224:227], v185, s[48:51], s17 offen offset:3072 sc1
  s_waitcnt vmcnt(21)
  v_mfma_f32_16x16x32_bf16 v[68:71], a[100:103], a[244:247], v[68:71]
  v_mfma_f32_16x16x32_bf16 v[72:75], a[104:107], a[244:247], v[72:75]
  v_mfma_f32_16x16x32_bf16 v[76:79], a[108:111], a[244:247], v[76:79]
  v_mfma_f32_16x16x32_bf16 v[80:83], a[112:115], a[244:247], v[80:83]
  v_mfma_f32_16x16x32_bf16 v[84:87], a[116:119], a[244:247], v[84:87]
  buffer_load_dwordx4 v182, s[40:43], s14 offen offset:2048 lds
  buffer_load_dwordx4 a[244:247], v186, s[48:51], s19 offen offset:0 sc1
  s_waitcnt vmcnt(22)
  v_mfma_f32_16x16x32_bf16 v[88:91], a[100:103], a[248:251], v[88:91]
  v_mfma_f32_16x16x32_bf16 v[92:95], a[104:107], a[248:251], v[92:95]
  v_mfma_f32_16x16x32_bf16 v[96:99], a[108:111], a[248:251], v[96:99]
  v_mfma_f32_16x16x32_bf16 v[100:103], a[112:115], a[248:251], v[100:103]
  v_mfma_f32_16x16x32_bf16 v[104:107], a[116:119], a[248:251], v[104:107]
  buffer_load_dwordx4 a[248:251], v187, s[48:51], s19 offen offset:0 sc1
  s_waitcnt vmcnt(21)
  v_mfma_f32_16x16x32_bf16 v[108:111], a[100:103], a[252:255], v[108:111]
  v_mfma_f32_16x16x32_bf16 v[208:211], a[104:107], a[252:255], v[208:211]
  v_mfma_f32_16x16x32_bf16 v[212:215], a[108:111], a[252:255], v[212:215]
  v_mfma_f32_16x16x32_bf16 v[216:219], a[112:115], a[252:255], v[216:219]
  v_mfma_f32_16x16x32_bf16 v[220:223], a[116:119], a[252:255], v[220:223]
  buffer_load_dwordx4 a[252:255], v188, s[48:51], s19 offen offset:0 sc1
  s_waitcnt vmcnt(21)
  v_mfma_f32_16x16x32_bf16 v[48:51], a[100:103], a[240:243], v[48:51]
  v_mfma_f32_16x16x32_bf16 v[52:55], a[104:107], a[240:243], v[52:55]
  buffer_load_dwordx4 v183, s[40:43], s14 offen offset:3072 lds
  v_mfma_f32_16x16x32_bf16 v[56:59], a[108:111], a[240:243], v[56:59]
  v_mfma_f32_16x16x32_bf16 v[60:63], a[112:115], a[240:243], v[60:63]
  v_mfma_f32_16x16x32_bf16 v[64:67], a[116:119], a[240:243], v[64:67]
  buffer_load_dwordx4 a[240:243], v185, s[48:51], s19 offen offset:0 sc1
  s_waitcnt vmcnt(21)
  v_mfma_f32_16x16x32_bf16 v[68:71], a[120:123], a[196:199], v[68:71]
  v_mfma_f32_16x16x32_bf16 v[72:75], a[124:127], a[196:199], v[72:75]
  v_mfma_f32_16x16x32_bf16 v[76:79], a[128:131], a[196:199], v[76:79]
  v_mfma_f32_16x16x32_bf16 v[80:83], a[132:135], a[196:199], v[80:83]
  s_mov_b32 s82, 5406720
  buffer_load_dword v27, v205, s[48:51], s82 offen sc1
  s_waitcnt lgkmcnt(0)
  v_mfma_f32_16x16x32_bf16 v[84:87], a[136:139], a[196:199], v[84:87]
  buffer_load_dwordx4 a[196:199], v186, s[48:51], s18 offen offset:0 sc1
  s_waitcnt vmcnt(22)
  v_mfma_f32_16x16x32_bf16 v[88:91], a[120:123], a[200:203], v[88:91]
  v_mfma_f32_16x16x32_bf16 v[92:95], a[124:127], a[200:203], v[92:95]
  v_mfma_f32_16x16x32_bf16 v[96:99], a[128:131], a[200:203], v[96:99]
  s_add_u32 m0, s94, 4096
  v_mfma_f32_16x16x32_bf16 v[100:103], a[132:135], a[200:203], v[100:103]
  buffer_load_dwordx4 v184, s[40:43], s14 offen offset:0 lds
  ds_write_b128 v192, v[68:71] offset:20480
  v_mfma_f32_16x16x32_bf16 v[104:107], a[136:139], a[200:203], v[104:107]
  buffer_load_dwordx4 a[200:203], v187, s[48:51], s18 offen offset:0 sc1
  ds_write_b128 v192, v[72:75] offset:21504
  s_waitcnt vmcnt(23)
  v_mfma_f32_16x16x32_bf16 v[108:111], a[120:123], a[204:207], v[108:111]
  ds_write_b128 v192, v[76:79] offset:22528
  ds_write_b128 v192, v[80:83] offset:23552
  v_mfma_f32_16x16x32_bf16 v[208:211], a[124:127], a[204:207], v[208:211]
  ds_write_b128 v192, v[84:87] offset:24576
  v_mfma_f32_16x16x32_bf16 v[212:215], a[128:131], a[204:207], v[212:215]
  v_mfma_f32_16x16x32_bf16 v[216:219], a[132:135], a[204:207], v[216:219]
  ds_write_b128 v192, v[88:91] offset:40960
  ds_write_b128 v192, v[92:95] offset:41984
  ds_write_b128 v192, v[96:99] offset:43008
  v_mfma_f32_16x16x32_bf16 v[220:223], a[136:139], a[204:207], v[220:223]
  buffer_load_dwordx4 a[204:207], v188, s[48:51], s18 offen offset:0 sc1
  ds_write_b128 v192, v[100:103] offset:44032
  s_waitcnt vmcnt(22)
  v_mfma_f32_16x16x32_bf16 v[48:51], a[120:123], a[192:195], v[48:51]
  ds_write_b128 v192, v[104:107] offset:45056
  v_mfma_f32_16x16x32_bf16 v[52:55], a[124:127], a[192:195], v[52:55]
  v_mfma_f32_16x16x32_bf16 v[56:59], a[128:131], a[192:195], v[56:59]
  v_mfma_f32_16x16x32_bf16 v[60:63], a[132:135], a[192:195], v[60:63]
  ds_write_b128 v193, v[108:111] offset:16384
  ds_write_b128 v193, v[208:211] offset:17408
  ds_write_b128 v193, v[212:215] offset:18432
  v_mfma_f32_16x16x32_bf16 v[64:67], a[136:139], a[192:195], v[64:67]
  buffer_load_dwordx4 a[192:195], v185, s[48:51], s18 offen offset:0 sc1
  ds_write_b128 v193, v[216:219] offset:19456
  s_waitcnt vmcnt(22)
  v_mfma_f32_16x16x32_bf16 a[140:143], a[40:43], a[212:215], a[140:143]
  ds_write_b128 v193, v[220:223] offset:20480
  v_mfma_f32_16x16x32_bf16 a[144:147], a[44:47], a[212:215], a[144:147]
  v_mfma_f32_16x16x32_bf16 a[148:151], a[48:51], a[212:215], a[148:151]
  v_mfma_f32_16x16x32_bf16 a[152:155], a[52:55], a[212:215], a[152:155]
  v_mfma_f32_16x16x32_bf16 a[156:159], a[56:59], a[212:215], a[156:159]
  buffer_load_dwordx4 a[212:215], v186, s[48:51], s18 offen offset:1024 sc1
  s_waitcnt vmcnt(21)
  v_mfma_f32_16x16x32_bf16 a[160:163], a[40:43], a[216:219], a[160:163]
  v_mfma_f32_16x16x32_bf16 a[164:167], a[44:47], a[216:219], a[164:167]
  v_mfma_f32_16x16x32_bf16 a[168:171], a[48:51], a[216:219], a[168:171]
  s_waitcnt lgkmcnt(0)
  s_barrier
  v_mfma_f32_16x16x32_bf16 a[172:175], a[52:55], a[216:219], a[172:175]
  ds_read_b128 v[68:71], v194 offset:0
  ds_read_b128 v[72:75], v194 offset:1024
  ds_read_b128 v[76:79], v194 offset:2048
  v_mfma_f32_16x16x32_bf16 a[176:179], a[56:59], a[216:219], a[176:179]
  buffer_load_dwordx4 a[216:219], v187, s[48:51], s18 offen offset:1024 sc1
  ds_read_b128 v[80:83], v194 offset:3072
  s_waitcnt vmcnt(21)
  v_mfma_f32_16x16x32_bf16 a[180:183], a[40:43], a[220:223], a[180:183]
  ds_read_b128 v[84:87], v194 offset:4096
  ds_read_b128 v[88:91], v195 offset:0
  v_mfma_f32_16x16x32_bf16 a[184:187], a[44:47], a[220:223], a[184:187]
  ds_read_b128 v[92:95], v195 offset:1024
  ds_read_b128 v[96:99], v195 offset:2048
  ds_read_b128 v[100:103], v195 offset:3072
  v_mfma_f32_16x16x32_bf16 a[188:191], a[48:51], a[220:223], a[188:191]
  ds_read_b128 v[104:107], v195 offset:4096
  ds_read_b128 v[108:111], v196 offset:0
  v_mfma_f32_16x16x32_bf16 v[6:9], a[52:55], a[220:223], v[6:9]
  ds_read_b128 v[208:211], v196 offset:1024
  ds_read_b128 v[212:215], v196 offset:2048
  v_mfma_f32_16x16x32_bf16 v[10:13], a[56:59], a[220:223], v[10:13]
  buffer_load_dwordx4 a[220:223], v188, s[48:51], s18 offen offset:1024 sc1
  ds_read_b128 v[216:219], v196 offset:3072
  ds_read_b128 v[220:223], v196 offset:4096
  s_waitcnt vmcnt(21)
  v_mfma_f32_16x16x32_bf16 v[224:227], a[40:43], a[208:211], v[224:227]
  s_waitcnt lgkmcnt(14)
  v_add_f32 v48, v48, v68
  v_add_f32 v49, v49, v69
  v_mfma_f32_16x16x32_bf16 v[228:231], a[44:47], a[208:211], v[228:231]
  v_add_f32 v50, v50, v70
  v_add_f32 v51, v51, v71
  v_mfma_f32_16x16x32_bf16 v[232:235], a[48:51], a[208:211], v[232:235]
  s_waitcnt lgkmcnt(13)
  v_add_f32 v52, v52, v72
  v_add_f32 v53, v53, v73
  v_mfma_f32_16x16x32_bf16 v[236:239], a[52:55], a[208:211], v[236:239]
  v_add_f32 v54, v54, v74
  v_add_f32 v55, v55, v75
  s_waitcnt lgkmcnt(12)
  v_add_f32 v56, v56, v76
  v_mfma_f32_16x16x32_bf16 v[240:243], a[56:59], a[208:211], v[240:243]
  buffer_load_dwordx4 a[208:211], v185, s[48:51], s18 offen offset:1024 sc1
  v_add_f32 v57, v57, v77
  s_waitcnt vmcnt(20)
  v_mfma_f32_16x16x32_bf16 a[140:143], a[60:63], a[228:231], a[140:143]
  v_add_f32 v58, v58, v78
  v_add_f32 v59, v59, v79
  v_mfma_f32_16x16x32_bf16 a[144:147], a[64:67], a[228:231], a[144:147]
  s_waitcnt lgkmcnt(11)
  v_add_f32 v60, v60, v80
  v_add_f32 v61, v61, v81
  v_add_f32 v62, v62, v82
  v_mfma_f32_16x16x32_bf16 a[148:151], a[68:71], a[228:231], a[148:151]
  v_add_f32 v63, v63, v83
  s_waitcnt lgkmcnt(10)
  v_add_f32 v64, v64, v84
  v_mfma_f32_16x16x32_bf16 a[152:155], a[72:75], a[228:231], a[152:155]
  v_add_f32 v65, v65, v85
  v_add_f32 v66, v66, v86
  s_add_u32 s82, s74, 5
  s_waitcnt vmcnt(9)
  v_cmp_ne_u32 vcc, s82, v27
  s_nop 0
  s_cbranch_vccnz L_slow54
L_back55:
  s_add_u32 s15, s20, 0
  v_mfma_f32_16x16x32_bf16 a[156:159], a[76:79], a[228:231], a[156:159]
  buffer_load_dwordx4 a[228:231], v186, s[48:51], s15 offen offset:0 sc1
  v_add_f32 v67, v67, v87
  v_mfma_f32_16x16x32_bf16 a[160:163], a[60:63], a[232:235], a[160:163]
  s_waitcnt lgkmcnt(9)
  v_add_f32 v48, v48, v88
  v_add_f32 v49, v49, v89
  v_mfma_f32_16x16x32_bf16 a[164:167], a[64:67], a[232:235], a[164:167]
  v_add_f32 v50, v50, v90
  v_add_f32 v51, v51, v91
  v_mfma_f32_16x16x32_bf16 a[168:171], a[68:71], a[232:235], a[168:171]
  s_waitcnt lgkmcnt(8)
  v_add_f32 v52, v52, v92
  v_add_f32 v53, v53, v93
  v_mfma_f32_16x16x32_bf16 a[172:175], a[72:75], a[232:235], a[172:175]
  v_add_f32 v54, v54, v94
  v_add_f32 v55, v55, v95
  s_waitcnt lgkmcnt(7)
  v_add_f32 v56, v56, v96
  v_mfma_f32_16x16x32_bf16 a[176:179], a[76:79], a[232:235], a[176:179]
  buffer_load_dwordx4 a[232:235], v187, s[48:51], s15 offen offset:0 sc1
  v_add_f32 v57, v57, v97
  v_mfma_f32_16x16x32_bf16 a[180:183], a[60:63], a[236:239], a[180:183]
  v_add_f32 v58, v58, v98
  v_add_f32 v59, v59, v99
  v_mfma_f32_16x16x32_bf16 a[184:187], a[64:67], a[236:239], a[184:187]
  s_waitcnt lgkmcnt(6)
  v_add_f32 v60, v60, v100
  v_add_f32 v61, v61, v101
  v_add_f32 v62, v62, v102
  v_mfma_f32_16x16x32_bf16 a[188:191], a[68:71], a[236:239], a[188:191]
  v_add_f32 v63, v63, v103
  s_waitcnt lgkmcnt(5)
  v_add_f32 v64, v64, v104
  v_mfma_f32_16x16x32_bf16 v[6:9], a[72:75], a[236:239], v[6:9]
  v_add_f32 v65, v65, v105
  v_add_f32 v66, v66, v106
  v_mfma_f32_16x16x32_bf16 v[10:13], a[76:79], a[236:239], v[10:13]
  buffer_load_dwordx4 a[236:239], v188, s[48:51], s15 offen offset:0 sc1
  v_add_f32 v67, v67, v107
  s_waitcnt lgkmcnt(4)
  v_add_f32 v48, v48, v108
  v_mfma_f32_16x16x32_bf16 v[224:227], a[60:63], a[224:227], v[224:227]
  v_add_f32 v49, v49, v109
  v_add_f32 v50, v50, v110
  v_mfma_f32_16x16x32_bf16 v[228:231], a[64:67], a[224:227], v[228:231]
  v_add_f32 v51, v51, v111
  s_waitcnt lgkmcnt(3)
  v_add_f32 v52, v52, v208
  v_mfma_f32_16x16x32_bf16 v[232:235], a[68:71], a[224:227], v[232:235]
  v_add_f32 v53, v53, v209
  v_add_f32 v54, v54, v210
  v_mfma_f32_16x16x32_bf16 v[236:239], a[72:75], a[224:227], v[236:239]
  v_add_f32 v55, v55, v211
  s_waitcnt lgkmcnt(2)
  v_add_f32 v56, v56, v212
  v_add_f32 v57, v57, v213
  v_mfma_f32_16x16x32_bf16 v[240:243], a[76:79], a[224:227], v[240:243]
  buffer_load_dwordx4 a[224:227], v185, s[48:51], s15 offen offset:0 sc1
  v_add_f32 v58, v58, v214
  v_mfma_f32_16x16x32_bf16 a[140:143], a[80:83], a[244:247], a[140:143]
  v_add_f32 v59, v59, v215
  s_waitcnt lgkmcnt(1)
  v_add_f32 v60, v60, v216
  v_mfma_f32_16x16x32_bf16 a[144:147], a[84:87], a[244:247], a[144:147]
  v_add_f32 v61, v61, v217
  v_add_f32 v62, v62, v218
  v_add_f32 v63, v63, v219
  v_mfma_f32_16x16x32_bf16 a[148:151], a[88:91], a[244:247], a[148:151]
  s_waitcnt lgkmcnt(0)
  v_add_f32 v64, v64, v220
  v_add_f32 v65, v65, v221
  v_mfma_f32_16x16x32_bf16 a[152:155], a[92:95], a[244:247], a[152:155]
  v_add_f32 v66, v66, v222
  v_add_f32 v67, v67, v223
  s_add_u32 s15, s20, 4096
  v_mfma_f32_16x16x32_bf16 a[156:159], a[96:99], a[244:247], a[156:159]
  buffer_load_dwordx4 a[244:247], v186, s[48:51], s15 offen offset:0 sc1
  v_cvt_pk_bf16_f32 v68, v48, v49
  v_mfma_f32_16x16x32_bf16 a[160:163], a[80:83], a[248:251], a[160:163]
  v_cvt_pk_bf16_f32 v69, v50, v51
  v_cvt_pk_bf16_f32 v70, v52, v53
  v_mfma_f32_16x16x32_bf16 a[164:167], a[84:87], a[248:251], a[164:167]
  v_cvt_pk_bf16_f32 v71, v54, v55
  v_cvt_pk_bf16_f32 v72, v56, v57
  v_mfma_f32_16x16x32_bf16 a[168:171], a[88:91], a[248:251], a[168:171]
  v_cvt_pk_bf16_f32 v73, v58, v59
  v_cvt_pk_bf16_f32 v74, v60, v61
  v_mfma_f32_16x16x32_bf16 a[172:175], a[92:95], a[248:251], a[172:175]
  v_cvt_pk_bf16_f32 v75, v62, v63
  v_cvt_pk_bf16_f32 v76, v64, v65
  v_cvt_pk_bf16_f32 v77, v66, v67
  v_mfma_f32_16x16x32_bf16 a[176:179], a[96:99], a[248:251], a[176:179]
  buffer_load_dwordx4 a[248:251], v187, s[48:51], s15 offen offset:0 sc1
  buffer_store_dwordx4 v[68:71], v37, s[48:51], s16 offen offset:0 sc1
  v_mfma_f32_16x16x32_bf16 a[180:183], a[80:83], a[252:255], a[180:183]
  buffer_store_dwordx4 v[72:75], v37, s[48:51], s16 offen offset:1024 sc1
  buffer_store_dwordx4 v[76:79], v37, s[48:51], s16 offen offset:2048 sc1
  v_mfma_f32_16x16x32_bf16 a[184:187], a[84:87], a[252:255], a[184:187]
  v_mfma_f32_16x16x32_bf16 a[188:191], a[88:91], a[252:255], a[188:191]
  v_mfma_f32_16x16x32_bf16 v[6:9], a[92:95], a[252:255], v[6:9]
  v_mfma_f32_16x16x32_bf16 v[10:13], a[96:99], a[252:255], v[10:13]
  buffer_load_dwordx4 a[252:255], v188, s[48:51], s15 offen offset:0 sc1
  v_mfma_f32_16x16x32_bf16 v[224:227], a[80:83], a[240:243], v[224:227]
  v_add_u32 v194, 81920, v194
  v_add_u32 v195, 20480, v195
  v_mfma_f32_16x16x32_bf16 v[228:231], a[84:87], a[240:243], v[228:231]
  v_add_u32 v196, 4294885376, v196
  v_mfma_f32_16x16x32_bf16 v[232:235], a[88:91], a[240:243], v[232:235]
  v_mfma_f32_16x16x32_bf16 v[236:239], a[92:95], a[240:243], v[236:239]
  v_mfma_f32_16x16x32_bf16 v[240:243], a[96:99], a[240:243], v[240:243]
  buffer_load_dwordx4 a[240:243], v185, s[48:51], s15 offen offset:0 sc1
  s_waitcnt vmcnt(19)
  v_mfma_f32_16x16x32_bf16 a[140:143], a[100:103], a[196:199], a[140:143]
  v_mfma_f32_16x16x32_bf16 a[144:147], a[104:107], a[196:199], a[144:147]
  v_mfma_f32_16x16x32_bf16 a[148:151], a[108:111], a[196:199], a[148:151]
  v_mfma_f32_16x16x32_bf16 a[152:155], a[112:115], a[196:199], a[152:155]
  s_add_u32 s15, s20, 8192
  v_mfma_f32_16x16x32_bf16 a[156:159], a[116:119], a[196:199], a[156:159]
  buffer_load_dwordx4 a[196:199], v186, s[48:51], s15 offen offset:0 sc1
  s_waitcnt vmcnt(18)
  v_mfma_f32_16x16x32_bf16 a[160:163], a[100:103], a[200:203], a[160:163]
  v_mfma_f32_16x16x32_bf16 a[164:167], a[104:107], a[200:203], a[164:167]
  v_mfma_f32_16x16x32_bf16 a[168:171], a[108:111], a[200:203], a[168:171]
  v_mfma_f32_16x16x32_bf16 a[172:175], a[112:115], a[200:203], a[172:175]
  v_mfma_f32_16x16x32_bf16 a[176:179], a[116:119], a[200:203], a[176:179]
  buffer_load_dwordx4 a[200:203], v187, s[48:51], s15 offen offset:0 sc1
  s_waitcnt vmcnt(18)
  v_mfma_f32_16x16x32_bf16 a[180:183], a[100:103], a[204:207], a[180:183]
  v_mfma_f32_16x16x32_bf16 a[184:187], a[104:107], a[204:207], a[184:187]
  v_mfma_f32_16x16x32_bf16 a[188:191], a[108:111], a[204:207], a[188:191]
  v_mfma_f32_16x16x32_bf16 v[6:9], a[112:115], a[204:207], v[6:9]
  v_mfma_f32_16x16x32_bf16 v[10:13], a[116:119], a[204:207], v[10:13]
  buffer_load_dwordx4 a[204:207], v188, s[48:51], s15 offen offset:0 sc1
  s_waitcnt vmcnt(18)
  v_mfma_f32_16x16x32_bf16 v[224:227], a[100:103], a[192:195], v[224:227]
  v_mfma_f32_16x16x32_bf16 v[228:231], a[104:107], a[192:195], v[228:231]
  v_mfma_f32_16x16x32_bf16 v[232:235], a[108:111], a[192:195], v[232:235]
  v_mfma_f32_16x16x32_bf16 v[236:239], a[112:115], a[192:195], v[236:239]
  v_mfma_f32_16x16x32_bf16 v[240:243], a[116:119], a[192:195], v[240:243]
  buffer_load_dwordx4 a[192:195], v185, s[48:51], s15 offen offset:0 sc1
  s_waitcnt vmcnt(18)
  v_mfma_f32_16x16x32_bf16 a[140:143], a[120:123], a[212:215], a[140:143]
  ds_read_b64_tr_b16 v[112:113], v191 offset:12288
  v_mfma_f32_16x16x32_bf16 a[144:147], a[124:127], a[212:215], a[144:147]
  v_mfma_f32_16x16x32_bf16 a[148:151], a[128:131], a[212:215], a[148:151]
  ds_read_b64_tr_b16 v[114:115], v191 offset:13568
  v_mfma_f32_16x16x32_bf16 a[152:155], a[132:135], a[212:215], a[152:155]
  s_add_u32 s15, s20, 12288
  v_mfma_f32_16x16x32_bf16 a[156:159], a[136:139], a[212:215], a[156:159]
  buffer_load_dwordx4 a[212:215], v186, s[48:51], s15 offen offset:0 sc1
  ds_read_b64_tr_b16 v[116:117], v191 offset:12320
  s_waitcnt vmcnt(18)
  v_mfma_f32_16x16x32_bf16 a[160:163], a[120:123], a[216:219], a[160:163]
  v_mfma_f32_16x16x32_bf16 a[164:167], a[124:127], a[216:219], a[164:167]
  ds_read_b64_tr_b16 v[118:119], v191 offset:13600
  v_mfma_f32_16x16x32_bf16 a[168:171], a[128:131], a[216:219], a[168:171]
  v_mfma_f32_16x16x32_bf16 a[172:175], a[132:135], a[216:219], a[172:175]
  ds_read_b64_tr_b16 v[120:121], v191 offset:12352
  v_mfma_f32_16x16x32_bf16 a[176:179], a[136:139], a[216:219], a[176:179]
  buffer_load_dwordx4 a[216:219], v187, s[48:51], s15 offen offset:0 sc1
  s_waitcnt vmcnt(18)
  v_mfma_f32_16x16x32_bf16 a[180:183], a[120:123], a[220:223], a[180:183]
  ds_read_b64_tr_b16 v[122:123], v191 offset:13632
  v_mfma_f32_16x16x32_bf16 a[184:187], a[124:127], a[220:223], a[184:187]
  v_mfma_f32_16x16x32_bf16 a[188:191], a[128:131], a[220:223], a[188:191]
  ds_read_b64_tr_b16 v[124:125], v191 offset:12384
  v_mfma_f32_16x16x32_bf16 v[6:9], a[132:135], a[220:223], v[6:9]
  v_mfma_f32_16x16x32_bf16 v[10:13], a[136:139], a[220:223], v[10:13]
  buffer_load_dwordx4 a[220:223], v188, s[48:51], s15 offen offset:0 sc1
  ds_read_b64_tr_b16 v[126:127], v191 offset:13664
  s_waitcnt vmcnt(18)
  v_mfma_f32_16x16x32_bf16 v[224:227], a[120:123], a[208:211], v[224:227]
  v_mfma_f32_16x16x32_bf16 v[228:231], a[124:127], a[208:211], v[228:231]
  ds_read_b64_tr_b16 v[128:129], v191 offset:12416
  v_mfma_f32_16x16x32_bf16 v[232:235], a[128:131], a[208:211], v[232:235]
  v_mfma_f32_16x16x32_bf16 v[236:239], a[132:135], a[208:211], v[236:239]
  ds_read_b64_tr_b16 v[130:131], v191 offset:13696
  v_mfma_f32_16x16x32_bf16 v[240:243], a[136:139], a[208:211], v[240:243]
  buffer_load_dwordx4 a[208:211], v185, s[48:51], s15 offen offset:0 sc1
  s_waitcnt vmcnt(18) lgkmcnt(8)
  v_mfma_f32_16x16x32_bf16 a[140:143], v[112:115], a[228:231], a[140:143]
  ds_read_b64_tr_b16 v[132:133], v190 offset:36864
  s_add_u32 s14, s24, 655360
  s_add_u32 m0, s94, 143360
  s_waitcnt lgkmcnt(7)
  v_mfma_f32_16x16x32_bf16 a[144:147], v[116:119], a[228:231], a[144:147]
  s_waitcnt lgkmcnt(1)
  buffer_load_dwordx4 v180, s[40:43], s14 offen offset:0 lds
  v_mfma_f32_16x16x32_bf16 a[148:151], v[120:123], a[228:231], a[148:151]
  ds_read_b64_tr_b16 v[134:135], v190 offset:38144
  v_mfma_f32_16x16x32_bf16 a[152:155], v[124:127], a[228:231], a[152:155]
  s_add_u32 s15, s20, 16384
  v_mfma_f32_16x16x32_bf16 a[156:159], v[128:131], a[228:231], a[156:159]
  buffer_load_dwordx4 a[228:231], v186, s[48:51], s15 offen offset:0 sc1
  buffer_load_dwordx4 v181, s[40:43], s14 offen offset:1024 lds
  ds_read_b64_tr_b16 v[136:137], v190 offset:36896
  s_waitcnt vmcnt(20)
  v_mfma_f32_16x16x32_bf16 a[160:163], v[112:115], a[232:235], a[160:163]
  v_mfma_f32_16x16x32_bf16 a[164:167], v[116:119], a[232:235], a[164:167]
  ds_read_b64_tr_b16 v[138:139], v190 offset:38176
  s_add_u32 s82, s74, 6
  v_mov_b32 v26, s82
  s_mov_b32 s82, 5439488
  s_waitcnt vmcnt(13)
  buffer_store_dword v26, v16, s[48:51], s82 offen sc1
  v_mfma_f32_16x16x32_bf16 a[168:171], v[120:123], a[232:235], a[168:171]
  v_mfma_f32_16x16x32_bf16 a[172:175], v[124:127], a[232:235], a[172:175]
  buffer_load_dwordx4 v182, s[40:43], s14 offen offset:2048 lds
  ds_read_b64_tr_b16 v[140:141], v190 offset:36928
  v_mfma_f32_16x16x32_bf16 a[176:179], v[128:131], a[232:235], a[176:179]
  buffer_load_dwordx4 a[232:235], v187, s[48:51], s15 offen offset:0 sc1
  v_mfma_f32_16x16x32_bf16 a[180:183], v[112:115], a[236:239], a[180:183]
  ds_read_b64_tr_b16 v[142:143], v190 offset:38208
  v_mfma_f32_16x16x32_bf16 a[184:187], v[116:119], a[236:239], a[184:187]
  v_mfma_f32_16x16x32_bf16 a[188:191], v[120:123], a[236:239], a[188:191]
  buffer_load_dwordx4 v183, s[40:43], s14 offen offset:3072 lds
  ds_read_b64_tr_b16 v[144:145], v190 offset:36960
  v_mfma_f32_16x16x32_bf16 v[6:9], v[124:127], a[236:239], v[6:9]
  v_mfma_f32_16x16x32_bf16 v[10:13], v[128:131], a[236:239], v[10:13]
  buffer_load_dwordx4 a[236:239], v188, s[48:51], s15 offen offset:0 sc1
  ds_read_b64_tr_b16 v[146:147], v190 offset:38240
  v_mfma_f32_16x16x32_bf16 v[224:227], v[112:115], a[224:227], v[224:227]
  s_add_u32 m0, s94, 147456
  v_mfma_f32_16x16x32_bf16 v[228:231], v[116:119], a[224:227], v[228:231]
  buffer_load_dwordx4 v184, s[40:43], s14 offen offset:0 lds
  ds_read_b64_tr_b16 v[148:149], v190 offset:36992
  v_mfma_f32_16x16x32_bf16 v[232:235], v[120:123], a[224:227], v[232:235]
  v_mfma_f32_16x16x32_bf16 v[236:239], v[124:127], a[224:227], v[236:239]
  ds_read_b64_tr_b16 v[150:151], v190 offset:38272
  v_mfma_f32_16x16x32_bf16 v[240:243], v[128:131], a[224:227], v[240:243]
  buffer_load_dwordx4 a[224:227], v185, s[48:51], s15 offen offset:0 sc1
  s_waitcnt lgkmcnt(8)
  v_mfma_f32_16x16x32_bf16 a[140:143], v[132:135], a[244:247], a[140:143]
  ds_read_b64_tr_b16 v[112:113], v189 offset:61440
  buffer_load_dwordx4 v[152:155], v180, s[28:31], s12 offen offset:0
  s_waitcnt lgkmcnt(7)
  v_mfma_f32_16x16x32_bf16 a[144:147], v[136:139], a[244:247], a[144:147]
  s_waitcnt lgkmcnt(5)
  v_mfma_f32_16x16x32_bf16 a[148:151], v[140:143], a[244:247], a[148:151]
  ds_read_b64_tr_b16 v[114:115], v189 offset:62720
  s_waitcnt lgkmcnt(4)
  v_mfma_f32_16x16x32_bf16 a[152:155], v[144:147], a[244:247], a[152:155]
  buffer_load_dwordx4 v[156:159], v181, s[28:31], s12 offen offset:1024
  s_waitcnt lgkmcnt(2)
  v_mfma_f32_16x16x32_bf16 a[156:159], v[148:151], a[244:247], a[156:159]
  ds_read_b64_tr_b16 v[116:117], v189 offset:61472
  v_mfma_f32_16x16x32_bf16 a[160:163], v[132:135], a[248:251], a[160:163]
  v_mfma_f32_16x16x32_bf16 a[164:167], v[136:139], a[248:251], a[164:167]
  ds_read_b64_tr_b16 v[118:119], v189 offset:62752
  buffer_load_dwordx4 v[160:163], v197, s[28:31], s12 offen offset:2048
  v_mfma_f32_16x16x32_bf16 a[168:171], v[140:143], a[248:251], a[168:171]
  v_mfma_f32_16x16x32_bf16 a[172:175], v[144:147], a[248:251], a[172:175]
  ds_read_b64_tr_b16 v[120:121], v189 offset:61504
  v_mfma_f32_16x16x32_bf16 a[176:179], v[148:151], a[248:251], a[176:179]
  s_waitcnt vmcnt(22)
  v_mfma_f32_16x16x32_bf16 a[180:183], v[132:135], a[252:255], a[180:183]
  ds_read_b64_tr_b16 v[122:123], v189 offset:62784
  v_mfma_f32_16x16x32_bf16 a[184:187], v[136:139], a[252:255], a[184:187]
  v_mfma_f32_16x16x32_bf16 a[188:191], v[140:143], a[252:255], a[188:191]
  ds_read_b64_tr_b16 v[124:125], v189 offset:61536
  v_mfma_f32_16x16x32_bf16 v[6:9], v[144:147], a[252:255], v[6:9]
  v_mfma_f32_16x16x32_bf16 v[10:13], v[148:151], a[252:255], v[10:13]
  ds_read_b64_tr_b16 v[126:127], v189 offset:62816
  s_waitcnt vmcnt(21)
  v_mfma_f32_16x16x32_bf16 v[224:227], v[132:135], a[240:243], v[224:227]
  v_mfma_f32_16x16x32_bf16 v[228:231], v[136:139], a[240:243], v[228:231]
  ds_read_b64_tr_b16 v[128:129], v189 offset:61568
  v_mfma_f32_16x16x32_bf16 v[232:235], v[140:143], a[240:243], v[232:235]
  v_mfma_f32_16x16x32_bf16 v[236:239], v[144:147], a[240:243], v[236:239]
  ds_read_b64_tr_b16 v[130:131], v189 offset:62848
  v_mfma_f32_16x16x32_bf16 v[240:243], v[148:151], a[240:243], v[240:243]
  s_waitcnt vmcnt(20) lgkmcnt(8)
  v_mfma_f32_16x16x32_bf16 a[140:143], v[112:115], a[196:199], a[140:143]
  ds_read_b64_tr_b16 v[132:133], v189 offset:0
  s_waitcnt lgkmcnt(7)
  v_mfma_f32_16x16x32_bf16 a[144:147], v[116:119], a[196:199], a[144:147]
  s_waitcnt lgkmcnt(5)
  v_mfma_f32_16x16x32_bf16 a[148:151], v[120:123], a[196:199], a[148:151]
  ds_read_b64_tr_b16 v[134:135], v189 offset:1280
  s_waitcnt lgkmcnt(4)
  v_mfma_f32_16x16x32_bf16 a[152:155], v[124:127], a[196:199], a[152:155]
  s_waitcnt lgkmcnt(2)
  v_mfma_f32_16x16x32_bf16 a[156:159], v[128:131], a[196:199], a[156:159]
  ds_read_b64_tr_b16 v[136:137], v189 offset:32
  s_waitcnt vmcnt(19)
  v_mfma_f32_16x16x32_bf16 a[160:163], v[112:115], a[200:203], a[160:163]
  v_mfma_f32_16x16x32_bf16 a[164:167], v[116:119], a[200:203], a[164:167]
  ds_read_b64_tr_b16 v[138:139], v189 offset:1312
  v_mfma_f32_16x16x32_bf16 a[168:171], v[120:123], a[200:203], a[168:171]
  v_mfma_f32_16x16x32_bf16 a[172:175], v[124:127], a[200:203], a[172:175]
  ds_read_b64_tr_b16 v[140:141], v189 offset:64
  v_mfma_f32_16x16x32_bf16 a[176:179], v[128:131], a[200:203], a[176:179]
  s_waitcnt vmcnt(18)
  v_mfma_f32_16x16x32_bf16 a[180:183], v[112:115], a[204:207], a[180:183]
  ds_read_b64_tr_b16 v[142:143], v189 offset:1344
  v_mfma_f32_16x16x32_bf16 a[184:187], v[116:119], a[204:207], a[184:187]
  v_mfma_f32_16x16x32_bf16 a[188:191], v[120:123], a[204:207], a[188:191]
  ds_read_b64_tr_b16 v[144:145], v189 offset:96
  v_mfma_f32_16x16x32_bf16 v[6:9], v[124:127], a[204:207], v[6:9]
  v_mfma_f32_16x16x32_bf16 v[10:13], v[128:131], a[204:207], v[10:13]
  ds_read_b64_tr_b16 v[146:147], v189 offset:1376
  s_waitcnt vmcnt(17)
  v_mfma_f32_16x16x32_bf16 v[224:227], v[112:115], a[192:195], v[224:227]
  v_mfma_f32_16x16x32_bf16 v[228:231], v[116:119], a[192:195], v[228:231]
  ds_read_b64_tr_b16 v[148:149], v189 offset:128
  v_mfma_f32_16x16x32_bf16 v[232:235], v[120:123], a[192:195], v[232:235]
  v_mfma_f32_16x16x32_bf16 v[236:239], v[124:127], a[192:195], v[236:239]
  ds_read_b64_tr_b16 v[150:151], v189 offset:1408
  v_mfma_f32_16x16x32_bf16 v[240:243], v[128:131], a[192:195], v[240:243]
  s_waitcnt vmcnt(16) lgkmcnt(8)
  v_mfma_f32_16x16x32_bf16 a[140:143], v[132:135], a[212:215], a[140:143]
  s_waitcnt vmcnt(4)
  ds_read_b64_tr_b16 v[112:113], v191 offset:12288
  s_waitcnt lgkmcnt(7)
  v_mfma_f32_16x16x32_bf16 a[144:147], v[136:139], a[212:215], a[144:147]
  s_waitcnt lgkmcnt(5)
  v_mfma_f32_16x16x32_bf16 a[148:151], v[140:143], a[212:215], a[148:151]
  ds_read_b64_tr_b16 v[114:115], v191 offset:13568
  s_waitcnt lgkmcnt(4)
  v_mfma_f32_16x16x32_bf16 a[152:155], v[144:147], a[212:215], a[152:155]
  s_waitcnt lgkmcnt(2)
  v_mfma_f32_16x16x32_bf16 a[156:159], v[148:151], a[212:215], a[156:159]
  ds_read_b64_tr_b16 v[116:117], v191 offset:12320
  v_mfma_f32_16x16x32_bf16 a[160:163], v[132:135], a[216:219], a[160:163]
  v_mfma_f32_16x16x32_bf16 a[164:167], v[136:139], a[216:219], a[164:167]
  ds_read_b64_tr_b16 v[118:119], v191 offset:13600
  v_mfma_f32_16x16x32_bf16 a[168:171], v[140:143], a[216:219], a[168:171]
  v_mfma_f32_16x16x32_bf16 a[172:175], v[144:147], a[216:219], a[172:175]
  ds_read_b64_tr_b16 v[120:121], v191 offset:12352
  v_mfma_f32_16x16x32_bf16 a[176:179], v[148:151], a[216:219], a[176:179]
  s_mov_b32 s82, 5439488
  buffer_load_dword v27, v35, s[48:51], s82 offen sc1
  v_mfma_f32_16x16x32_bf16 a[180:183], v[132:135], a[220:223], a[180:183]
  ds_read_b64_tr_b16 v[122:123], v191 offset:13632
  v_mfma_f32_16x16x32_bf16 a[184:187], v[136:139], a[220:223], a[184:187]
  v_mfma_f32_16x16x32_bf16 a[188:191], v[140:143], a[220:223], a[188:191]
  ds_read_b64_tr_b16 v[124:125], v191 offset:12384
  v_mfma_f32_16x16x32_bf16 v[6:9], v[144:147], a[220:223], v[6:9]
  v_mfma_f32_16x16x32_bf16 v[10:13], v[148:151], a[220:223], v[10:13]
  ds_read_b64_tr_b16 v[126:127], v191 offset:13664
  v_mfma_f32_16x16x32_bf16 v[224:227], v[132:135], a[208:211], v[224:227]
  v_mfma_f32_16x16x32_bf16 v[228:231], v[136:139], a[208:211], v[228:231]
  ds_read_b64_tr_b16 v[128:129], v191 offset:12416
  v_mfma_f32_16x16x32_bf16 v[232:235], v[140:143], a[208:211], v[232:235]
  v_mfma_f32_16x16x32_bf16 v[236:239], v[144:147], a[208:211], v[236:239]
  ds_read_b64_tr_b16 v[130:131], v191 offset:13696
  v_mfma_f32_16x16x32_bf16 v[240:243], v[148:151], a[208:211], v[240:243]
  s_waitcnt lgkmcnt(8)
  v_mfma_f32_16x16x32_bf16 a[140:143], v[112:115], a[228:231], a[140:143]
  s_waitcnt lgkmcnt(6)
  v_mfma_f32_16x16x32_bf16 a[144:147], v[116:119], a[228:231], a[144:147]
  s_waitcnt lgkmcnt(4)
  v_mfma_f32_16x16x32_bf16 a[148:151], v[120:123], a[228:231], a[148:151]
  s_waitcnt lgkmcnt(2)
  v_mfma_f32_16x16x32_bf16 a[152:155], v[124:127], a[228:231], a[152:155]
  s_waitcnt lgkmcnt(0)
  v_mfma_f32_16x16x32_bf16 a[156:159], v[128:131], a[228:231], a[156:159]
  v_mfma_f32_16x16x32_bf16 a[160:163], v[112:115], a[232:235], a[160:163]
  v_mfma_f32_16x16x32_bf16 a[164:167], v[116:119], a[232:235], a[164:167]
  v_mfma_f32_16x16x32_bf16 a[168:171], v[120:123], a[232:235], a[168:171]
  v_mfma_f32_16x16x32_bf16 a[172:175], v[124:127], a[232:235], a[172:175]
  ds_write_b128 v193, a[140:143] offset:36864
  ds_write_b128 v193, a[144:147] offset:37888
  ds_write_b128 v193, a[148:151] offset:38912
  v_mfma_f32_16x16x32_bf16 a[176:179], v[128:131], a[232:235], a[176:179]
  ds_write_b128 v193, a[152:155] offset:39936
  ds_write_b128 v193, a[156:159] offset:40960
  v_mfma_f32_16x16x32_bf16 a[180:183], v[112:115], a[236:239], a[180:183]
  v_mfma_f32_16x16x32_bf16 a[184:187], v[116:119], a[236:239], a[184:187]
  v_mfma_f32_16x16x32_bf16 a[188:191], v[120:123], a[236:239], a[188:191]
  v_mfma_f32_16x16x32_bf16 v[6:9], v[124:127], a[236:239], v[6:9]
  ds_write_b128 v192, a[160:163] offset:61440
  ds_write_b128 v192, a[164:167] offset:62464
  ds_write_b128 v192, a[168:171] offset:63488
  v_mfma_f32_16x16x32_bf16 v[10:13], v[128:131], a[236:239], v[10:13]
  s_add_u32 s82, s74, 6
  s_waitcnt vmcnt(0)
  v_cmp_ne_u32 vcc, s82, v27
  s_nop 0
  s_cbranch_vccnz L_slow57
L_back58:
  s_xor_b32 s79, s2, 2
  s_sub_u32 s79, s79, s2
  s_mul_i32 s79, s79, 12288
  s_add_u32 s16, s16, s79
  buffer_load_dwordx4 v[164:167], v37, s[48:51], s16 offen offset:0 sc1
  buffer_load_dwordx4 v[168:171], v37, s[48:51], s16 offen offset:1024 sc1
  buffer_load_dwordx4 v[172:175], v37, s[48:51], s16 offen offset:2048 sc1
  ds_write_b128 v192, a[172:175] offset:64512
  ds_write_b128 v193, a[176:179] offset:0
  v_mfma_f32_16x16x32_bf16 v[224:227], v[112:115], a[224:227], v[224:227]
  v_mfma_f32_16x16x32_bf16 v[228:231], v[116:119], a[224:227], v[228:231]
  v_mfma_f32_16x16x32_bf16 v[232:235], v[120:123], a[224:227], v[232:235]
  v_mfma_f32_16x16x32_bf16 v[236:239], v[124:127], a[224:227], v[236:239]
  ds_write_b128 v192, a[180:183] offset:0
  ds_write_b128 v192, a[184:187] offset:1024
  ds_write_b128 v192, a[188:191] offset:2048
  v_mfma_f32_16x16x32_bf16 v[240:243], v[128:131], a[224:227], v[240:243]
  ds_write_b128 v192, v[6:9] offset:3072
  ds_write_b128 v192, v[10:13] offset:4096
  s_waitcnt lgkmcnt(0)
  s_barrier
  ds_read_b128 v[68:71], v194 offset:0
  ds_read_b128 v[72:75], v194 offset:1024
  ds_read_b128 v[76:79], v194 offset:2048
  ds_read_b128 v[80:83], v194 offset:3072
  ds_read_b128 v[84:87], v194 offset:4096
  ds_read_b128 v[88:91], v195 offset:0
  ds_read_b128 v[92:95], v195 offset:1024
  ds_read_b128 v[96:99], v195 offset:2048
  ds_read_b128 v[100:103], v195 offset:3072
  ds_read_b128 v[104:107], v195 offset:4096
  ds_read_b128 v[108:111], v196 offset:0
  ds_read_b128 v[208:211], v196 offset:1024
  ds_read_b128 v[212:215], v196 offset:2048
  ds_read_b128 v[216:219], v196 offset:3072
  ds_read_b128 v[220:223], v196 offset:4096
  s_waitcnt vmcnt(2)
  v_dot2_f32_bf16 v224, v164, s88, v224
  v_dot2_f32_bf16 v225, v164, s89, v225
  v_dot2_f32_bf16 v226, v165, s88, v226
  v_dot2_f32_bf16 v227, v165, s89, v227
  v_dot2_f32_bf16 v228, v166, s88, v228
  v_dot2_f32_bf16 v229, v166, s89, v229
  v_dot2_f32_bf16 v230, v167, s88, v230
  v_dot2_f32_bf16 v231, v167, s89, v231
  s_waitcnt vmcnt(1)
  v_dot2_f32_bf16 v232, v168, s88, v232
  v_dot2_f32_bf16 v233, v168, s89, v233
  v_dot2_f32_bf16 v234, v169, s88, v234
  v_dot2_f32_bf16 v235, v169, s89, v235
  v_dot2_f32_bf16 v236, v170, s88, v236
  v_dot2_f32_bf16 v237, v170, s89, v237
  v_dot2_f32_bf16 v238, v171, s88, v238
  v_dot2_f32_bf16 v239, v171, s89, v239
  s_waitcnt vmcnt(0)
  v_dot2_f32_bf16 v240, v172, s88, v240
  v_dot2_f32_bf16 v241, v172, s89, v241
  v_dot2_f32_bf16 v242, v173, s88, v242
  v_dot2_f32_bf16 v243, v173, s89, v243
  s_waitcnt lgkmcnt(14)
  v_pk_add_f32 v[224:225], v[224:225], v[68:69]
  v_pk_add_f32 v[226:227], v[226:227], v[70:71]
  s_waitcnt lgkmcnt(13)
  v_pk_add_f32 v[228:229], v[228:229], v[72:73]
  v_pk_add_f32 v[230:231], v[230:231], v[74:75]
  s_waitcnt lgkmcnt(12)
  v_pk_add_f32 v[232:233], v[232:233], v[76:77]
  v_pk_add_f32 v[234:235], v[234:235], v[78:79]
  s_waitcnt lgkmcnt(11)
  v_pk_add_f32 v[236:237], v[236:237], v[80:81]
  v_pk_add_f32 v[238:239], v[238:239], v[82:83]
  s_waitcnt lgkmcnt(10)
  v_pk_add_f32 v[240:241], v[240:241], v[84:85]
  v_pk_add_f32 v[242:243], v[242:243], v[86:87]
  s_waitcnt lgkmcnt(9)
  v_pk_add_f32 v[224:225], v[224:225], v[88:89]
  v_pk_add_f32 v[226:227], v[226:227], v[90:91]
  s_waitcnt lgkmcnt(8)
  v_pk_add_f32 v[228:229], v[228:229], v[92:93]
  v_pk_add_f32 v[230:231], v[230:231], v[94:95]
  s_waitcnt lgkmcnt(7)
  v_pk_add_f32 v[232:233], v[232:233], v[96:97]
  v_pk_add_f32 v[234:235], v[234:235], v[98:99]
  s_waitcnt lgkmcnt(6)
  v_pk_add_f32 v[236:237], v[236:237], v[100:101]
  v_pk_add_f32 v[238:239], v[238:239], v[102:103]
  s_waitcnt lgkmcnt(5)
  v_pk_add_f32 v[240:241], v[240:241], v[104:105]
  v_pk_add_f32 v[242:243], v[242:243], v[106:107]
  s_waitcnt lgkmcnt(4)
  v_pk_add_f32 v[224:225], v[224:225], v[108:109]
  v_pk_add_f32 v[226:227], v[226:227], v[110:111]
  s_waitcnt lgkmcnt(3)
  v_pk_add_f32 v[228:229], v[228:229], v[208:209]
  v_pk_add_f32 v[230:231], v[230:231], v[210:211]
  s_waitcnt lgkmcnt(2)
  v_pk_add_f32 v[232:233], v[232:233], v[212:213]
  v_pk_add_f32 v[234:235], v[234:235], v[214:215]
  s_waitcnt lgkmcnt(1)
  v_pk_add_f32 v[236:237], v[236:237], v[216:217]
  v_pk_add_f32 v[238:239], v[238:239], v[218:219]
  s_waitcnt lgkmcnt(0)
  v_pk_add_f32 v[240:241], v[240:241], v[220:221]
  v_pk_add_f32 v[242:243], v[242:243], v[222:223]
  ds_write_b128 v198, v[224:227] offset:0
  ds_write_b128 v198, v[228:231] offset:64
  ds_write_b128 v198, v[232:235] offset:128
  ds_write_b128 v198, v[236:239] offset:192
  ds_write_b128 v198, v[240:243] offset:256
  ds_read_b128 v[48:51], v202 offset:0
  ds_read_b128 v[52:55], v202 offset:16
  ds_read_b128 v[56:59], v203 offset:2048
  ds_read_b128 v[60:63], v203 offset:2064
  ds_read_b128 v[64:67], v204 offset:4096
  ds_read_b128 v[68:71], v204 offset:4112
  s_waitcnt lgkmcnt(5)
  v_dot2_f32_bf16 v48, v152, s88, v48
  v_dot2_f32_bf16 v49, v152, s89, v49
  v_dot2_f32_bf16 v50, v153, s88, v50
  v_dot2_f32_bf16 v51, v153, s89, v51
  s_waitcnt lgkmcnt(4)
  v_dot2_f32_bf16 v52, v154, s88, v52
  v_dot2_f32_bf16 v53, v154, s89, v53
  v_dot2_f32_bf16 v54, v155, s88, v54
  v_dot2_f32_bf16 v55, v155, s89, v55
  s_waitcnt lgkmcnt(3)
  v_dot2_f32_bf16 v56, v156, s88, v56
  v_dot2_f32_bf16 v57, v156, s89, v57
  v_dot2_f32_bf16 v58, v157, s88, v58
  v_dot2_f32_bf16 v59, v157, s89, v59
  s_waitcnt lgkmcnt(2)
  v_dot2_f32_bf16 v60, v158, s88, v60
  v_dot2_f32_bf16 v61, v158, s89, v61
  v_dot2_f32_bf16 v62, v159, s88, v62
  v_dot2_f32_bf16 v63, v159, s89, v63
  v_cvt_pk_bf16_f32 v48, v48, v49
  v_cvt_pk_bf16_f32 v49, v50, v51
  v_cvt_pk_bf16_f32 v50, v52, v53
  v_cvt_pk_bf16_f32 v51, v54, v55
  buffer_store_dwordx4 v[48:51], v180, s[52:55], s12 offen offset:0
  s_waitcnt lgkmcnt(1)
  v_dot2_f32_bf16 v64, v160, s88, v64
  v_dot2_f32_bf16 v65, v160, s89, v65
  v_dot2_f32_bf16 v66, v161, s88, v66
  v_dot2_f32_bf16 v67, v161, s89, v67
  s_waitcnt lgkmcnt(0)
  v_dot2_f32_bf16 v68, v162, s88, v68
  v_dot2_f32_bf16 v69, v162, s89, v69
  v_dot2_f32_bf16 v70, v163, s88, v70
  v_dot2_f32_bf16 v71, v163, s89, v71
  v_cvt_pk_bf16_f32 v56, v56, v57
  v_cvt_pk_bf16_f32 v57, v58, v59
  v_cvt_pk_bf16_f32 v58, v60, v61
  v_cvt_pk_bf16_f32 v59, v62, v63
  buffer_store_dwordx4 v[56:59], v181, s[52:55], s12 offen offset:1024
  s_nop 1
  v_cvt_pk_bf16_f32 v64, v64, v65
  v_cvt_pk_bf16_f32 v65, v66, v67
  v_cvt_pk_bf16_f32 v66, v68, v69
  v_cvt_pk_bf16_f32 v67, v70, v71
  buffer_store_dwordx4 v[64:67], v197, s[52:55], s12 offen offset:2048
  s_endpgm
L_end:
  s_endpgm
L_nslow6:
  s_mov_b32 s87, 20000
L_nloop8:
  s_sleep 4
  v_mov_b32 v45, 0
  buffer_load_dword v45, v45, s[64:67], 0 offen sc1
  s_waitcnt vmcnt(0)
  v_readfirstlane_b32 s74, v45
  s_nop 0
  s_cmp_lg_u32 s74, 0
  s_cbranch_scc1 L_nback7
  s_sub_u32 s87, s87, 1
  s_cmp_lg_u32 s87, 0
  s_cbranch_scc1 L_nloop8
  s_branch L_nback7
L_slow10:
  s_mov_b32 s87, 20000
L_loop12:
  s_sleep 4
  s_mov_b32 s82, 5275648
  buffer_load_dword v27, v17, s[48:51], s82 offen sc1
  s_waitcnt vmcnt(0)
  s_add_u32 s82, s74, 1
  v_cmp_ne_u32 vcc, s82, v27
  s_nop 0
  s_cbranch_vccz L_back11
  s_sub_u32 s87, s87, 1
  s_cmp_lg_u32 s87, 0
  s_cbranch_scc1 L_loop12
  s_branch L_back11
L_slow13:
  s_mov_b32 s87, 20000
L_loop15:
  s_sleep 4
  s_mov_b32 s82, 5275648
  buffer_load_dword v45, v18, s[48:51], s82 offen sc1
  s_waitcnt vmcnt(0)
  s_add_u32 s82, s74, 1
  v_cmp_ne_u32 vcc, s82, v45
  s_nop 0
  s_cbranch_vccz L_back14
  s_sub_u32 s87, s87, 1
  s_cmp_lg_u32 s87, 0
  s_cbranch_scc1 L_loop15
  s_branch L_back14
L_slow17:
  s_mov_b32 s87, 20000
L_loop19:
  s_sleep 4
  s_mov_b32 s82, 5308416
  buffer_load_dword v27, v205, s[48:51], s82 offen sc1
  s_waitcnt vmcnt(0)
  s_add_u32 s82, s74, 2
  v_cmp_ne_u32 vcc, s82, v27
  s_nop 0
  s_cbranch_vccz L_back18
  s_sub_u32 s87, s87, 1
  s_cmp_lg_u32 s87, 0
  s_cbranch_scc1 L_loop19
  s_branch L_back18
L_slow20:
  s_mov_b32 s87, 20000
L_loop22:
  s_sleep 4
  s_mov_b32 s82, 5373952
  buffer_load_dword v27, v33, s[48:51], s82 offen sc1
  s_waitcnt vmcnt(0)
  s_add_u32 s82, s74, 4
  v_cmp_ne_u32 vcc, s82, v27
  s_nop 0
  s_cbranch_vccz L_back21
  s_sub_u32 s87, s87, 1
  s_cmp_lg_u32 s87, 0
  s_cbranch_scc1 L_loop22
  s_branch L_back21
L_slow23:
  s_mov_b32 s87, 20000
L_loop25:
  s_sleep 4
  s_mov_b32 s82, 5406720
  buffer_load_dword v27, v205, s[48:51], s82 offen sc1
  s_waitcnt vmcnt(0)
  s_add_u32 s82, s74, 5
  v_cmp_ne_u32 vcc, s82, v27
  s_nop 0
  s_cbranch_vccz L_back24
  s_sub_u32 s87, s87, 1
  s_cmp_lg_u32 s87, 0
  s_cbranch_scc1 L_loop25
  s_branch L_back24
L_slow26:
  s_mov_b32 s87, 20000
L_loop28:
  s_sleep 4
  s_mov_b32 s82, 5439488
  buffer_load_dword v27, v35, s[48:51], s82 offen sc1
  s_waitcnt vmcnt(0)
  s_add_u32 s82, s74, 6
  v_cmp_ne_u32 vcc, s82, v27
  s_nop 0
  s_cbranch_vccz L_back27
  s_sub_u32 s87, s87, 1
  s_cmp_lg_u32 s87, 0
  s_cbranch_scc1 L_loop28
  s_branch L_back27
L_nslow35:
  s_mov_b32 s87, 20000
L_nloop37:
  s_sleep 4
  v_mov_b32 v45, 0
  buffer_load_dword v45, v45, s[64:67], 0 offen sc1
  s_waitcnt vmcnt(0)
  v_readfirstlane_b32 s74, v45
  s_nop 0
  s_cmp_lg_u32 s74, 0
  s_cbranch_scc1 L_nback36
  s_sub_u32 s87, s87, 1
  s_cmp_lg_u32 s87, 0
  s_cbranch_scc1 L_nloop37
  s_branch L_nback36
L_slow39:
  s_mov_b32 s87, 20000
L_loop41:
  s_sleep 4
  s_mov_b32 s82, 5275648
  buffer_load_dword v27, v17, s[48:51], s82 offen sc1
  s_waitcnt vmcnt(0)
  s_add_u32 s82, s74, 1
  v_cmp_ne_u32 vcc, s82, v27
  s_nop 0
  s_cbranch_vccz L_back40
  s_sub_u32 s87, s87, 1
  s_cmp_lg_u32 s87, 0
  s_cbranch_scc1 L_loop41
  s_branch L_back40
L_slow42:
  s_mov_b32 s87, 20000
L_loop44:
  s_sleep 4
  s_mov_b32 s82, 5275648
  buffer_load_dword v45, v18, s[48:51], s82 offen sc1
  s_waitcnt vmcnt(0)
  s_add_u32 s82, s74, 1
  v_cmp_ne_u32 vcc, s82, v45
  s_nop 0
  s_cbranch_vccz L_back43
  s_sub_u32 s87, s87, 1
  s_cmp_lg_u32 s87, 0
  s_cbranch_scc1 L_loop44
  s_branch L_back43
L_slow45:
  s_mov_b32 s87, 20000
L_loop47:
  s_sleep 4
  s_mov_b32 s82, 5308416
  buffer_load_dword v45, v176, s[48:51], s82 offen sc1
  s_waitcnt vmcnt(0)
  s_add_u32 s82, s74, 2
  v_cmp_ne_u32 vcc, s82, v45
  s_nop 0
  s_cbranch_vccz L_back46
  s_sub_u32 s87, s87, 1
  s_cmp_lg_u32 s87, 0
  s_cbranch_scc1 L_loop47
  s_branch L_back46
L_slow48:
  s_mov_b32 s87, 20000
L_loop50:
  s_sleep 4
  s_mov_b32 s82, 5308416
  buffer_load_dword v27, v205, s[48:51], s82 offen sc1
  s_waitcnt vmcnt(0)
  s_add_u32 s82, s74, 2
  v_cmp_ne_u32 vcc, s82, v27
  s_nop 0
  s_cbranch_vccz L_back49
  s_sub_u32 s87, s87, 1
  s_cmp_lg_u32 s87, 0
  s_cbranch_scc1 L_loop50
  s_branch L_back49
L_slow51:
  s_mov_b32 s87, 20000
L_loop53:
  s_sleep 4
  s_mov_b32 s82, 5373952
  buffer_load_dword v27, v33, s[48:51], s82 offen sc1
  s_waitcnt vmcnt(0)
  s_add_u32 s82, s74, 4
  v_cmp_ne_u32 vcc, s82, v27
  s_nop 0
  s_cbranch_vccz L_back52
  s_sub_u32 s87, s87, 1
  s_cmp_lg_u32 s87, 0
  s_cbranch_scc1 L_loop53
  s_branch L_back52
L_slow54:
  s_mov_b32 s87, 20000
L_loop56:
  s_sleep 4
  s_mov_b32 s82, 5406720
  buffer_load_dword v27, v205, s[48:51], s82 offen sc1
  s_waitcnt vmcnt(0)
  s_add_u32 s82, s74, 5
  v_cmp_ne_u32 vcc, s82, v27
  s_nop 0
  s_cbranch_vccz L_back55
  s_sub_u32 s87, s87, 1
  s_cmp_lg_u32 s87, 0
  s_cbranch_scc1 L_loop56
  s_branch L_back55
L_slow57:
  s_mov_b32 s87, 20000
L_loop59:
  s_sleep 4
  s_mov_b32 s82, 5439488
  buffer_load_dword v27, v35, s[48:51], s82 offen sc1
  s_waitcnt vmcnt(0)
  s_add_u32 s82, s74, 6
  v_cmp_ne_u32 vcc, s82, v27
  s_nop 0
  s_cbranch_vccz L_back58
  s_sub_u32 s87, s87, 1
  s_cmp_lg_u32 s87, 0
  s_cbranch_scc1 L_loop59
  s_branch L_back58
L_code_end:
.fill 65536 / 4, 4, 0xbf810000
.section .rodata,"a"
.p2align 6
.amdhsa_kernel parallel_sum__linear_attn_block__mixer_channel_mlp__prompt_kernel
  .amdhsa_next_free_vgpr 512
  .amdhsa_next_free_sgpr 102
  .amdhsa_accum_offset 256
  .amdhsa_group_segment_fixed_size 0
  .amdhsa_kernarg_size 88
  .amdhsa_user_sgpr_count 2
  .amdhsa_user_sgpr_kernarg_segment_ptr 1
  .amdhsa_system_sgpr_workgroup_id_x 1
.end_amdhsa_kernel
```
